```python
import torch

def _softmax(x, axis=-1):
    return torch.softmax(x, dim=axis)
def _gelu(x):
    return torch.nn.functional.gelu(x, approximate="tanh")
def _silu(x):
    return torch.nn.functional.silu(x)
def _sigmoid(x):
    return torch.sigmoid(x)
def _layernorm(x, axis=-1, eps=1e-5):
    m = x.mean(dim=axis, keepdim=True)
    v = x.var(dim=axis, keepdim=True, unbiased=False)
    return (x - m) / torch.sqrt(v + eps)
def _scatter_add(tgt, idx, src, axis=0):
    return tgt.clone().index_add_(axis, idx, src)
def _segment_sum(src, seg, n):
    out = torch.zeros((n,) + src.shape[1:], dtype=src.dtype)
    return out.index_add_(0, seg, src)
def _pad(x, pw):
    flat = tuple(v for pair in reversed(pw) for v in pair)
    return torch.nn.functional.pad(x, flat)

kernel_name = 'concat_heads__linear_kernel_hedgehog__mha_block__prompt'

def setup_inputs():

    _w = (lambda a: (lambda t: t.to(torch.bfloat16) if t.is_floating_point() else t)(torch.as_tensor(a)))
    def _A_setup():
        B, S, D, H = 1, 2048, 448, 16
        Dh = D // H
        return {
            "x": _w((lambda *s: torch.randn(*s, dtype=torch.bfloat16) * 0.8)(B, S, D)),
            "wqkv": _w((lambda *s: torch.randn(*s, dtype=torch.bfloat16) * 1.6)(D, 3 * D)),
            "w_phi": _w((lambda *s: torch.randn(*s, dtype=torch.bfloat16) * 1.6)(H, Dh, Dh) * (Dh ** -0.5)),
            "wo": _w((lambda *s: torch.randn(*s, dtype=torch.bfloat16) * 0.1)(D, D)),
        }
    _A_in = _A_setup()

    def _B_setup():
        B, S, D, H = 1, 2048, 448, 16
        return {
            "x": _w((lambda *s: torch.randn(*s, dtype=torch.bfloat16) * 0.4)(B, S, D)),
            "wqkv": _w((lambda *s: torch.randn(*s, dtype=torch.bfloat16) * 0.4)(D, 3 * D)),
            "wo": _w((lambda *s: torch.randn(*s, dtype=torch.bfloat16) * 0.05)(D, D)),
        }
    _B_in = _B_setup()

    return {
        "A_x": _A_in["x"],
        "A_wqkv": _A_in["wqkv"],
        "A_w_phi": _A_in["w_phi"],
        "A_wo": _A_in["wo"],
        "B_x": _B_in["x"],
        "B_wqkv": _B_in["wqkv"],
        "B_wo": _B_in["wo"],
    }

def reference(A_x, A_wqkv, A_w_phi, A_wo, B_x, B_wqkv, B_wo):
    def _A_ref(x, wqkv, w_phi, wo):
        B, S, D = x.shape
        H = 16; Dh = D // H
        qkv = (lambda x, *d: x.permute(*d))((x @ wqkv).reshape(B, S, 3, H, Dh), 2, 0, 3, 1, 4)
        q, k, v = qkv[0], qkv[1], qkv[2]
        pq = torch.einsum("bhsd,hdf->bhsf", q, w_phi)
        pk = torch.einsum("bhsd,hdf->bhsf", k, w_phi)
        phi_q = torch.concatenate([_softmax(pq, axis=-1), _softmax(-pq, axis=-1)], axis=-1)
        phi_k = torch.concatenate([_softmax(pk, axis=-1), _softmax(-pk, axis=-1)], axis=-1)
        kv = torch.einsum("bhsf,bhsd->bhfd", phi_k, v)
        z  = torch.einsum("bhsf->bhf", phi_k)
        num = torch.einsum("bhqf,bhfd->bhqd", phi_q, kv)
        den = torch.einsum("bhqf,bhf->bhq", phi_q, z)[..., None] + 1e-6
        o = num / den
        return (lambda x, *d: x.permute(*d))(o, 0, 2, 1, 3).reshape(B, S, D) @ wo

    def _B_ref(x, wqkv, wo):
        B, S, D = x.shape
        H = 16
        Dh = D // H
        qkv = (lambda x, *d: x.permute(*d))((x @ wqkv).reshape(B, S, 3, H, Dh), 2, 0, 3, 1, 4)
        q, k, v = qkv[0], qkv[1], qkv[2]
        scores = torch.einsum("bhqd,bhkd->bhqk", q, k) * (Dh ** -0.5)
        p = _softmax(scores, axis=-1)
        o = torch.einsum("bhqk,bhkd->bhqd", p, v)
        return (lambda x, *d: x.permute(*d))(o, 0, 2, 1, 3).reshape(B, S, D) @ wo

    a = _A_ref(A_x, A_wqkv, A_w_phi, A_wo)
    b = _B_ref(B_x, B_wqkv, B_wo)
    return torch.concatenate([a, b], axis=-1)
```

```asm
; @launch grid=(256,1,1) block=(256,1,1) lds=155648
.amdgcn_target "amdgcn-amd-amdhsa--gfx950"
.text
.globl concat_heads__linear_kernel_hedgehog__mha_block__prompt_kernel
.p2align 8
.type concat_heads__linear_kernel_hedgehog__mha_block__prompt_kernel,@function
concat_heads__linear_kernel_hedgehog__mha_block__prompt_kernel:
  s_getpc_b64 s[48:49]
L_pc:
  s_load_dwordx16 s[4:19], s[0:1], 0
  s_load_dwordx4 s[20:23], s[0:1], 64
  s_cmp_ge_u32 s2, 256
  s_cbranch_scc1 L_end
  s_mov_b32 s50, L_codeend-L_pc
  s_mov_b32 s51, 0x20000
  v_lshlrev_b32 v16, 7, v0
  v_lshrrev_b32 v17, 6, v0
  buffer_load_dword v18, v16, s[48:51], 0 offen
  v_add_u32 v16, 0x8000, v16
  buffer_load_dword v31, v16, s[48:51], 0 offen
  v_readfirstlane_b32 s55, v17
  v_and_b32 v0, 63, v0
  v_mov_b32 v24, 0
  s_mov_b32 s100, 0
  s_and_b32 s72, s2, 7
  s_lshr_b32 s73, s2, 3
  s_and_b32 s52, s73, 1
  s_lshr_b32 s75, s73, 1
  s_and_b32 s53, s72, 1
  s_lshl_b32 s53, s53, 2
  s_and_b32 s74, s75, 3
  s_add_u32 s53, s53, s74
  s_lshr_b32 s54, s72, 1
  s_lshl_b32 s54, s54, 2
  s_lshr_b32 s74, s75, 2
  s_add_u32 s54, s54, s74
  s_lshl_b32 s57, s72, 1
  s_and_b32 s74, s73, 1
  s_add_u32 s57, s57, s74
  s_lshr_b32 s58, s73, 1
  s_and_b32 s59, s55, 1
  s_lshr_b32 s60, s55, 1
  s_lshl_b32 s92, s53, 1
  s_add_u32 s92, s92, s60
  s_lshl_b32 s72, s54, 2
  s_add_u32 s72, s72, s55
  s_mul_i32 s61, s72, 28672
  s_mul_i32 s73, s53, 112
  s_lshl_b32 s72, s55, 3
  s_mul_i32 s62, s72, 2688
  s_add_u32 s62, s62, s73
  s_add_u32 s62, s62, 896
  s_lshl_b32 s72, s55, 4
  s_mul_i32 s93, s72, 2688
  s_add_u32 s93, s93, s73
  s_lshl_b32 s63, s55, 12
  s_lshl_b32 s64, s55, 11
  s_add_u32 s64, s64, 114688
  s_lshl_b32 s82, s2, 2
  s_add_u32 s82, s82, s55
  s_mul_i32 s83, s82, 619
  s_lshr_b32 s83, s83, 16
  s_mul_i32 s84, s83, 106
  s_sub_u32 s84, s82, s84
  s_and_b32 s85, s84, 31
  s_mul_i32 s85, s85, 57344
  s_lshl_b32 s86, s83, 7
  s_add_u32 s85, s85, s86
  s_bfe_u32 s86, s84, 0x10005
  s_sub_u32 s87, s84, 64
  s_mul_i32 s88, s87, 3121
  s_lshr_b32 s88, s88, 16
  s_mul_i32 s89, s88, 21
  s_sub_u32 s87, s87, s89
  s_lshl_b32 s87, s87, 13
  s_mul_i32 s89, s83, 172032
  s_add_u32 s87, s87, s89
  s_cmp_lt_u32 s84, 64
  s_cselect_b32 s49, s85, s87
  s_cselect_b32 s50, s86, s88
  s_movk_i32 s67, 128
  s_cselect_b32 s67, 896, s67
  s_cselect_b32 s51, 0, 1
  s_sub_u32 s85, s82, 742
  s_cmp_ge_u32 s85, 49
  s_cselect_b32 s86, 1, 0
  s_mul_i32 s87, s86, 49
  s_sub_u32 s85, s85, s87
  s_lshl_b32 s85, s85, 13
  s_cmp_ge_u32 s82, 742
  s_cselect_b32 s49, s85, s49
  s_cselect_b32 s50, s86, s50
  s_cselect_b32 s67, 128, s67
  s_cselect_b32 s51, 2, s51
  s_cselect_b32 s83, 7, s83
  s_cmp_ge_u32 s82, 840
  s_cselect_b32 s48, 8, s83
  v_mul_u32_u24 v202, s67, v0
  v_lshlrev_b32 v1, 4, v0
  v_lshrrev_b32 v19, 3, v0
  v_lshrrev_b32 v20, 4, v0
  v_and_b32 v21, 7, v0
  v_and_b32 v22, 1, v20
  v_lshlrev_b32 v22, 2, v22
  v_xor_b32 v22, v22, v21
  v_min_u32 v22, 6, v22
  v_mul_u32_u24 v19, 2688, v19
  v_lshl_add_u32 v19, v22, 4, v19
  v_add_u32 v2, 256, v19
  v_add_u32 v3, 128, v19
  v_add_u32 v4, 20736, v19
  v_lshrrev_b32 v19, 3, v0
  v_mul_u32_u24 v19, 896, v19
  v_add_u32 v22, 0, v20
  v_xor_b32 v22, v22, v21
  v_lshl_add_u32 v196, v22, 4, v19
  v_add_u32 v22, 4, v20
  v_xor_b32 v22, v22, v21
  v_lshl_add_u32 v197, v22, 4, v19
  v_add_u32 v197, 6144, v197
  v_add_u32 v198, 12288, v196
  v_add_u32 v199, 12288, v197
  s_waitcnt lgkmcnt(0)
  s_cmp_eq_u32 s52, 0
  s_cselect_b32 s72, s12, s4
  s_cselect_b32 s73, s13, s5
  s_cselect_b32 s74, s14, s6
  s_cselect_b32 s75, s15, s7
  s_mov_b32 s24, s72
  s_and_b32 s25, s73, 0xffff
  s_mov_b32 s26, 1835008
  s_mov_b32 s27, 0x20000
  s_sub_u32 s28, s74, 256
  s_subb_u32 s29, s75, 0
  s_and_b32 s29, s29, 0xffff
  s_mov_b32 s30, 1204480
  s_mov_b32 s31, 0x20000
  s_cmp_eq_u32 s50, 0
  s_cselect_b32 s82, s12, s4
  s_cselect_b32 s83, s13, s5
  s_cselect_b32 s84, s14, s6
  s_cselect_b32 s85, s15, s7
  s_cselect_b32 s86, s16, s10
  s_cselect_b32 s87, s17, s11
  s_cmp_eq_u32 s51, 1
  s_cselect_b32 s36, s84, s82
  s_cselect_b32 s37, s85, s83
  s_mov_b32 s38, 1835008
  s_cselect_b32 s38, 1204224, s38
  s_cmp_eq_u32 s51, 2
  s_cselect_b32 s36, s86, s36
  s_cselect_b32 s37, s87, s37
  s_cselect_b32 s38, 401408, s38
  s_and_b32 s37, s37, 0xffff
  s_mov_b32 s39, 0x20000
  s_sub_u32 s82, s48, 0
  s_cmp_le_u32 s82, 1
  s_cbranch_scc0 L_nopf_1
  buffer_load_dword v203, v202, s[36:39], s49 offen
L_nopf_1:
  s_add_u32 m0, s63, 0
  s_add_u32 s65, s61, 0
  buffer_load_dwordx4 v196, s[24:27], s65 offen offset:0 lds
  buffer_load_dwordx4 v197, s[24:27], s65 offen offset:1024 lds
  buffer_load_dwordx4 v198, s[24:27], s65 offen offset:2048 lds
  buffer_load_dwordx4 v199, s[24:27], s65 offen offset:3072 lds
  s_add_u32 m0, s64, 0
  s_add_u32 s66, s62, 0
  buffer_load_dwordx4 v2, s[28:31], s66 offen offset:0 lds
  buffer_load_dwordx4 v3, s[28:31], s66 offen offset:1024 lds
  s_add_u32 m0, s64, 8192
  s_add_u32 s66, s62, 86016
  buffer_load_dwordx4 v2, s[28:31], s66 offen offset:0 lds
  buffer_load_dwordx4 v3, s[28:31], s66 offen offset:1024 lds
  s_mov_b32 s40, s22
  s_and_b32 s41, s23, 0xffff
  s_mov_b32 s42, 15204352
  s_mov_b32 s43, 0x20000
  s_load_dword s56, s[22:23], 0
  s_add_u32 m0, s63, 16384
  s_add_u32 s65, s61, 128
  buffer_load_dwordx4 v196, s[24:27], s65 offen offset:0 lds
  buffer_load_dwordx4 v197, s[24:27], s65 offen offset:1024 lds
  buffer_load_dwordx4 v198, s[24:27], s65 offen offset:2048 lds
  buffer_load_dwordx4 v199, s[24:27], s65 offen offset:3072 lds
  s_add_u32 m0, s64, 16384
  s_add_u32 s66, s62, 172032
  buffer_load_dwordx4 v2, s[28:31], s66 offen offset:0 lds
  buffer_load_dwordx4 v3, s[28:31], s66 offen offset:1024 lds
  s_add_u32 m0, s64, 24576
  s_add_u32 s66, s62, 258048
  buffer_load_dwordx4 v2, s[28:31], s66 offen offset:0 lds
  buffer_load_dwordx4 v3, s[28:31], s66 offen offset:1024 lds
  s_sub_u32 s82, s48, 2
  s_cmp_le_u32 s82, 1
  s_cbranch_scc0 L_nopf_2
  buffer_load_dword v203, v202, s[36:39], s49 offen
L_nopf_2:
  s_mov_b32 s32, s8
  s_and_b32 s33, s9, 0xffff
  s_mov_b32 s34, 25088
  s_mov_b32 s35, 0x20000
  s_mov_b32 s44, s18
  s_and_b32 s45, s19, 0xffff
  s_mov_b32 s46, 3670016
  s_mov_b32 s47, 0x20000
  v_and_b32 v19, 31, v0
  v_lshrrev_b32 v20, 5, v0
  s_lshl_b32 s72, s59, 6
  v_add_u32 v21, s72, v19
  v_lshlrev_b32 v21, 7, v21
  v_bfe_u32 v22, v0, 1, 3
  v_xor_b32 v22, v22, v20
  v_xor_b32 v23, 0, v22
  v_lshl_add_u32 v5, v23, 4, v21
  v_add_u32 v9, 65536, v5
  v_xor_b32 v23, 2, v22
  v_lshl_add_u32 v6, v23, 4, v21
  v_add_u32 v10, 65536, v6
  v_xor_b32 v23, 4, v22
  v_lshl_add_u32 v7, v23, 4, v21
  v_add_u32 v11, 65536, v7
  v_xor_b32 v23, 6, v22
  v_lshl_add_u32 v8, v23, 4, v21
  v_add_u32 v12, 65536, v8
  v_bfe_u32 v21, v0, 4, 1
  v_lshlrev_b32 v21, 5, v21
  v_and_b32 v22, 3, v0
  v_lshl_add_u32 v21, v22, 3, v21
  s_mul_i32 s72, s60, 56
  v_add_u32 v21, s72, v21
  v_bfe_u32 v22, v0, 3, 1
  v_lshlrev_b32 v22, 6, v22
  v_xor_b32 v21, v21, v22
  v_bfe_u32 v22, v0, 2, 2
  v_lshl_add_u32 v21, v22, 7, v21
  v_add_u32 v21, 114688, v21
  v_lshl_add_u32 v13, v20, 11, v21
  v_lshl_add_u32 v14, v20, 10, v21
  s_mov_b32 s68, 0x3e8b97f6
  s_mov_b32 s69, 0x3e8b97f6
  s_mov_b32 s70, 0x3fb8aa3b
  s_mov_b32 s71, 0x3fb8aa3b
  s_waitcnt vmcnt(10)
  s_waitcnt lgkmcnt(0)
  s_barrier
  s_add_u32 m0, s63, 32768
  s_add_u32 s65, s61, 256
  buffer_load_dwordx4 v196, s[24:27], s65 offen offset:0 lds
  buffer_load_dwordx4 v197, s[24:27], s65 offen offset:1024 lds
  buffer_load_dwordx4 v198, s[24:27], s65 offen offset:2048 lds
  buffer_load_dwordx4 v199, s[24:27], s65 offen offset:3072 lds
  s_add_u32 m0, s64, 32768
  s_add_u32 s66, s62, 344064
  buffer_load_dwordx4 v2, s[28:31], s66 offen offset:0 lds
  buffer_load_dwordx4 v3, s[28:31], s66 offen offset:1024 lds
  s_sub_u32 s82, s48, 4
  s_cmp_le_u32 s82, 0
  s_cbranch_scc0 L_nopf_3
  buffer_load_dword v203, v202, s[36:39], s49 offen
L_nopf_3:
  s_mul_i32 s56, s56, 0x9E3779B1
  s_add_u32 s56, s56, 0x7F4A7C15
  ds_read_b128 v[32:35], v5 offset:0
  ds_read_b128 v[36:39], v5 offset:4096
  ds_read_b64_tr_b16 v[40:41], v13 offset:0
  ds_read_b64_tr_b16 v[42:43], v13 offset:512
  ds_read_b64_tr_b16 v[44:45], v13 offset:1024
  ds_read_b64_tr_b16 v[46:47], v13 offset:1536
  ds_read_b128 v[48:51], v6 offset:0
  ds_read_b128 v[52:55], v6 offset:4096
  ds_read_b64_tr_b16 v[56:57], v13 offset:4096
  ds_read_b64_tr_b16 v[58:59], v13 offset:4608
  ds_read_b64_tr_b16 v[60:61], v13 offset:5120
  ds_read_b64_tr_b16 v[62:63], v13 offset:5632
  s_waitcnt vmcnt(14)
  s_waitcnt lgkmcnt(0)
  s_barrier
  v_mfma_f32_32x32x16_bf16 v[96:111], v[40:43], v[32:35], 0
  s_add_u32 m0, s64, 0
  s_add_u32 s66, s62, 430080
  buffer_load_dwordx4 v2, s[28:31], s66 offen offset:0 lds
  buffer_load_dwordx4 v3, s[28:31], s66 offen offset:1024 lds
  s_sub_u32 s82, s48, 5
  s_cmp_le_u32 s82, 0
  s_cbranch_scc0 L_nopf_4
  buffer_load_dword v203, v202, s[36:39], s49 offen
L_nopf_4:
  ds_read_b128 v[64:67], v7 offset:0
  ds_read_b128 v[68:71], v7 offset:4096
  ds_read_b64_tr_b16 v[72:73], v13 offset:8192
  v_mfma_f32_32x32x16_bf16 v[112:127], v[40:43], v[36:39], 0
  ds_read_b64_tr_b16 v[74:75], v13 offset:8704
  ds_read_b64_tr_b16 v[76:77], v13 offset:9216
  ds_read_b64_tr_b16 v[78:79], v13 offset:9728
  v_mfma_f32_32x32x16_bf16 v[128:143], v[32:35], v[44:47], 0
  ds_read_b128 v[80:83], v8 offset:0
  ds_read_b128 v[84:87], v8 offset:4096
  ds_read_b64_tr_b16 v[88:89], v13 offset:12288
  v_mfma_f32_32x32x16_bf16 v[144:159], v[36:39], v[44:47], 0
  ds_read_b64_tr_b16 v[90:91], v13 offset:12800
  ds_read_b64_tr_b16 v[92:93], v13 offset:13312
  ds_read_b64_tr_b16 v[94:95], v13 offset:13824
  v_mfma_f32_32x32x16_bf16 v[96:111], v[56:59], v[48:51], v[96:111]
  v_mfma_f32_32x32x16_bf16 v[112:127], v[56:59], v[52:55], v[112:127]
  v_mfma_f32_32x32x16_bf16 v[128:143], v[48:51], v[60:63], v[128:143]
  v_mfma_f32_32x32x16_bf16 v[144:159], v[52:55], v[60:63], v[144:159]
  s_waitcnt vmcnt(10)
  s_waitcnt lgkmcnt(0)
  s_barrier
  v_mfma_f32_32x32x16_bf16 v[96:111], v[72:75], v[64:67], v[96:111]
  s_add_u32 m0, s63, 49152
  s_add_u32 s65, s61, 384
  buffer_load_dwordx4 v196, s[24:27], s65 offen offset:0 lds
  buffer_load_dwordx4 v197, s[24:27], s65 offen offset:1024 lds
  buffer_load_dwordx4 v198, s[24:27], s65 offen offset:2048 lds
  buffer_load_dwordx4 v199, s[24:27], s65 offen offset:3072 lds
  s_add_u32 m0, s64, 8192
  s_add_u32 s66, s62, 516096
  buffer_load_dwordx4 v2, s[28:31], s66 offen offset:0 lds
  buffer_load_dwordx4 v3, s[28:31], s66 offen offset:1024 lds
  s_sub_u32 s82, s48, 6
  s_cmp_le_u32 s82, 0
  s_cbranch_scc0 L_nopf_5
  buffer_load_dword v203, v202, s[36:39], s49 offen
L_nopf_5:
  ds_read_b128 v[32:35], v5 offset:16384
  ds_read_b128 v[36:39], v5 offset:20480
  ds_read_b64_tr_b16 v[40:41], v13 offset:16384
  v_mfma_f32_32x32x16_bf16 v[112:127], v[72:75], v[68:71], v[112:127]
  ds_read_b64_tr_b16 v[42:43], v13 offset:16896
  ds_read_b64_tr_b16 v[44:45], v13 offset:17408
  ds_read_b64_tr_b16 v[46:47], v13 offset:17920
  v_mfma_f32_32x32x16_bf16 v[128:143], v[64:67], v[76:79], v[128:143]
  ds_read_b128 v[48:51], v6 offset:16384
  ds_read_b128 v[52:55], v6 offset:20480
  ds_read_b64_tr_b16 v[56:57], v13 offset:20480
  v_mfma_f32_32x32x16_bf16 v[144:159], v[68:71], v[76:79], v[144:159]
  ds_read_b64_tr_b16 v[58:59], v13 offset:20992
  ds_read_b64_tr_b16 v[60:61], v13 offset:21504
  ds_read_b64_tr_b16 v[62:63], v13 offset:22016
  v_mfma_f32_32x32x16_bf16 v[96:111], v[88:91], v[80:83], v[96:111]
  v_mfma_f32_32x32x16_bf16 v[112:127], v[88:91], v[84:87], v[112:127]
  v_mfma_f32_32x32x16_bf16 v[128:143], v[80:83], v[92:95], v[128:143]
  v_mfma_f32_32x32x16_bf16 v[144:159], v[84:87], v[92:95], v[144:159]
  s_waitcnt vmcnt(14)
  s_waitcnt lgkmcnt(0)
  s_barrier
  v_mfma_f32_32x32x16_bf16 v[96:111], v[40:43], v[32:35], v[96:111]
  s_add_u32 m0, s64, 16384
  s_add_u32 s66, s62, 602112
  buffer_load_dwordx4 v2, s[28:31], s66 offen offset:0 lds
  buffer_load_dwordx4 v3, s[28:31], s66 offen offset:1024 lds
  ds_read_b128 v[64:67], v7 offset:16384
  ds_read_b128 v[68:71], v7 offset:20480
  ds_read_b64_tr_b16 v[72:73], v13 offset:24576
  v_mfma_f32_32x32x16_bf16 v[112:127], v[40:43], v[36:39], v[112:127]
  ds_read_b64_tr_b16 v[74:75], v13 offset:25088
  ds_read_b64_tr_b16 v[76:77], v13 offset:25600
  ds_read_b64_tr_b16 v[78:79], v13 offset:26112
  v_mfma_f32_32x32x16_bf16 v[128:143], v[32:35], v[44:47], v[128:143]
  ds_read_b128 v[80:83], v8 offset:16384
  ds_read_b128 v[84:87], v8 offset:20480
  ds_read_b64_tr_b16 v[88:89], v13 offset:28672
  v_mfma_f32_32x32x16_bf16 v[144:159], v[36:39], v[44:47], v[144:159]
  ds_read_b64_tr_b16 v[90:91], v13 offset:29184
  ds_read_b64_tr_b16 v[92:93], v13 offset:29696
  ds_read_b64_tr_b16 v[94:95], v13 offset:30208
  v_mfma_f32_32x32x16_bf16 v[96:111], v[56:59], v[48:51], v[96:111]
  v_mfma_f32_32x32x16_bf16 v[112:127], v[56:59], v[52:55], v[112:127]
  v_mfma_f32_32x32x16_bf16 v[128:143], v[48:51], v[60:63], v[128:143]
  v_mfma_f32_32x32x16_bf16 v[144:159], v[52:55], v[60:63], v[144:159]
  s_waitcnt vmcnt(10)
  s_waitcnt lgkmcnt(0)
  s_barrier
  v_mfma_f32_32x32x16_bf16 v[96:111], v[72:75], v[64:67], v[96:111]
  s_add_u32 m0, s63, 65536
  s_add_u32 s65, s61, 512
  buffer_load_dwordx4 v196, s[24:27], s65 offen offset:0 lds
  buffer_load_dwordx4 v197, s[24:27], s65 offen offset:1024 lds
  buffer_load_dwordx4 v198, s[24:27], s65 offen offset:2048 lds
  buffer_load_dwordx4 v199, s[24:27], s65 offen offset:3072 lds
  s_add_u32 m0, s64, 24576
  s_add_u32 s66, s62, 688128
  buffer_load_dwordx4 v2, s[28:31], s66 offen offset:0 lds
  buffer_load_dwordx4 v3, s[28:31], s66 offen offset:1024 lds
  ds_read_b128 v[32:35], v5 offset:32768
  ds_read_b128 v[36:39], v5 offset:36864
  ds_read_b64_tr_b16 v[40:41], v13 offset:32768
  v_mfma_f32_32x32x16_bf16 v[112:127], v[72:75], v[68:71], v[112:127]
  ds_read_b64_tr_b16 v[42:43], v13 offset:33280
  ds_read_b64_tr_b16 v[44:45], v13 offset:33792
  ds_read_b64_tr_b16 v[46:47], v13 offset:34304
  v_mfma_f32_32x32x16_bf16 v[128:143], v[64:67], v[76:79], v[128:143]
  ds_read_b128 v[48:51], v6 offset:32768
  ds_read_b128 v[52:55], v6 offset:36864
  ds_read_b64_tr_b16 v[56:57], v13 offset:36864
  v_mfma_f32_32x32x16_bf16 v[144:159], v[68:71], v[76:79], v[144:159]
  ds_read_b64_tr_b16 v[58:59], v13 offset:37376
  ds_read_b64_tr_b16 v[60:61], v13 offset:37888
  ds_read_b64_tr_b16 v[62:63], v13 offset:38400
  v_mfma_f32_32x32x16_bf16 v[96:111], v[88:91], v[80:83], v[96:111]
  v_mfma_f32_32x32x16_bf16 v[112:127], v[88:91], v[84:87], v[112:127]
  v_mfma_f32_32x32x16_bf16 v[128:143], v[80:83], v[92:95], v[128:143]
  v_mfma_f32_32x32x16_bf16 v[144:159], v[84:87], v[92:95], v[144:159]
  s_waitcnt vmcnt(14)
  s_waitcnt lgkmcnt(0)
  s_barrier
  v_mfma_f32_32x32x16_bf16 v[96:111], v[40:43], v[32:35], v[96:111]
  s_add_u32 m0, s64, 32768
  s_add_u32 s66, s62, 774144
  buffer_load_dwordx4 v2, s[28:31], s66 offen offset:0 lds
  buffer_load_dwordx4 v3, s[28:31], s66 offen offset:1024 lds
  ds_read_b128 v[64:67], v7 offset:32768
  ds_read_b128 v[68:71], v7 offset:36864
  ds_read_b64_tr_b16 v[72:73], v13 offset:0
  v_mfma_f32_32x32x16_bf16 v[112:127], v[40:43], v[36:39], v[112:127]
  ds_read_b64_tr_b16 v[74:75], v13 offset:512
  ds_read_b64_tr_b16 v[76:77], v13 offset:1024
  ds_read_b64_tr_b16 v[78:79], v13 offset:1536
  v_mfma_f32_32x32x16_bf16 v[128:143], v[32:35], v[44:47], v[128:143]
  ds_read_b128 v[80:83], v8 offset:32768
  ds_read_b128 v[84:87], v8 offset:36864
  ds_read_b64_tr_b16 v[88:89], v13 offset:4096
  v_mfma_f32_32x32x16_bf16 v[144:159], v[36:39], v[44:47], v[144:159]
  ds_read_b64_tr_b16 v[90:91], v13 offset:4608
  ds_read_b64_tr_b16 v[92:93], v13 offset:5120
  ds_read_b64_tr_b16 v[94:95], v13 offset:5632
  v_mfma_f32_32x32x16_bf16 v[96:111], v[56:59], v[48:51], v[96:111]
  v_mfma_f32_32x32x16_bf16 v[112:127], v[56:59], v[52:55], v[112:127]
  v_mfma_f32_32x32x16_bf16 v[128:143], v[48:51], v[60:63], v[128:143]
  v_mfma_f32_32x32x16_bf16 v[144:159], v[52:55], v[60:63], v[144:159]
  s_waitcnt vmcnt(10)
  s_waitcnt lgkmcnt(0)
  s_barrier
  v_mfma_f32_32x32x16_bf16 v[96:111], v[72:75], v[64:67], v[96:111]
  s_add_u32 m0, s63, 81920
  s_add_u32 s65, s61, 640
  buffer_load_dwordx4 v196, s[24:27], s65 offen offset:0 lds
  buffer_load_dwordx4 v197, s[24:27], s65 offen offset:1024 lds
  buffer_load_dwordx4 v198, s[24:27], s65 offen offset:2048 lds
  buffer_load_dwordx4 v199, s[24:27], s65 offen offset:3072 lds
  s_add_u32 m0, s64, 0
  s_add_u32 s66, s62, 860160
  buffer_load_dwordx4 v2, s[28:31], s66 offen offset:0 lds
  buffer_load_dwordx4 v3, s[28:31], s66 offen offset:1024 lds
  ds_read_b128 v[32:35], v5 offset:49152
  ds_read_b128 v[36:39], v5 offset:53248
  ds_read_b64_tr_b16 v[40:41], v13 offset:8192
  v_mfma_f32_32x32x16_bf16 v[112:127], v[72:75], v[68:71], v[112:127]
  ds_read_b64_tr_b16 v[42:43], v13 offset:8704
  ds_read_b64_tr_b16 v[44:45], v13 offset:9216
  ds_read_b64_tr_b16 v[46:47], v13 offset:9728
  v_mfma_f32_32x32x16_bf16 v[128:143], v[64:67], v[76:79], v[128:143]
  ds_read_b128 v[48:51], v6 offset:49152
  ds_read_b128 v[52:55], v6 offset:53248
  ds_read_b64_tr_b16 v[56:57], v13 offset:12288
  v_mfma_f32_32x32x16_bf16 v[144:159], v[68:71], v[76:79], v[144:159]
  ds_read_b64_tr_b16 v[58:59], v13 offset:12800
  ds_read_b64_tr_b16 v[60:61], v13 offset:13312
  ds_read_b64_tr_b16 v[62:63], v13 offset:13824
  v_mfma_f32_32x32x16_bf16 v[96:111], v[88:91], v[80:83], v[96:111]
  v_mfma_f32_32x32x16_bf16 v[112:127], v[88:91], v[84:87], v[112:127]
  v_mfma_f32_32x32x16_bf16 v[128:143], v[80:83], v[92:95], v[128:143]
  v_mfma_f32_32x32x16_bf16 v[144:159], v[84:87], v[92:95], v[144:159]
  s_waitcnt vmcnt(14)
  s_waitcnt lgkmcnt(0)
  s_barrier
  v_mfma_f32_32x32x16_bf16 v[96:111], v[40:43], v[32:35], v[96:111]
  s_add_u32 m0, s64, 8192
  s_add_u32 s66, s62, 946176
  buffer_load_dwordx4 v2, s[28:31], s66 offen offset:0 lds
  buffer_load_dwordx4 v3, s[28:31], s66 offen offset:1024 lds
  ds_read_b128 v[64:67], v7 offset:49152
  ds_read_b128 v[68:71], v7 offset:53248
  ds_read_b64_tr_b16 v[72:73], v13 offset:16384
  v_mfma_f32_32x32x16_bf16 v[112:127], v[40:43], v[36:39], v[112:127]
  ds_read_b64_tr_b16 v[74:75], v13 offset:16896
  ds_read_b64_tr_b16 v[76:77], v13 offset:17408
  ds_read_b64_tr_b16 v[78:79], v13 offset:17920
  v_mfma_f32_32x32x16_bf16 v[128:143], v[32:35], v[44:47], v[128:143]
  ds_read_b128 v[80:83], v8 offset:49152
  ds_read_b128 v[84:87], v8 offset:53248
  ds_read_b64_tr_b16 v[88:89], v13 offset:20480
  v_mfma_f32_32x32x16_bf16 v[144:159], v[36:39], v[44:47], v[144:159]
  ds_read_b64_tr_b16 v[90:91], v13 offset:20992
  ds_read_b64_tr_b16 v[92:93], v13 offset:21504
  ds_read_b64_tr_b16 v[94:95], v13 offset:22016
  v_mfma_f32_32x32x16_bf16 v[96:111], v[56:59], v[48:51], v[96:111]
  v_mfma_f32_32x32x16_bf16 v[112:127], v[56:59], v[52:55], v[112:127]
  v_mfma_f32_32x32x16_bf16 v[128:143], v[48:51], v[60:63], v[128:143]
  v_mfma_f32_32x32x16_bf16 v[144:159], v[52:55], v[60:63], v[144:159]
  s_waitcnt vmcnt(10)
  s_waitcnt lgkmcnt(0)
  s_barrier
  v_mfma_f32_32x32x16_bf16 v[96:111], v[72:75], v[64:67], v[96:111]
  s_add_u32 m0, s63, 98304
  s_add_u32 s65, s61, 768
  buffer_load_dwordx4 v196, s[24:27], s65 offen offset:0 lds
  buffer_load_dwordx4 v197, s[24:27], s65 offen offset:1024 lds
  buffer_load_dwordx4 v198, s[24:27], s65 offen offset:2048 lds
  buffer_load_dwordx4 v199, s[24:27], s65 offen offset:3072 lds
  s_add_u32 m0, s64, 16384
  s_add_u32 s66, s62, 1032192
  buffer_load_dwordx4 v2, s[28:31], s66 offen offset:0 lds
  buffer_load_dwordx4 v3, s[28:31], s66 offen offset:1024 lds
  s_sub_u32 s82, s48, 7
  s_cmp_le_u32 s82, 0
  s_cbranch_scc0 L_nopf_6
  buffer_load_dword v203, v202, s[36:39], s49 offen
L_nopf_6:
  ds_read_b128 v[32:35], v9 offset:0
  ds_read_b128 v[36:39], v9 offset:4096
  ds_read_b64_tr_b16 v[40:41], v13 offset:24576
  v_mfma_f32_32x32x16_bf16 v[112:127], v[72:75], v[68:71], v[112:127]
  ds_read_b64_tr_b16 v[42:43], v13 offset:25088
  ds_read_b64_tr_b16 v[44:45], v13 offset:25600
  ds_read_b64_tr_b16 v[46:47], v13 offset:26112
  v_mfma_f32_32x32x16_bf16 v[128:143], v[64:67], v[76:79], v[128:143]
  ds_read_b128 v[48:51], v10 offset:0
  ds_read_b128 v[52:55], v10 offset:4096
  ds_read_b64_tr_b16 v[56:57], v13 offset:28672
  v_mfma_f32_32x32x16_bf16 v[144:159], v[68:71], v[76:79], v[144:159]
  ds_read_b64_tr_b16 v[58:59], v13 offset:29184
  ds_read_b64_tr_b16 v[60:61], v13 offset:29696
  ds_read_b64_tr_b16 v[62:63], v13 offset:30208
  v_mfma_f32_32x32x16_bf16 v[96:111], v[88:91], v[80:83], v[96:111]
  v_mfma_f32_32x32x16_bf16 v[112:127], v[88:91], v[84:87], v[112:127]
  v_mfma_f32_32x32x16_bf16 v[128:143], v[80:83], v[92:95], v[128:143]
  v_mfma_f32_32x32x16_bf16 v[144:159], v[84:87], v[92:95], v[144:159]
  s_waitcnt vmcnt(14)
  s_waitcnt lgkmcnt(0)
  s_barrier
  v_mfma_f32_32x32x16_bf16 v[96:111], v[40:43], v[32:35], v[96:111]
  s_add_u32 m0, s64, 24576
  s_add_u32 s66, s62, 1118208
  buffer_load_dwordx4 v2, s[28:31], s66 offen offset:0 lds
  buffer_load_dwordx4 v3, s[28:31], s66 offen offset:1024 lds
  v_and_b32 v19, 31, v0
  v_lshrrev_b32 v20, 5, v0
  v_min_u32 v21, 27, v19
  v_mul_u32_u24 v22, 112, v20
  v_add_u32 v21, v21, v22
  v_lshlrev_b32 v21, 1, v21
  s_mul_i32 s72, s92, 1568
  buffer_load_ushort v216, v21, s[32:35], s72 offen offset:0
  buffer_load_ushort v217, v21, s[32:35], s72 offen offset:56
  buffer_load_ushort v218, v21, s[32:35], s72 offen offset:112
  buffer_load_ushort v219, v21, s[32:35], s72 offen offset:168
  buffer_load_ushort v220, v21, s[32:35], s72 offen offset:448
  buffer_load_ushort v221, v21, s[32:35], s72 offen offset:504
  buffer_load_ushort v222, v21, s[32:35], s72 offen offset:560
  buffer_load_ushort v223, v21, s[32:35], s72 offen offset:616
  buffer_load_ushort v224, v21, s[32:35], s72 offen offset:896
  buffer_load_ushort v225, v21, s[32:35], s72 offen offset:952
  buffer_load_ushort v226, v21, s[32:35], s72 offen offset:1008
  buffer_load_ushort v227, v21, s[32:35], s72 offen offset:1064
  buffer_load_ushort v228, v21, s[32:35], s72 offen offset:1344
  buffer_load_ushort v229, v21, s[32:35], s72 offen offset:1400
  buffer_load_ushort v230, v21, s[32:35], s72 offen offset:1456
  buffer_load_ushort v231, v21, s[32:35], s72 offen offset:1512
  ds_read_b128 v[64:67], v11 offset:0
  ds_read_b128 v[68:71], v11 offset:4096
  ds_read_b64_tr_b16 v[72:73], v13 offset:32768
  v_mfma_f32_32x32x16_bf16 v[112:127], v[40:43], v[36:39], v[112:127]
  ds_read_b64_tr_b16 v[74:75], v13 offset:33280
  ds_read_b64_tr_b16 v[76:77], v13 offset:33792
  ds_read_b64_tr_b16 v[78:79], v13 offset:34304
  v_mfma_f32_32x32x16_bf16 v[128:143], v[32:35], v[44:47], v[128:143]
  ds_read_b128 v[80:83], v12 offset:0
  ds_read_b128 v[84:87], v12 offset:4096
  ds_read_b64_tr_b16 v[88:89], v13 offset:36864
  v_mfma_f32_32x32x16_bf16 v[144:159], v[36:39], v[44:47], v[144:159]
  ds_read_b64_tr_b16 v[90:91], v13 offset:37376
  ds_read_b64_tr_b16 v[92:93], v13 offset:37888
  ds_read_b64_tr_b16 v[94:95], v13 offset:38400
  v_mfma_f32_32x32x16_bf16 v[96:111], v[56:59], v[48:51], v[96:111]
  v_mfma_f32_32x32x16_bf16 v[112:127], v[56:59], v[52:55], v[112:127]
  v_mfma_f32_32x32x16_bf16 v[128:143], v[48:51], v[60:63], v[128:143]
  v_mfma_f32_32x32x16_bf16 v[144:159], v[52:55], v[60:63], v[144:159]
  s_waitcnt vmcnt(26)
  s_waitcnt lgkmcnt(0)
  s_barrier
  v_mfma_f32_32x32x16_bf16 v[96:111], v[72:75], v[64:67], v[96:111]
  s_add_u32 m0, s64, 32768
  s_add_u32 s66, s93, 0
  buffer_load_dwordx4 v2, s[28:31], s66 offen lds
  buffer_load_dwordx4 v4, s[28:31], s66 offen offset:1024 lds
  ds_read_b128 v[32:35], v9 offset:16384
  ds_read_b128 v[36:39], v9 offset:20480
  ds_read_b64_tr_b16 v[40:41], v13 offset:0
  v_mfma_f32_32x32x16_bf16 v[112:127], v[72:75], v[68:71], v[112:127]
  ds_read_b64_tr_b16 v[42:43], v13 offset:512
  ds_read_b64_tr_b16 v[44:45], v13 offset:1024
  ds_read_b64_tr_b16 v[46:47], v13 offset:1536
  v_mfma_f32_32x32x16_bf16 v[128:143], v[64:67], v[76:79], v[128:143]
  ds_read_b128 v[48:51], v10 offset:16384
  ds_read_b128 v[52:55], v10 offset:20480
  ds_read_b64_tr_b16 v[56:57], v13 offset:4096
  v_mfma_f32_32x32x16_bf16 v[144:159], v[68:71], v[76:79], v[144:159]
  ds_read_b64_tr_b16 v[58:59], v13 offset:4608
  ds_read_b64_tr_b16 v[60:61], v13 offset:5120
  ds_read_b64_tr_b16 v[62:63], v13 offset:5632
  v_mfma_f32_32x32x16_bf16 v[96:111], v[88:91], v[80:83], v[96:111]
  v_mfma_f32_32x32x16_bf16 v[112:127], v[88:91], v[84:87], v[112:127]
  v_mfma_f32_32x32x16_bf16 v[128:143], v[80:83], v[92:95], v[128:143]
  v_mfma_f32_32x32x16_bf16 v[144:159], v[84:87], v[92:95], v[144:159]
  s_waitcnt vmcnt(26)
  s_waitcnt lgkmcnt(0)
  s_barrier
  v_mfma_f32_32x32x16_bf16 v[96:111], v[40:43], v[32:35], v[96:111]
  s_add_u32 m0, s64, 0
  s_add_u32 s66, s93, 172032
  buffer_load_dwordx4 v2, s[28:31], s66 offen lds
  buffer_load_dwordx4 v4, s[28:31], s66 offen offset:1024 lds
  ds_read_b128 v[64:67], v11 offset:16384
  ds_read_b128 v[68:71], v11 offset:20480
  ds_read_b64_tr_b16 v[72:73], v13 offset:8192
  v_mfma_f32_32x32x16_bf16 v[112:127], v[40:43], v[36:39], v[112:127]
  ds_read_b64_tr_b16 v[74:75], v13 offset:8704
  ds_read_b64_tr_b16 v[76:77], v13 offset:9216
  ds_read_b64_tr_b16 v[78:79], v13 offset:9728
  v_mfma_f32_32x32x16_bf16 v[128:143], v[32:35], v[44:47], v[128:143]
  ds_read_b128 v[80:83], v12 offset:16384
  ds_read_b128 v[84:87], v12 offset:20480
  ds_read_b64_tr_b16 v[88:89], v13 offset:12288
  v_mfma_f32_32x32x16_bf16 v[144:159], v[36:39], v[44:47], v[144:159]
  ds_read_b64_tr_b16 v[90:91], v13 offset:12800
  ds_read_b64_tr_b16 v[92:93], v13 offset:13312
  ds_read_b64_tr_b16 v[94:95], v13 offset:13824
  v_mfma_f32_32x32x16_bf16 v[96:111], v[56:59], v[48:51], v[96:111]
  v_mfma_f32_32x32x16_bf16 v[112:127], v[56:59], v[52:55], v[112:127]
  v_mfma_f32_32x32x16_bf16 v[128:143], v[48:51], v[60:63], v[128:143]
  v_mfma_f32_32x32x16_bf16 v[144:159], v[52:55], v[60:63], v[144:159]
  s_waitcnt vmcnt(22)
  s_waitcnt lgkmcnt(0)
  s_barrier
  v_mfma_f32_32x32x16_bf16 v[96:111], v[72:75], v[64:67], v[96:111]
  s_add_u32 m0, s64, 8192
  s_add_u32 s66, s93, 344064
  buffer_load_dwordx4 v2, s[28:31], s66 offen lds
  buffer_load_dwordx4 v4, s[28:31], s66 offen offset:1024 lds
  ds_read_b128 v[32:35], v9 offset:32768
  ds_read_b128 v[36:39], v9 offset:36864
  ds_read_b64_tr_b16 v[40:41], v13 offset:16384
  v_mfma_f32_32x32x16_bf16 v[112:127], v[72:75], v[68:71], v[112:127]
  ds_read_b64_tr_b16 v[42:43], v13 offset:16896
  ds_read_b64_tr_b16 v[44:45], v13 offset:17408
  ds_read_b64_tr_b16 v[46:47], v13 offset:17920
  v_mfma_f32_32x32x16_bf16 v[128:143], v[64:67], v[76:79], v[128:143]
  ds_read_b128 v[48:51], v10 offset:32768
  ds_read_b128 v[52:55], v10 offset:36864
  ds_read_b64_tr_b16 v[56:57], v13 offset:20480
  v_mfma_f32_32x32x16_bf16 v[144:159], v[68:71], v[76:79], v[144:159]
  ds_read_b64_tr_b16 v[58:59], v13 offset:20992
  ds_read_b64_tr_b16 v[60:61], v13 offset:21504
  ds_read_b64_tr_b16 v[62:63], v13 offset:22016
  v_mfma_f32_32x32x16_bf16 v[96:111], v[88:91], v[80:83], v[96:111]
  v_mfma_f32_32x32x16_bf16 v[112:127], v[88:91], v[84:87], v[112:127]
  v_mfma_f32_32x32x16_bf16 v[128:143], v[80:83], v[92:95], v[128:143]
  v_mfma_f32_32x32x16_bf16 v[144:159], v[84:87], v[92:95], v[144:159]
  s_waitcnt vmcnt(22)
  s_waitcnt lgkmcnt(0)
  s_barrier
  v_mfma_f32_32x32x16_bf16 v[96:111], v[40:43], v[32:35], v[96:111]
  s_add_u32 m0, s64, 16384
  s_add_u32 s66, s93, 516096
  buffer_load_dwordx4 v2, s[28:31], s66 offen lds
  buffer_load_dwordx4 v4, s[28:31], s66 offen offset:1024 lds
  s_waitcnt vmcnt(8)
  v_lshl_or_b32 v208, v217, 16, v216
  v_lshl_or_b32 v209, v219, 16, v218
  v_lshl_or_b32 v210, v221, 16, v220
  v_lshl_or_b32 v211, v223, 16, v222
  v_lshl_or_b32 v212, v225, 16, v224
  v_lshl_or_b32 v213, v227, 16, v226
  v_lshl_or_b32 v214, v229, 16, v228
  v_lshl_or_b32 v215, v231, 16, v230
  ds_read_b128 v[64:67], v11 offset:32768
  ds_read_b128 v[68:71], v11 offset:36864
  ds_read_b64_tr_b16 v[72:73], v13 offset:24576
  v_mfma_f32_32x32x16_bf16 v[112:127], v[40:43], v[36:39], v[112:127]
  ds_read_b64_tr_b16 v[74:75], v13 offset:25088
  ds_read_b64_tr_b16 v[76:77], v13 offset:25600
  ds_read_b64_tr_b16 v[78:79], v13 offset:26112
  v_mfma_f32_32x32x16_bf16 v[128:143], v[32:35], v[44:47], v[128:143]
  ds_read_b128 v[80:83], v12 offset:32768
  ds_read_b128 v[84:87], v12 offset:36864
  ds_read_b64_tr_b16 v[88:89], v13 offset:28672
  v_mfma_f32_32x32x16_bf16 v[144:159], v[36:39], v[44:47], v[144:159]
  ds_read_b64_tr_b16 v[90:91], v13 offset:29184
  ds_read_b64_tr_b16 v[92:93], v13 offset:29696
  ds_read_b64_tr_b16 v[94:95], v13 offset:30208
  v_mfma_f32_32x32x16_bf16 v[96:111], v[56:59], v[48:51], v[96:111]
  v_mfma_f32_32x32x16_bf16 v[112:127], v[56:59], v[52:55], v[112:127]
  v_mfma_f32_32x32x16_bf16 v[128:143], v[48:51], v[60:63], v[128:143]
  v_mfma_f32_32x32x16_bf16 v[144:159], v[52:55], v[60:63], v[144:159]
  s_waitcnt lgkmcnt(6)
  v_mfma_f32_32x32x16_bf16 v[96:111], v[72:75], v[64:67], v[96:111]
  v_mfma_f32_32x32x16_bf16 v[112:127], v[72:75], v[68:71], v[112:127]
  v_mfma_f32_32x32x16_bf16 v[128:143], v[64:67], v[76:79], v[128:143]
  v_mfma_f32_32x32x16_bf16 v[144:159], v[68:71], v[76:79], v[144:159]
  s_waitcnt lgkmcnt(0)
  s_barrier
  v_mfma_f32_32x32x16_bf16 v[96:111], v[88:91], v[80:83], v[96:111]
  s_add_u32 m0, s64, 24576
  s_add_u32 s66, s93, 688128
  buffer_load_dwordx4 v2, s[28:31], s66 offen lds
  buffer_load_dwordx4 v4, s[28:31], s66 offen offset:1024 lds
  v_mfma_f32_32x32x16_bf16 v[112:127], v[88:91], v[84:87], v[112:127]
  v_mfma_f32_32x32x16_bf16 v[128:143], v[80:83], v[92:95], v[128:143]
  v_mfma_f32_32x32x16_bf16 v[144:159], v[84:87], v[92:95], v[144:159]
  s_nop 7
  s_cmp_eq_u32 s52, 0
  s_cbranch_scc0 L_roleA
  s_waitcnt vmcnt(8)
  s_waitcnt lgkmcnt(0)
  s_barrier
  ds_read_b128 a[0:3], v5 offset:0
  ds_read_b128 a[4:7], v5 offset:4096
  ds_read_b64_tr_b16 a[8:9], v14 offset:32768
  ds_read_b64_tr_b16 a[10:11], v14 offset:33280
  ds_read_b128 a[12:15], v6 offset:0
  ds_read_b128 a[16:19], v6 offset:4096
  ds_read_b64_tr_b16 a[20:21], v14 offset:34816
  ds_read_b64_tr_b16 a[22:23], v14 offset:35328
  ds_read_b128 a[24:27], v7 offset:0
  ds_read_b128 a[28:31], v7 offset:4096
  ds_read_b64_tr_b16 a[32:33], v14 offset:36864
  ds_read_b64_tr_b16 a[34:35], v14 offset:37376
  ds_read_b128 a[36:39], v8 offset:0
  ds_read_b128 a[40:43], v8 offset:4096
  ds_read_b64_tr_b16 a[44:45], v14 offset:38912
  ds_read_b64_tr_b16 a[46:47], v14 offset:39424
  v_cvt_pk_bf16_f32 v96, v96, v97
  v_cvt_pk_bf16_f32 v97, v98, v99
  v_cvt_pk_bf16_f32 v98, v100, v101
  v_cvt_pk_bf16_f32 v99, v102, v103
  v_cvt_pk_bf16_f32 v100, v104, v105
  v_cvt_pk_bf16_f32 v101, v106, v107
  v_cvt_pk_bf16_f32 v102, v108, v109
  v_cvt_pk_bf16_f32 v103, v110, v111
  v_cvt_pk_bf16_f32 v128, v128, v129
  v_cvt_pk_bf16_f32 v129, v130, v131
  v_cvt_pk_bf16_f32 v130, v132, v133
  v_cvt_pk_bf16_f32 v131, v134, v135
  v_cvt_pk_bf16_f32 v132, v136, v137
  v_cvt_pk_bf16_f32 v133, v138, v139
  v_cvt_pk_bf16_f32 v134, v140, v141
  v_cvt_pk_bf16_f32 v135, v142, v143
  v_cvt_pk_bf16_f32 v112, v112, v113
  v_cvt_pk_bf16_f32 v113, v114, v115
  v_cvt_pk_bf16_f32 v114, v116, v117
  v_cvt_pk_bf16_f32 v115, v118, v119
  v_cvt_pk_bf16_f32 v116, v120, v121
  v_cvt_pk_bf16_f32 v117, v122, v123
  v_cvt_pk_bf16_f32 v118, v124, v125
  v_cvt_pk_bf16_f32 v119, v126, v127
  s_waitcnt vmcnt(6)
  s_barrier
  s_waitcnt lgkmcnt(12)
  v_mfma_f32_32x32x16_bf16 v[160:175], a[8:11], a[0:3], 0
  ds_read_b128 a[48:51], v5 offset:16384
  ds_read_b128 a[52:55], v5 offset:20480
  v_cvt_pk_bf16_f32 v144, v144, v145
  v_cvt_pk_bf16_f32 v145, v146, v147
  v_cvt_pk_bf16_f32 v146, v148, v149
  v_cvt_pk_bf16_f32 v147, v150, v151
  v_cvt_pk_bf16_f32 v148, v152, v153
  v_cvt_pk_bf16_f32 v149, v154, v155
  v_mfma_f32_32x32x16_bf16 v[176:191], a[8:11], a[4:7], 0
  ds_read_b64_tr_b16 a[56:57], v14 offset:0
  ds_read_b64_tr_b16 a[58:59], v14 offset:512
  v_cvt_pk_bf16_f32 v150, v156, v157
  v_cvt_pk_bf16_f32 v151, v158, v159
  s_mov_b32 exec_lo, 0
  v_mov_b32 v102, 0x3f80
  v_mov_b32 v103, 0
  v_mov_b32 v118, 0x3f80
  v_mov_b32 v119, 0
  s_mov_b32 exec_lo, 0x10000000
  s_mov_b32 exec_hi, 0x10000000
  v_mov_b32 v128, 0x3f803f80
  v_mov_b32 v129, 0x3f803f80
  v_mov_b32 v130, 0x3f803f80
  v_mov_b32 v131, 0x3f803f80
  v_mov_b32 v132, 0x3f803f80
  v_mov_b32 v133, 0x3f803f80
  v_mov_b32 v134, 0x3f803f80
  v_mov_b32 v135, 0x3f803f80
  v_mov_b32 v144, 0x3f803f80
  v_mov_b32 v145, 0x3f803f80
  v_mov_b32 v146, 0x3f803f80
  v_mov_b32 v147, 0x3f803f80
  v_mov_b32 v148, 0x3f803f80
  v_mov_b32 v149, 0x3f803f80
  v_mov_b32 v150, 0x3f803f80
  v_mov_b32 v151, 0x3f803f80
  s_mov_b64 exec, -1
  s_waitcnt lgkmcnt(12)
  v_mfma_f32_32x32x16_bf16 v[160:175], a[20:23], a[12:15], v[160:175]
  ds_read_b128 a[60:63], v6 offset:16384
  ds_read_b128 a[64:67], v6 offset:20480
  v_mfma_f32_32x32x16_bf16 v[176:191], a[20:23], a[16:19], v[176:191]
  ds_read_b64_tr_b16 a[68:69], v14 offset:2048
  ds_read_b64_tr_b16 a[70:71], v14 offset:2560
  s_waitcnt lgkmcnt(12)
  v_mfma_f32_32x32x16_bf16 v[160:175], a[32:35], a[24:27], v[160:175]
  ds_read_b128 a[72:75], v7 offset:16384
  ds_read_b128 a[76:79], v7 offset:20480
  v_mfma_f32_32x32x16_bf16 v[176:191], a[32:35], a[28:31], v[176:191]
  ds_read_b64_tr_b16 a[80:81], v14 offset:4096
  ds_read_b64_tr_b16 a[82:83], v14 offset:4608
  s_waitcnt lgkmcnt(12)
  v_mfma_f32_32x32x16_bf16 v[160:175], a[44:47], a[36:39], v[160:175]
  ds_read_b128 a[84:87], v8 offset:16384
  ds_read_b128 a[88:91], v8 offset:20480
  v_mfma_f32_32x32x16_bf16 v[176:191], a[44:47], a[40:43], v[176:191]
  ds_read_b64_tr_b16 a[92:93], v14 offset:6144
  ds_read_b64_tr_b16 a[94:95], v14 offset:6656
  s_waitcnt vmcnt(4)
  s_barrier
  s_waitcnt lgkmcnt(12)
  v_mfma_f32_32x32x16_bf16 v[160:175], a[56:59], a[48:51], v[160:175]
  s_add_u32 m0, s64, 32768
  s_add_u32 s66, s93, 860160
  buffer_load_dwordx4 v2, s[28:31], s66 offen lds
  buffer_load_dwordx4 v4, s[28:31], s66 offen offset:1024 lds
  ds_read_b128 a[0:3], v5 offset:32768
  ds_read_b128 a[4:7], v5 offset:36864
  v_mfma_f32_32x32x16_bf16 v[176:191], a[56:59], a[52:55], v[176:191]
  ds_read_b64_tr_b16 a[8:9], v14 offset:8192
  ds_read_b64_tr_b16 a[10:11], v14 offset:8704
  s_waitcnt lgkmcnt(12)
  v_mfma_f32_32x32x16_bf16 v[160:175], a[68:71], a[60:63], v[160:175]
  ds_read_b128 a[12:15], v6 offset:32768
  ds_read_b128 a[16:19], v6 offset:36864
  v_mfma_f32_32x32x16_bf16 v[176:191], a[68:71], a[64:67], v[176:191]
  ds_read_b64_tr_b16 a[20:21], v14 offset:10240
  ds_read_b64_tr_b16 a[22:23], v14 offset:10752
  s_waitcnt lgkmcnt(12)
  v_mfma_f32_32x32x16_bf16 v[160:175], a[80:83], a[72:75], v[160:175]
  ds_read_b128 a[24:27], v7 offset:32768
  ds_read_b128 a[28:31], v7 offset:36864
  v_mfma_f32_32x32x16_bf16 v[176:191], a[80:83], a[76:79], v[176:191]
  ds_read_b64_tr_b16 a[32:33], v14 offset:12288
  ds_read_b64_tr_b16 a[34:35], v14 offset:12800
  s_waitcnt lgkmcnt(12)
  v_mfma_f32_32x32x16_bf16 v[160:175], a[92:95], a[84:87], v[160:175]
  ds_read_b128 a[36:39], v8 offset:32768
  ds_read_b128 a[40:43], v8 offset:36864
  v_mfma_f32_32x32x16_bf16 v[176:191], a[92:95], a[88:91], v[176:191]
  ds_read_b64_tr_b16 a[44:45], v14 offset:14336
  ds_read_b64_tr_b16 a[46:47], v14 offset:14848
  s_waitcnt vmcnt(4)
  s_barrier
  s_waitcnt lgkmcnt(12)
  v_mfma_f32_32x32x16_bf16 v[160:175], a[8:11], a[0:3], v[160:175]
  s_add_u32 m0, s64, 0
  s_add_u32 s66, s93, 1032192
  buffer_load_dwordx4 v2, s[28:31], s66 offen lds
  buffer_load_dwordx4 v4, s[28:31], s66 offen offset:1024 lds
  ds_read_b128 a[48:51], v5 offset:49152
  ds_read_b128 a[52:55], v5 offset:53248
  s_lshl_b32 s72, s54, 2
  s_lshl_b32 s73, s59, 1
  s_add_u32 s72, s72, s73
  s_lshl_b32 s73, s92, 6
  s_add_u32 s72, s72, s73
  s_lshl_b32 s74, s72, 12
  s_add_u32 s74, s74, 1048576
  s_add_u32 s75, s74, 4096
  v_mfma_f32_32x32x16_bf16 v[176:191], a[8:11], a[4:7], v[176:191]
  ds_read_b64_tr_b16 a[56:57], v14 offset:16384
  ds_read_b64_tr_b16 a[58:59], v14 offset:16896
  buffer_store_dwordx4 v[96:99], v1, s[40:43], s74 offen offset:0 sc1
  s_waitcnt lgkmcnt(12)
  v_mfma_f32_32x32x16_bf16 v[160:175], a[20:23], a[12:15], v[160:175]
  ds_read_b128 a[60:63], v6 offset:49152
  ds_read_b128 a[64:67], v6 offset:53248
  v_mfma_f32_32x32x16_bf16 v[176:191], a[20:23], a[16:19], v[176:191]
  ds_read_b64_tr_b16 a[68:69], v14 offset:18432
  ds_read_b64_tr_b16 a[70:71], v14 offset:18944
  s_waitcnt lgkmcnt(12)
  v_mfma_f32_32x32x16_bf16 v[160:175], a[32:35], a[24:27], v[160:175]
  ds_read_b128 a[72:75], v7 offset:49152
  ds_read_b128 a[76:79], v7 offset:53248
  v_mfma_f32_32x32x16_bf16 v[176:191], a[32:35], a[28:31], v[176:191]
  ds_read_b64_tr_b16 a[80:81], v14 offset:20480
  ds_read_b64_tr_b16 a[82:83], v14 offset:20992
  buffer_store_dwordx4 v[100:103], v1, s[40:43], s74 offen offset:1024 sc1
  s_waitcnt lgkmcnt(12)
  v_mfma_f32_32x32x16_bf16 v[160:175], a[44:47], a[36:39], v[160:175]
  ds_read_b128 a[84:87], v8 offset:49152
  ds_read_b128 a[88:91], v8 offset:53248
  v_mfma_f32_32x32x16_bf16 v[176:191], a[44:47], a[40:43], v[176:191]
  ds_read_b64_tr_b16 a[92:93], v14 offset:22528
  ds_read_b64_tr_b16 a[94:95], v14 offset:23040
  s_waitcnt vmcnt(6)
  s_barrier
  s_waitcnt lgkmcnt(12)
  v_mfma_f32_32x32x16_bf16 v[160:175], a[56:59], a[48:51], v[160:175]
  ds_read_b128 a[0:3], v9 offset:0
  ds_read_b128 a[4:7], v9 offset:4096
  v_mfma_f32_32x32x16_bf16 v[176:191], a[56:59], a[52:55], v[176:191]
  ds_read_b64_tr_b16 a[8:9], v14 offset:24576
  ds_read_b64_tr_b16 a[10:11], v14 offset:25088
  buffer_store_dwordx4 v[128:131], v1, s[40:43], s74 offen offset:2048 sc1
  s_waitcnt lgkmcnt(12)
  v_mfma_f32_32x32x16_bf16 v[160:175], a[68:71], a[60:63], v[160:175]
  ds_read_b128 a[12:15], v10 offset:0
  ds_read_b128 a[16:19], v10 offset:4096
  v_mfma_f32_32x32x16_bf16 v[176:191], a[68:71], a[64:67], v[176:191]
  ds_read_b64_tr_b16 a[20:21], v14 offset:26624
  ds_read_b64_tr_b16 a[22:23], v14 offset:27136
  s_waitcnt lgkmcnt(12)
  v_mfma_f32_32x32x16_bf16 v[160:175], a[80:83], a[72:75], v[160:175]
  ds_read_b128 a[24:27], v11 offset:0
  ds_read_b128 a[28:31], v11 offset:4096
  v_mfma_f32_32x32x16_bf16 v[176:191], a[80:83], a[76:79], v[176:191]
  ds_read_b64_tr_b16 a[32:33], v14 offset:28672
  ds_read_b64_tr_b16 a[34:35], v14 offset:29184
  buffer_store_dwordx4 v[132:135], v1, s[40:43], s74 offen offset:3072 sc1
  s_waitcnt lgkmcnt(12)
  v_mfma_f32_32x32x16_bf16 v[160:175], a[92:95], a[84:87], v[160:175]
  ds_read_b128 a[36:39], v12 offset:0
  ds_read_b128 a[40:43], v12 offset:4096
  v_mfma_f32_32x32x16_bf16 v[176:191], a[92:95], a[88:91], v[176:191]
  ds_read_b64_tr_b16 a[44:45], v14 offset:30720
  ds_read_b64_tr_b16 a[46:47], v14 offset:31232
  s_waitcnt vmcnt(6)
  s_barrier
  s_waitcnt lgkmcnt(12)
  v_mfma_f32_32x32x16_bf16 v[160:175], a[8:11], a[0:3], v[160:175]
  ds_read_b128 a[48:51], v9 offset:16384
  ds_read_b128 a[52:55], v9 offset:20480
  v_mfma_f32_32x32x16_bf16 v[176:191], a[8:11], a[4:7], v[176:191]
  ds_read_b64_tr_b16 a[56:57], v14 offset:32768
  ds_read_b64_tr_b16 a[58:59], v14 offset:33280
  buffer_store_dwordx4 v[112:115], v1, s[40:43], s75 offen offset:0 sc1
  s_waitcnt lgkmcnt(12)
  v_mfma_f32_32x32x16_bf16 v[160:175], a[20:23], a[12:15], v[160:175]
  ds_read_b128 a[60:63], v10 offset:16384
  ds_read_b128 a[64:67], v10 offset:20480
  v_mfma_f32_32x32x16_bf16 v[176:191], a[20:23], a[16:19], v[176:191]
  ds_read_b64_tr_b16 a[68:69], v14 offset:34816
  ds_read_b64_tr_b16 a[70:71], v14 offset:35328
  s_waitcnt lgkmcnt(12)
  v_mfma_f32_32x32x16_bf16 v[160:175], a[32:35], a[24:27], v[160:175]
  ds_read_b128 a[72:75], v11 offset:16384
  ds_read_b128 a[76:79], v11 offset:20480
  v_mfma_f32_32x32x16_bf16 v[176:191], a[32:35], a[28:31], v[176:191]
  ds_read_b64_tr_b16 a[80:81], v14 offset:36864
  ds_read_b64_tr_b16 a[82:83], v14 offset:37376
  buffer_store_dwordx4 v[116:119], v1, s[40:43], s75 offen offset:1024 sc1
  s_waitcnt lgkmcnt(12)
  v_mfma_f32_32x32x16_bf16 v[160:175], a[44:47], a[36:39], v[160:175]
  ds_read_b128 a[84:87], v12 offset:16384
  ds_read_b128 a[88:91], v12 offset:20480
  v_mfma_f32_32x32x16_bf16 v[176:191], a[44:47], a[40:43], v[176:191]
  ds_read_b64_tr_b16 a[92:93], v14 offset:38912
  ds_read_b64_tr_b16 a[94:95], v14 offset:39424
  s_waitcnt vmcnt(6)
  s_barrier
  s_waitcnt lgkmcnt(12)
  v_mfma_f32_32x32x16_bf16 v[160:175], a[56:59], a[48:51], v[160:175]
  ds_read_b128 a[0:3], v9 offset:32768
  ds_read_b128 a[4:7], v9 offset:36864
  v_mfma_f32_32x32x16_bf16 v[176:191], a[56:59], a[52:55], v[176:191]
  ds_read_b64_tr_b16 a[8:9], v14 offset:0
  ds_read_b64_tr_b16 a[10:11], v14 offset:512
  buffer_store_dwordx4 v[144:147], v1, s[40:43], s75 offen offset:2048 sc1
  s_waitcnt lgkmcnt(12)
  v_mfma_f32_32x32x16_bf16 v[160:175], a[68:71], a[60:63], v[160:175]
  ds_read_b128 a[12:15], v10 offset:32768
  ds_read_b128 a[16:19], v10 offset:36864
  v_mfma_f32_32x32x16_bf16 v[176:191], a[68:71], a[64:67], v[176:191]
  ds_read_b64_tr_b16 a[20:21], v14 offset:2048
  ds_read_b64_tr_b16 a[22:23], v14 offset:2560
  s_waitcnt lgkmcnt(12)
  v_mfma_f32_32x32x16_bf16 v[160:175], a[80:83], a[72:75], v[160:175]
  ds_read_b128 a[24:27], v11 offset:32768
  ds_read_b128 a[28:31], v11 offset:36864
  v_mfma_f32_32x32x16_bf16 v[176:191], a[80:83], a[76:79], v[176:191]
  ds_read_b64_tr_b16 a[32:33], v14 offset:4096
  ds_read_b64_tr_b16 a[34:35], v14 offset:4608
  buffer_store_dwordx4 v[148:151], v1, s[40:43], s75 offen offset:3072 sc1
  s_waitcnt lgkmcnt(12)
  v_mfma_f32_32x32x16_bf16 v[160:175], a[92:95], a[84:87], v[160:175]
  ds_read_b128 a[36:39], v12 offset:32768
  ds_read_b128 a[40:43], v12 offset:36864
  v_mfma_f32_32x32x16_bf16 v[176:191], a[92:95], a[88:91], v[176:191]
  ds_read_b64_tr_b16 a[44:45], v14 offset:6144
  ds_read_b64_tr_b16 a[46:47], v14 offset:6656
  s_waitcnt lgkmcnt(12)
  v_mfma_f32_32x32x16_bf16 v[160:175], a[8:11], a[0:3], v[160:175]
  v_mfma_f32_32x32x16_bf16 v[176:191], a[8:11], a[4:7], v[176:191]
  s_waitcnt lgkmcnt(8)
  v_mfma_f32_32x32x16_bf16 v[160:175], a[20:23], a[12:15], v[160:175]
  v_mfma_f32_32x32x16_bf16 v[176:191], a[20:23], a[16:19], v[176:191]
  s_waitcnt lgkmcnt(4)
  v_mfma_f32_32x32x16_bf16 v[160:175], a[32:35], a[24:27], v[160:175]
  v_mfma_f32_32x32x16_bf16 v[176:191], a[32:35], a[28:31], v[176:191]
  s_waitcnt lgkmcnt(0)
  v_mfma_f32_32x32x16_bf16 v[160:175], a[44:47], a[36:39], v[160:175]
  v_mfma_f32_32x32x16_bf16 v[176:191], a[44:47], a[40:43], v[176:191]
  s_nop 10
  v_pk_mul_f32 v[160:161], v[160:161], s[68:69]
  v_pk_mul_f32 v[162:163], v[162:163], s[68:69]
  v_pk_mul_f32 v[164:165], v[164:165], s[68:69]
  v_pk_mul_f32 v[166:167], v[166:167], s[68:69]
  v_pk_mul_f32 v[168:169], v[168:169], s[68:69]
  v_pk_mul_f32 v[170:171], v[170:171], s[68:69]
  v_pk_mul_f32 v[172:173], v[172:173], s[68:69]
  v_pk_mul_f32 v[174:175], v[174:175], s[68:69]
  v_cvt_pk_bf16_f32 v160, v160, v161
  v_cvt_pk_bf16_f32 v161, v162, v163
  v_cvt_pk_bf16_f32 v162, v164, v165
  v_cvt_pk_bf16_f32 v163, v166, v167
  v_cvt_pk_bf16_f32 v164, v168, v169
  v_cvt_pk_bf16_f32 v165, v170, v171
  v_cvt_pk_bf16_f32 v166, v172, v173
  v_cvt_pk_bf16_f32 v167, v174, v175
  v_pk_mul_f32 v[176:177], v[176:177], s[68:69]
  v_pk_mul_f32 v[178:179], v[178:179], s[68:69]
  v_pk_mul_f32 v[180:181], v[180:181], s[68:69]
  v_pk_mul_f32 v[182:183], v[182:183], s[68:69]
  v_pk_mul_f32 v[184:185], v[184:185], s[68:69]
  v_pk_mul_f32 v[186:187], v[186:187], s[68:69]
  v_pk_mul_f32 v[188:189], v[188:189], s[68:69]
  v_pk_mul_f32 v[190:191], v[190:191], s[68:69]
  v_cvt_pk_bf16_f32 v176, v176, v177
  v_cvt_pk_bf16_f32 v177, v178, v179
  v_cvt_pk_bf16_f32 v178, v180, v181
  v_cvt_pk_bf16_f32 v179, v182, v183
  v_cvt_pk_bf16_f32 v180, v184, v185
  v_cvt_pk_bf16_f32 v181, v186, v187
  v_cvt_pk_bf16_f32 v182, v188, v189
  v_cvt_pk_bf16_f32 v183, v190, v191
  s_mov_b32 exec_lo, 0
  v_mov_b32 v166, 0
  v_mov_b32 v167, 0
  v_mov_b32 v182, 0
  v_mov_b32 v183, 0
  s_mov_b32 exec_lo, -1
  s_lshl_b32 s72, s54, 2
  s_lshl_b32 s73, s59, 1
  s_add_u32 s72, s72, s73
  s_lshl_b32 s73, s92, 6
  s_add_u32 s72, s72, s73
  s_lshl_b32 s76, s72, 11
  s_add_u32 s76, s76, 12582912
  v_mfma_f32_32x32x16_bf16 v[32:47], v[96:99], v[160:163], 0
  v_mfma_f32_32x32x16_bf16 v[32:47], v[100:103], v[164:167], v[32:47]
  v_mfma_f32_32x32x16_bf16 v[48:63], v[112:115], v[176:179], 0
  v_mfma_f32_32x32x16_bf16 v[48:63], v[116:119], v[180:183], v[48:63]
  buffer_store_dwordx4 v[160:163], v1, s[40:43], s76 offen offset:0 sc1
  buffer_store_dwordx4 v[176:179], v1, s[40:43], s76 offen offset:2048 sc1
  s_nop 7
  v_max3_f32 v16, v32, v33, v34
  v_max3_f32 v16, v16, v35, v36
  v_max3_f32 v16, v16, v37, v38
  v_max3_f32 v16, v16, v39, v40
  v_max3_f32 v16, v16, v41, v42
  v_max3_f32 v16, v16, v43, v44
  v_max3_f32 v16, v16, v45, v46
  v_max_f32 v16, v16, v47
  v_max3_f32 v18, v48, v49, v50
  v_max3_f32 v18, v18, v51, v52
  v_max3_f32 v18, v18, v53, v54
  v_max3_f32 v18, v18, v55, v56
  v_max3_f32 v18, v18, v57, v58
  v_max3_f32 v18, v18, v59, v60
  v_max3_f32 v18, v18, v61, v62
  v_max_f32 v18, v18, v63
  v_mov_b32 v17, v16
  v_mov_b32 v19, v18
  s_nop 0
  v_permlane32_swap_b32 v16, v17
  v_permlane32_swap_b32 v18, v19
  v_max_f32 v16, v16, v17
  v_max_f32 v18, v18, v19
  v_sub_f32 v16, 0xc2800000, v16
  v_sub_f32 v18, 0xc2800000, v18
  s_mov_b32 exec_lo, 0
  v_cvt_pk_bf16_f32 v166, v16, 0
  v_cvt_pk_bf16_f32 v182, v18, 0
  s_mov_b32 exec_lo, -1
  buffer_store_dwordx4 v[164:167], v1, s[40:43], s76 offen offset:1024 sc1
  buffer_store_dwordx4 v[180:183], v1, s[40:43], s76 offen offset:3072 sc1
  s_waitcnt vmcnt(0)
  s_barrier
  s_cmp_lg_u32 s55, 0
  s_cbranch_scc1 L_sig1_7
  s_lshl_b32 s72, s53, 7
  s_lshl_b32 s73, s54, 2
  s_add_u32 s72, s72, s73
  s_add_u32 s72, s72, 8192
  v_mov_b32 v22, s72
  v_mov_b32 v23, s56
  s_mov_b64 exec, 1
  buffer_store_dword v23, v22, s[40:43], 0 offen sc1
  s_mov_b64 exec, -1
L_sig1_7:
  s_lshl_b32 s72, s53, 4
  s_add_u32 s72, s72, s54
  s_lshl_b32 s72, s72, 2
  s_add_u32 s72, s72, s55
  s_lshr_b32 s73, s72, 8
  s_cmp_eq_u32 s73, 0
  s_cselect_b32 s36, s10, s16
  s_cselect_b32 s37, s11, s17
  s_and_b32 s37, s37, 0xffff
  s_mov_b32 s38, 401408
  s_mov_b32 s39, 0x20000
  s_bfe_u32 s73, s72, 0x40004
  s_and_b32 s74, s72, 15
  s_mul_i32 s74, s74, 25088
  s_mul_i32 s73, s73, 56
  s_add_u32 s74, s74, s73
  v_and_b32 v16, 31, v0
  v_lshrrev_b32 v17, 5, v0
  v_mul_u32_u24 v18, 3584, v17
  v_lshl_add_u32 v18, v16, 1, v18
  v_lshlrev_b32 v21, 30, v17
  v_add_u32 v21, v21, v18
  s_add_u32 s75, s74, 0
  buffer_load_ushort v32, v18, s[36:39], s75 offen offset:0
  buffer_load_ushort v33, v18, s[36:39], s75 offen offset:896
  buffer_load_ushort v34, v18, s[36:39], s75 offen offset:1792
  buffer_load_ushort v35, v18, s[36:39], s75 offen offset:2688
  s_add_u32 s75, s74, 7168
  buffer_load_ushort v36, v18, s[36:39], s75 offen offset:0
  buffer_load_ushort v37, v18, s[36:39], s75 offen offset:896
  buffer_load_ushort v38, v18, s[36:39], s75 offen offset:1792
  buffer_load_ushort v39, v18, s[36:39], s75 offen offset:2688
  s_add_u32 s75, s74, 14336
  buffer_load_ushort v40, v18, s[36:39], s75 offen offset:0
  buffer_load_ushort v41, v18, s[36:39], s75 offen offset:896
  buffer_load_ushort v42, v18, s[36:39], s75 offen offset:1792
  buffer_load_ushort v43, v18, s[36:39], s75 offen offset:2688
  s_add_u32 s75, s74, 21504
  buffer_load_ushort v44, v21, s[36:39], s75 offen offset:0
  buffer_load_ushort v45, v21, s[36:39], s75 offen offset:896
  buffer_load_ushort v46, v21, s[36:39], s75 offen offset:1792
  buffer_load_ushort v47, v21, s[36:39], s75 offen offset:2688
  s_waitcnt vmcnt(0)
  v_lshl_or_b32 v84, v33, 16, v32
  v_lshl_or_b32 v85, v35, 16, v34
  v_lshl_or_b32 v86, v37, 16, v36
  v_lshl_or_b32 v87, v39, 16, v38
  v_lshl_or_b32 v88, v41, 16, v40
  v_lshl_or_b32 v89, v43, 16, v42
  v_lshl_or_b32 v90, v45, 16, v44
  v_lshl_or_b32 v91, v47, 16, v46
  v_mov_b32 v92, -1
  v_mov_b32 v93, -1
  v_mov_b32 v94, -1
  v_mov_b32 v95, -1
  s_lshl_b32 s34, s72, 13
  s_add_u32 s34, s34, 7340032
  s_lshl_b32 s35, s72, 11
  s_add_u32 s35, s35, 11534336
  s_lshr_b32 s82, s57, 1
  s_lshl_b32 s82, s82, 7
  s_add_u32 s82, s82, 8192
  v_and_b32 v19, 15, v0
  v_lshlrev_b32 v19, 2, v19
  buffer_load_dword v20, v19, s[40:43], s82 offen sc1
  s_waitcnt lgkmcnt(0)
  s_barrier
  s_waitcnt vmcnt(0)
  v_cmp_ne_u32 vcc, s56, v20
  s_nop 1
  s_cbranch_vccnz L_spin_f1_9
L_back_f1_8:
  s_lshl_b32 s80, s57, 18
  s_lshl_b32 s72, s55, 16
  s_add_u32 s80, s80, s72
  s_add_u32 s80, s80, 1048576
  s_lshl_b32 s72, s57, 6
  s_lshl_b32 s73, s58, 2
  s_add_u32 s72, s72, s73
  s_lshl_b32 s72, s72, 11
  s_add_u32 s72, s72, 12582912
  s_add_u32 s73, s55, 1
  s_and_b32 s73, s73, 3
  s_lshl_b32 s73, s73, 11
  s_add_u32 s83, s72, s73
  s_add_u32 s73, s55, 2
  s_and_b32 s73, s73, 3
  s_lshl_b32 s73, s73, 11
  s_add_u32 s84, s72, s73
  s_add_u32 s73, s55, 3
  s_and_b32 s73, s73, 3
  s_lshl_b32 s73, s73, 11
  s_add_u32 s85, s72, s73
  s_add_u32 s73, s55, 4
  s_and_b32 s73, s73, 3
  s_lshl_b32 s73, s73, 11
  s_add_u32 s86, s72, s73
  s_add_u32 s65, s80, 0
  buffer_load_dwordx4 a[0:3], v1, s[40:43], s65 offen offset:0 sc1
  buffer_load_dwordx4 a[4:7], v1, s[40:43], s65 offen offset:1024 sc1
  buffer_load_dwordx4 v[160:163], v1, s[40:43], s83 offen offset:0 sc1
  buffer_load_dwordx4 v[164:167], v1, s[40:43], s83 offen offset:1024 sc1
  buffer_load_dwordx4 v[168:171], v1, s[40:43], s84 offen offset:0 sc1
  buffer_load_dwordx4 v[172:175], v1, s[40:43], s84 offen offset:1024 sc1
  s_add_u32 s65, s80, 0
  buffer_load_dwordx4 a[8:11], v1, s[40:43], s65 offen offset:2048 sc1
  buffer_load_dwordx4 a[12:15], v1, s[40:43], s65 offen offset:3072 sc1
  buffer_load_dwordx4 v[176:179], v1, s[40:43], s85 offen offset:0 sc1
  buffer_load_dwordx4 v[180:183], v1, s[40:43], s85 offen offset:1024 sc1
  buffer_load_dwordx4 v[184:187], v1, s[40:43], s86 offen offset:0 sc1
  buffer_load_dwordx4 v[188:191], v1, s[40:43], s86 offen offset:1024 sc1
  s_add_u32 s65, s80, 4096
  buffer_load_dwordx4 a[16:19], v1, s[40:43], s65 offen offset:0 sc1
  buffer_load_dwordx4 a[20:23], v1, s[40:43], s65 offen offset:1024 sc1
  buffer_load_dwordx4 a[24:27], v1, s[40:43], s65 offen offset:2048 sc1
  buffer_load_dwordx4 a[28:31], v1, s[40:43], s65 offen offset:3072 sc1
  s_waitcnt vmcnt(12)
  v_mfma_f32_32x32x16_bf16 v[32:47], a[0:3], v[160:163], 0
  v_mfma_f32_32x32x16_bf16 v[32:47], a[4:7], v[164:167], v[32:47]
  s_nop 10
  s_waitcnt vmcnt(10)
  v_mfma_f32_32x32x16_bf16 v[48:63], a[0:3], v[168:171], 0
  v_exp_f32 v32, v32
  v_exp_f32 v33, v33
  v_exp_f32 v34, v34
  v_exp_f32 v35, v35
  v_cvt_pk_bf16_f32 v64, v32, v33
  v_mfma_f32_32x32x16_bf16 v[48:63], a[4:7], v[172:175], v[48:63]
  s_add_u32 s65, s80, 8192
  buffer_load_dwordx4 a[32:35], v1, s[40:43], s65 offen offset:0 sc1
  buffer_load_dwordx4 a[36:39], v1, s[40:43], s65 offen offset:1024 sc1
  buffer_load_dwordx4 a[40:43], v1, s[40:43], s65 offen offset:2048 sc1
  buffer_load_dwordx4 a[44:47], v1, s[40:43], s65 offen offset:3072 sc1
  v_exp_f32 v36, v36
  v_exp_f32 v37, v37
  v_cvt_pk_bf16_f32 v65, v34, v35
  v_exp_f32 v38, v38
  v_exp_f32 v39, v39
  v_cvt_pk_bf16_f32 v66, v36, v37
  v_exp_f32 v40, v40
  v_exp_f32 v41, v41
  v_cvt_pk_bf16_f32 v67, v38, v39
  v_exp_f32 v42, v42
  v_exp_f32 v43, v43
  v_cvt_pk_bf16_f32 v68, v40, v41
  v_exp_f32 v44, v44
  v_exp_f32 v45, v45
  v_cvt_pk_bf16_f32 v69, v42, v43
  v_exp_f32 v46, v46
  v_exp_f32 v47, v47
  v_cvt_pk_bf16_f32 v70, v44, v45
  v_cvt_pk_bf16_f32 v71, v46, v47
  s_waitcnt vmcnt(10)
  v_mfma_f32_32x32x16_bf16 v[32:47], a[0:3], v[176:179], 0
  buffer_store_dwordx4 v[84:87], v1, s[40:43], s35 offen offset:0 sc1
  buffer_store_dwordx4 v[88:91], v1, s[40:43], s35 offen offset:1024 sc1
  v_exp_f32 v48, v48
  v_exp_f32 v49, v49
  v_exp_f32 v50, v50
  v_exp_f32 v51, v51
  v_cvt_pk_bf16_f32 v72, v48, v49
  v_mfma_f32_32x32x16_bf16 v[32:47], a[4:7], v[180:183], v[32:47]
  s_add_u32 s65, s80, 12288
  buffer_load_dwordx4 a[48:51], v1, s[40:43], s65 offen offset:0 sc1
  buffer_load_dwordx4 a[52:55], v1, s[40:43], s65 offen offset:1024 sc1
  buffer_load_dwordx4 a[56:59], v1, s[40:43], s65 offen offset:2048 sc1
  buffer_load_dwordx4 a[60:63], v1, s[40:43], s65 offen offset:3072 sc1
  v_exp_f32 v52, v52
  v_exp_f32 v53, v53
  v_cvt_pk_bf16_f32 v73, v50, v51
  v_exp_f32 v54, v54
  v_exp_f32 v55, v55
  v_cvt_pk_bf16_f32 v74, v52, v53
  v_mfma_f32_32x32x16_bf16 v[96:111], a[8:11], v[64:67], 0
  v_exp_f32 v56, v56
  v_exp_f32 v57, v57
  v_cvt_pk_bf16_f32 v75, v54, v55
  v_exp_f32 v58, v58
  v_exp_f32 v59, v59
  v_cvt_pk_bf16_f32 v76, v56, v57
  v_mfma_f32_32x32x16_bf16 v[96:111], a[12:15], v[68:71], v[96:111]
  v_exp_f32 v60, v60
  v_exp_f32 v61, v61
  v_cvt_pk_bf16_f32 v77, v58, v59
  v_exp_f32 v62, v62
  v_exp_f32 v63, v63
  v_cvt_pk_bf16_f32 v78, v60, v61
  v_cvt_pk_bf16_f32 v79, v62, v63
  s_waitcnt vmcnt(14)
  v_mfma_f32_32x32x16_bf16 v[48:63], a[0:3], v[184:187], 0
  buffer_store_dwordx4 v[92:95], v1, s[40:43], s34 offen offset:0 sc1
  buffer_store_dwordx4 v[92:95], v1, s[40:43], s34 offen offset:1024 sc1
  v_exp_f32 v32, v32
  v_exp_f32 v33, v33
  v_exp_f32 v34, v34
  v_exp_f32 v35, v35
  v_cvt_pk_bf16_f32 v64, v32, v33
  v_mfma_f32_32x32x16_bf16 v[48:63], a[4:7], v[188:191], v[48:63]
  v_exp_f32 v36, v36
  v_exp_f32 v37, v37
  v_cvt_pk_bf16_f32 v65, v34, v35
  v_exp_f32 v38, v38
  v_exp_f32 v39, v39
  v_cvt_pk_bf16_f32 v66, v36, v37
  v_mfma_f32_32x32x16_bf16 v[112:127], a[8:11], v[72:75], 0
  v_exp_f32 v40, v40
  v_exp_f32 v41, v41
  v_cvt_pk_bf16_f32 v67, v38, v39
  v_exp_f32 v42, v42
  v_exp_f32 v43, v43
  v_cvt_pk_bf16_f32 v68, v40, v41
  v_mfma_f32_32x32x16_bf16 v[112:127], a[12:15], v[76:79], v[112:127]
  v_exp_f32 v44, v44
  v_exp_f32 v45, v45
  v_cvt_pk_bf16_f32 v69, v42, v43
  v_exp_f32 v46, v46
  v_exp_f32 v47, v47
  v_cvt_pk_bf16_f32 v70, v44, v45
  v_cvt_pk_bf16_f32 v71, v46, v47
  s_waitcnt vmcnt(12)
  v_mfma_f32_32x32x16_bf16 v[32:47], a[16:19], v[160:163], 0
  buffer_store_dwordx4 v[92:95], v1, s[40:43], s34 offen offset:2048 sc1
  buffer_store_dwordx4 v[92:95], v1, s[40:43], s34 offen offset:3072 sc1
  v_exp_f32 v48, v48
  v_exp_f32 v49, v49
  v_exp_f32 v50, v50
  v_exp_f32 v51, v51
  v_cvt_pk_bf16_f32 v72, v48, v49
  v_mfma_f32_32x32x16_bf16 v[32:47], a[20:23], v[164:167], v[32:47]
  v_exp_f32 v52, v52
  v_exp_f32 v53, v53
  v_cvt_pk_bf16_f32 v73, v50, v51
  v_exp_f32 v54, v54
  v_exp_f32 v55, v55
  v_cvt_pk_bf16_f32 v74, v52, v53
  v_mfma_f32_32x32x16_bf16 v[128:143], a[8:11], v[64:67], 0
  v_exp_f32 v56, v56
  v_exp_f32 v57, v57
  v_cvt_pk_bf16_f32 v75, v54, v55
  v_exp_f32 v58, v58
  v_exp_f32 v59, v59
  v_cvt_pk_bf16_f32 v76, v56, v57
  v_mfma_f32_32x32x16_bf16 v[128:143], a[12:15], v[68:71], v[128:143]
  v_exp_f32 v60, v60
  v_exp_f32 v61, v61
  v_cvt_pk_bf16_f32 v77, v58, v59
  v_exp_f32 v62, v62
  v_exp_f32 v63, v63
  v_cvt_pk_bf16_f32 v78, v60, v61
  v_cvt_pk_bf16_f32 v79, v62, v63
  v_mfma_f32_32x32x16_bf16 v[48:63], a[16:19], v[168:171], 0
  s_add_u32 s34, s34, 4096
  buffer_store_dwordx4 v[92:95], v1, s[40:43], s34 offen offset:0 sc1
  buffer_store_dwordx4 v[92:95], v1, s[40:43], s34 offen offset:1024 sc1
  v_exp_f32 v32, v32
  v_exp_f32 v33, v33
  v_exp_f32 v34, v34
  v_exp_f32 v35, v35
  v_cvt_pk_bf16_f32 v64, v32, v33
  v_mfma_f32_32x32x16_bf16 v[48:63], a[20:23], v[172:175], v[48:63]
  v_exp_f32 v36, v36
  v_exp_f32 v37, v37
  v_cvt_pk_bf16_f32 v65, v34, v35
  v_exp_f32 v38, v38
  v_exp_f32 v39, v39
  v_cvt_pk_bf16_f32 v66, v36, v37
  v_mfma_f32_32x32x16_bf16 v[144:159], a[8:11], v[72:75], 0
  v_exp_f32 v40, v40
  v_exp_f32 v41, v41
  v_cvt_pk_bf16_f32 v67, v38, v39
  v_exp_f32 v42, v42
  v_exp_f32 v43, v43
  v_cvt_pk_bf16_f32 v68, v40, v41
  v_mfma_f32_32x32x16_bf16 v[144:159], a[12:15], v[76:79], v[144:159]
  v_exp_f32 v44, v44
  v_exp_f32 v45, v45
  v_cvt_pk_bf16_f32 v69, v42, v43
  v_exp_f32 v46, v46
  v_exp_f32 v47, v47
  v_cvt_pk_bf16_f32 v70, v44, v45
  v_cvt_pk_bf16_f32 v71, v46, v47
  v_mfma_f32_32x32x16_bf16 v[32:47], a[16:19], v[176:179], 0
  v_exp_f32 v48, v48
  v_exp_f32 v49, v49
  v_exp_f32 v50, v50
  v_exp_f32 v51, v51
  v_cvt_pk_bf16_f32 v72, v48, v49
  v_mfma_f32_32x32x16_bf16 v[32:47], a[20:23], v[180:183], v[32:47]
  s_add_u32 s65, s80, 16384
  buffer_load_dwordx4 a[0:3], v1, s[40:43], s65 offen offset:0 sc1
  buffer_load_dwordx4 a[4:7], v1, s[40:43], s65 offen offset:1024 sc1
  buffer_load_dwordx4 a[8:11], v1, s[40:43], s65 offen offset:2048 sc1
  buffer_load_dwordx4 a[12:15], v1, s[40:43], s65 offen offset:3072 sc1
  v_exp_f32 v52, v52
  v_exp_f32 v53, v53
  v_cvt_pk_bf16_f32 v73, v50, v51
  v_exp_f32 v54, v54
  v_exp_f32 v55, v55
  v_cvt_pk_bf16_f32 v74, v52, v53
  v_mfma_f32_32x32x16_bf16 v[96:111], a[24:27], v[64:67], v[96:111]
  v_exp_f32 v56, v56
  v_exp_f32 v57, v57
  v_cvt_pk_bf16_f32 v75, v54, v55
  v_exp_f32 v58, v58
  v_exp_f32 v59, v59
  v_cvt_pk_bf16_f32 v76, v56, v57
  v_mfma_f32_32x32x16_bf16 v[96:111], a[28:31], v[68:71], v[96:111]
  v_exp_f32 v60, v60
  v_exp_f32 v61, v61
  v_cvt_pk_bf16_f32 v77, v58, v59
  v_exp_f32 v62, v62
  v_exp_f32 v63, v63
  v_cvt_pk_bf16_f32 v78, v60, v61
  v_cvt_pk_bf16_f32 v79, v62, v63
  v_mfma_f32_32x32x16_bf16 v[48:63], a[16:19], v[184:187], 0
  buffer_store_dwordx4 v[92:95], v1, s[40:43], s34 offen offset:2048 sc1
  buffer_store_dwordx4 v[92:95], v1, s[40:43], s34 offen offset:3072 sc1
  v_exp_f32 v32, v32
  v_exp_f32 v33, v33
  v_exp_f32 v34, v34
  v_exp_f32 v35, v35
  v_cvt_pk_bf16_f32 v64, v32, v33
  v_mfma_f32_32x32x16_bf16 v[48:63], a[20:23], v[188:191], v[48:63]
  v_exp_f32 v36, v36
  v_exp_f32 v37, v37
  v_cvt_pk_bf16_f32 v65, v34, v35
  v_exp_f32 v38, v38
  v_exp_f32 v39, v39
  v_cvt_pk_bf16_f32 v66, v36, v37
  v_mfma_f32_32x32x16_bf16 v[112:127], a[24:27], v[72:75], v[112:127]
  v_exp_f32 v40, v40
  v_exp_f32 v41, v41
  v_cvt_pk_bf16_f32 v67, v38, v39
  v_exp_f32 v42, v42
  v_exp_f32 v43, v43
  v_cvt_pk_bf16_f32 v68, v40, v41
  v_mfma_f32_32x32x16_bf16 v[112:127], a[28:31], v[76:79], v[112:127]
  v_exp_f32 v44, v44
  v_exp_f32 v45, v45
  v_cvt_pk_bf16_f32 v69, v42, v43
  v_exp_f32 v46, v46
  v_exp_f32 v47, v47
  v_cvt_pk_bf16_f32 v70, v44, v45
  v_cvt_pk_bf16_f32 v71, v46, v47
  s_waitcnt vmcnt(18)
  v_mfma_f32_32x32x16_bf16 v[32:47], a[32:35], v[160:163], 0
  v_exp_f32 v48, v48
  v_exp_f32 v49, v49
  v_exp_f32 v50, v50
  v_exp_f32 v51, v51
  v_cvt_pk_bf16_f32 v72, v48, v49
  v_mfma_f32_32x32x16_bf16 v[32:47], a[36:39], v[164:167], v[32:47]
  v_exp_f32 v52, v52
  v_exp_f32 v53, v53
  v_cvt_pk_bf16_f32 v73, v50, v51
  v_exp_f32 v54, v54
  v_exp_f32 v55, v55
  v_cvt_pk_bf16_f32 v74, v52, v53
  v_mfma_f32_32x32x16_bf16 v[128:143], a[24:27], v[64:67], v[128:143]
  v_exp_f32 v56, v56
  v_exp_f32 v57, v57
  v_cvt_pk_bf16_f32 v75, v54, v55
  v_exp_f32 v58, v58
  v_exp_f32 v59, v59
  v_cvt_pk_bf16_f32 v76, v56, v57
  v_mfma_f32_32x32x16_bf16 v[128:143], a[28:31], v[68:71], v[128:143]
  v_exp_f32 v60, v60
  v_exp_f32 v61, v61
  v_cvt_pk_bf16_f32 v77, v58, v59
  v_exp_f32 v62, v62
  v_exp_f32 v63, v63
  v_cvt_pk_bf16_f32 v78, v60, v61
  v_cvt_pk_bf16_f32 v79, v62, v63
  v_mfma_f32_32x32x16_bf16 v[48:63], a[32:35], v[168:171], 0
  v_exp_f32 v32, v32
  v_exp_f32 v33, v33
  v_exp_f32 v34, v34
  v_exp_f32 v35, v35
  v_cvt_pk_bf16_f32 v64, v32, v33
  v_mfma_f32_32x32x16_bf16 v[48:63], a[36:39], v[172:175], v[48:63]
  v_exp_f32 v36, v36
  v_exp_f32 v37, v37
  v_cvt_pk_bf16_f32 v65, v34, v35
  v_exp_f32 v38, v38
  v_exp_f32 v39, v39
  v_cvt_pk_bf16_f32 v66, v36, v37
  v_mfma_f32_32x32x16_bf16 v[144:159], a[24:27], v[72:75], v[144:159]
  v_exp_f32 v40, v40
  v_exp_f32 v41, v41
  v_cvt_pk_bf16_f32 v67, v38, v39
  v_exp_f32 v42, v42
  v_exp_f32 v43, v43
  v_cvt_pk_bf16_f32 v68, v40, v41
  v_mfma_f32_32x32x16_bf16 v[144:159], a[28:31], v[76:79], v[144:159]
  v_exp_f32 v44, v44
  v_exp_f32 v45, v45
  v_cvt_pk_bf16_f32 v69, v42, v43
  v_exp_f32 v46, v46
  v_exp_f32 v47, v47
  v_cvt_pk_bf16_f32 v70, v44, v45
  v_cvt_pk_bf16_f32 v71, v46, v47
  v_mfma_f32_32x32x16_bf16 v[32:47], a[32:35], v[176:179], 0
  v_exp_f32 v48, v48
  v_exp_f32 v49, v49
  v_exp_f32 v50, v50
  v_exp_f32 v51, v51
  v_cvt_pk_bf16_f32 v72, v48, v49
  v_mfma_f32_32x32x16_bf16 v[32:47], a[36:39], v[180:183], v[32:47]
  s_add_u32 s65, s80, 20480
  buffer_load_dwordx4 a[16:19], v1, s[40:43], s65 offen offset:0 sc1
  buffer_load_dwordx4 a[20:23], v1, s[40:43], s65 offen offset:1024 sc1
  buffer_load_dwordx4 a[24:27], v1, s[40:43], s65 offen offset:2048 sc1
  buffer_load_dwordx4 a[28:31], v1, s[40:43], s65 offen offset:3072 sc1
  v_exp_f32 v52, v52
  v_exp_f32 v53, v53
  v_cvt_pk_bf16_f32 v73, v50, v51
  v_exp_f32 v54, v54
  v_exp_f32 v55, v55
  v_cvt_pk_bf16_f32 v74, v52, v53
  v_mfma_f32_32x32x16_bf16 v[96:111], a[40:43], v[64:67], v[96:111]
  v_exp_f32 v56, v56
  v_exp_f32 v57, v57
  v_cvt_pk_bf16_f32 v75, v54, v55
  v_exp_f32 v58, v58
  v_exp_f32 v59, v59
  v_cvt_pk_bf16_f32 v76, v56, v57
  v_mfma_f32_32x32x16_bf16 v[96:111], a[44:47], v[68:71], v[96:111]
  v_exp_f32 v60, v60
  v_exp_f32 v61, v61
  v_cvt_pk_bf16_f32 v77, v58, v59
  v_exp_f32 v62, v62
  v_exp_f32 v63, v63
  v_cvt_pk_bf16_f32 v78, v60, v61
  v_cvt_pk_bf16_f32 v79, v62, v63
  v_mfma_f32_32x32x16_bf16 v[48:63], a[32:35], v[184:187], 0
  v_exp_f32 v32, v32
  v_exp_f32 v33, v33
  v_exp_f32 v34, v34
  v_exp_f32 v35, v35
  v_cvt_pk_bf16_f32 v64, v32, v33
  v_mfma_f32_32x32x16_bf16 v[48:63], a[36:39], v[188:191], v[48:63]
  v_exp_f32 v36, v36
  v_exp_f32 v37, v37
  v_cvt_pk_bf16_f32 v65, v34, v35
  v_exp_f32 v38, v38
  v_exp_f32 v39, v39
  v_cvt_pk_bf16_f32 v66, v36, v37
  v_mfma_f32_32x32x16_bf16 v[112:127], a[40:43], v[72:75], v[112:127]
  v_exp_f32 v40, v40
  v_exp_f32 v41, v41
  v_cvt_pk_bf16_f32 v67, v38, v39
  v_exp_f32 v42, v42
  v_exp_f32 v43, v43
  v_cvt_pk_bf16_f32 v68, v40, v41
  v_mfma_f32_32x32x16_bf16 v[112:127], a[44:47], v[76:79], v[112:127]
  v_exp_f32 v44, v44
  v_exp_f32 v45, v45
  v_cvt_pk_bf16_f32 v69, v42, v43
  v_exp_f32 v46, v46
  v_exp_f32 v47, v47
  v_cvt_pk_bf16_f32 v70, v44, v45
  v_cvt_pk_bf16_f32 v71, v46, v47
  s_waitcnt vmcnt(16)
  v_mfma_f32_32x32x16_bf16 v[32:47], a[48:51], v[160:163], 0
  s_cmp_lt_u32 s55, 2
  s_cbranch_scc1 L_nored_10
  s_lshl_b32 s91, s53, 1
  s_add_u32 s91, s91, s55
  s_sub_u32 s91, s91, 2
  s_lshl_b32 s73, s91, 7
  s_add_u32 s90, s73, 12288
  v_and_b32 v24, 31, v0
  v_lshlrev_b32 v24, 2, v24
  buffer_load_dword v25, v24, s[40:43], s90 offen sc1
L_nored_10:
  v_exp_f32 v48, v48
  v_exp_f32 v49, v49
  v_exp_f32 v50, v50
  v_exp_f32 v51, v51
  v_cvt_pk_bf16_f32 v72, v48, v49
  v_mfma_f32_32x32x16_bf16 v[32:47], a[52:55], v[164:167], v[32:47]
  v_exp_f32 v52, v52
  v_exp_f32 v53, v53
  v_cvt_pk_bf16_f32 v73, v50, v51
  v_exp_f32 v54, v54
  v_exp_f32 v55, v55
  v_cvt_pk_bf16_f32 v74, v52, v53
  v_mfma_f32_32x32x16_bf16 v[128:143], a[40:43], v[64:67], v[128:143]
  v_exp_f32 v56, v56
  v_exp_f32 v57, v57
  v_cvt_pk_bf16_f32 v75, v54, v55
  v_exp_f32 v58, v58
  v_exp_f32 v59, v59
  v_cvt_pk_bf16_f32 v76, v56, v57
  v_mfma_f32_32x32x16_bf16 v[128:143], a[44:47], v[68:71], v[128:143]
  v_exp_f32 v60, v60
  v_exp_f32 v61, v61
  v_cvt_pk_bf16_f32 v77, v58, v59
  v_exp_f32 v62, v62
  v_exp_f32 v63, v63
  v_cvt_pk_bf16_f32 v78, v60, v61
  v_cvt_pk_bf16_f32 v79, v62, v63
  v_mfma_f32_32x32x16_bf16 v[48:63], a[48:51], v[168:171], 0
  v_exp_f32 v32, v32
  v_exp_f32 v33, v33
  v_exp_f32 v34, v34
  v_exp_f32 v35, v35
  v_cvt_pk_bf16_f32 v64, v32, v33
  v_mfma_f32_32x32x16_bf16 v[48:63], a[52:55], v[172:175], v[48:63]
  v_exp_f32 v36, v36
  v_exp_f32 v37, v37
  v_cvt_pk_bf16_f32 v65, v34, v35
  v_exp_f32 v38, v38
  v_exp_f32 v39, v39
  v_cvt_pk_bf16_f32 v66, v36, v37
  v_mfma_f32_32x32x16_bf16 v[144:159], a[40:43], v[72:75], v[144:159]
  v_exp_f32 v40, v40
  v_exp_f32 v41, v41
  v_cvt_pk_bf16_f32 v67, v38, v39
  v_exp_f32 v42, v42
  v_exp_f32 v43, v43
  v_cvt_pk_bf16_f32 v68, v40, v41
  v_mfma_f32_32x32x16_bf16 v[144:159], a[44:47], v[76:79], v[144:159]
  v_exp_f32 v44, v44
  v_exp_f32 v45, v45
  v_cvt_pk_bf16_f32 v69, v42, v43
  v_exp_f32 v46, v46
  v_exp_f32 v47, v47
  v_cvt_pk_bf16_f32 v70, v44, v45
  v_cvt_pk_bf16_f32 v71, v46, v47
  v_mfma_f32_32x32x16_bf16 v[32:47], a[48:51], v[176:179], 0
  v_exp_f32 v48, v48
  v_exp_f32 v49, v49
  v_exp_f32 v50, v50
  v_exp_f32 v51, v51
  v_cvt_pk_bf16_f32 v72, v48, v49
  v_mfma_f32_32x32x16_bf16 v[32:47], a[52:55], v[180:183], v[32:47]
  s_add_u32 s65, s80, 24576
  buffer_load_dwordx4 a[32:35], v1, s[40:43], s65 offen offset:0 sc1
  buffer_load_dwordx4 a[36:39], v1, s[40:43], s65 offen offset:1024 sc1
  buffer_load_dwordx4 a[40:43], v1, s[40:43], s65 offen offset:2048 sc1
  buffer_load_dwordx4 a[44:47], v1, s[40:43], s65 offen offset:3072 sc1
  v_exp_f32 v52, v52
  v_exp_f32 v53, v53
  v_cvt_pk_bf16_f32 v73, v50, v51
  v_exp_f32 v54, v54
  v_exp_f32 v55, v55
  v_cvt_pk_bf16_f32 v74, v52, v53
  v_mfma_f32_32x32x16_bf16 v[96:111], a[56:59], v[64:67], v[96:111]
  v_exp_f32 v56, v56
  v_exp_f32 v57, v57
  v_cvt_pk_bf16_f32 v75, v54, v55
  v_exp_f32 v58, v58
  v_exp_f32 v59, v59
  v_cvt_pk_bf16_f32 v76, v56, v57
  v_mfma_f32_32x32x16_bf16 v[96:111], a[60:63], v[68:71], v[96:111]
  v_exp_f32 v60, v60
  v_exp_f32 v61, v61
  v_cvt_pk_bf16_f32 v77, v58, v59
  v_exp_f32 v62, v62
  v_exp_f32 v63, v63
  v_cvt_pk_bf16_f32 v78, v60, v61
  v_cvt_pk_bf16_f32 v79, v62, v63
  v_mfma_f32_32x32x16_bf16 v[48:63], a[48:51], v[184:187], 0
  s_waitcnt vmcnt(8)
  s_barrier
  s_cmp_lg_u32 s55, 0
  s_cbranch_scc1 L_nof0_11
  s_lshl_b32 s72, s53, 7
  s_lshl_b32 s73, s54, 2
  s_add_u32 s72, s72, s73
  s_add_u32 s72, s72, 4096
  v_mov_b32 v22, s72
  v_mov_b32 v23, s56
  s_mov_b64 exec, 1
  buffer_store_dword v23, v22, s[40:43], 0 offen sc1
  s_mov_b64 exec, -1
L_nof0_11:
  v_exp_f32 v32, v32
  v_exp_f32 v33, v33
  v_exp_f32 v34, v34
  v_exp_f32 v35, v35
  v_cvt_pk_bf16_f32 v64, v32, v33
  v_mfma_f32_32x32x16_bf16 v[48:63], a[52:55], v[188:191], v[48:63]
  v_exp_f32 v36, v36
  v_exp_f32 v37, v37
  v_cvt_pk_bf16_f32 v65, v34, v35
  v_exp_f32 v38, v38
  v_exp_f32 v39, v39
  v_cvt_pk_bf16_f32 v66, v36, v37
  v_mfma_f32_32x32x16_bf16 v[112:127], a[56:59], v[72:75], v[112:127]
  v_exp_f32 v40, v40
  v_exp_f32 v41, v41
  v_cvt_pk_bf16_f32 v67, v38, v39
  v_exp_f32 v42, v42
  v_exp_f32 v43, v43
  v_cvt_pk_bf16_f32 v68, v40, v41
  v_mfma_f32_32x32x16_bf16 v[112:127], a[60:63], v[76:79], v[112:127]
  v_exp_f32 v44, v44
  v_exp_f32 v45, v45
  v_cvt_pk_bf16_f32 v69, v42, v43
  v_exp_f32 v46, v46
  v_exp_f32 v47, v47
  v_cvt_pk_bf16_f32 v70, v44, v45
  v_cvt_pk_bf16_f32 v71, v46, v47
  s_waitcnt vmcnt(10)
  v_mfma_f32_32x32x16_bf16 v[32:47], a[0:3], v[160:163], 0
  v_exp_f32 v48, v48
  v_exp_f32 v49, v49
  v_exp_f32 v50, v50
  v_exp_f32 v51, v51
  v_cvt_pk_bf16_f32 v72, v48, v49
  v_mfma_f32_32x32x16_bf16 v[32:47], a[4:7], v[164:167], v[32:47]
  v_exp_f32 v52, v52
  v_exp_f32 v53, v53
  v_cvt_pk_bf16_f32 v73, v50, v51
  v_exp_f32 v54, v54
  v_exp_f32 v55, v55
  v_cvt_pk_bf16_f32 v74, v52, v53
  v_mfma_f32_32x32x16_bf16 v[128:143], a[56:59], v[64:67], v[128:143]
  v_exp_f32 v56, v56
  v_exp_f32 v57, v57
  v_cvt_pk_bf16_f32 v75, v54, v55
  v_exp_f32 v58, v58
  v_exp_f32 v59, v59
  v_cvt_pk_bf16_f32 v76, v56, v57
  v_mfma_f32_32x32x16_bf16 v[128:143], a[60:63], v[68:71], v[128:143]
  v_exp_f32 v60, v60
  v_exp_f32 v61, v61
  v_cvt_pk_bf16_f32 v77, v58, v59
  v_exp_f32 v62, v62
  v_exp_f32 v63, v63
  v_cvt_pk_bf16_f32 v78, v60, v61
  v_cvt_pk_bf16_f32 v79, v62, v63
  v_mfma_f32_32x32x16_bf16 v[48:63], a[0:3], v[168:171], 0
  s_cmp_lt_u32 s55, 2
  s_cbranch_scc1 L_nored_12
  s_waitcnt vmcnt(4)
  v_cmp_ne_u32 vcc, s56, v25
  s_nop 1
  s_cbranch_vccnz L_spin_f2_14
L_back_f2_13:
  s_lshl_b32 s73, s91, 17
  s_lshr_b32 s74, s54, 1
  s_lshl_b32 s74, s74, 10
  s_add_u32 s73, s73, s74
  s_and_b32 s74, s54, 1
  s_lshl_b32 s74, s74, 3
  s_add_u32 s73, s73, s74
  s_add_u32 s73, s73, 5242880
  buffer_load_dwordx2 v[192:193], v1, s[40:43], s73 offen sc1
  s_add_u32 s73, s73, 8192
  buffer_load_dwordx2 v[194:195], v1, s[40:43], s73 offen sc1
  s_add_u32 s73, s73, 8192
  buffer_load_dwordx2 v[196:197], v1, s[40:43], s73 offen sc1
  s_add_u32 s73, s73, 8192
  buffer_load_dwordx2 v[198:199], v1, s[40:43], s73 offen sc1
  s_add_u32 s73, s73, 8192
  buffer_load_dwordx2 v[200:201], v1, s[40:43], s73 offen sc1
  s_add_u32 s73, s73, 8192
  buffer_load_dwordx2 v[202:203], v1, s[40:43], s73 offen sc1
  s_add_u32 s73, s73, 8192
  buffer_load_dwordx2 v[204:205], v1, s[40:43], s73 offen sc1
  s_add_u32 s73, s73, 8192
  buffer_load_dwordx2 v[206:207], v1, s[40:43], s73 offen sc1
  s_add_u32 s73, s73, 8192
  buffer_load_dwordx2 v[208:209], v1, s[40:43], s73 offen sc1
  s_add_u32 s73, s73, 8192
  buffer_load_dwordx2 v[210:211], v1, s[40:43], s73 offen sc1
  s_add_u32 s73, s73, 8192
  buffer_load_dwordx2 v[212:213], v1, s[40:43], s73 offen sc1
  s_add_u32 s73, s73, 8192
  buffer_load_dwordx2 v[214:215], v1, s[40:43], s73 offen sc1
  s_add_u32 s73, s73, 8192
  buffer_load_dwordx2 v[216:217], v1, s[40:43], s73 offen sc1
  s_add_u32 s73, s73, 8192
  buffer_load_dwordx2 v[218:219], v1, s[40:43], s73 offen sc1
  s_add_u32 s73, s73, 8192
  buffer_load_dwordx2 v[220:221], v1, s[40:43], s73 offen sc1
  s_add_u32 s73, s73, 8192
  buffer_load_dwordx2 v[222:223], v1, s[40:43], s73 offen sc1
L_nored_12:
  v_exp_f32 v32, v32
  v_exp_f32 v33, v33
  v_exp_f32 v34, v34
  v_exp_f32 v35, v35
  v_cvt_pk_bf16_f32 v64, v32, v33
  v_mfma_f32_32x32x16_bf16 v[48:63], a[4:7], v[172:175], v[48:63]
  v_exp_f32 v36, v36
  v_exp_f32 v37, v37
  v_cvt_pk_bf16_f32 v65, v34, v35
  v_exp_f32 v38, v38
  v_exp_f32 v39, v39
  v_cvt_pk_bf16_f32 v66, v36, v37
  v_mfma_f32_32x32x16_bf16 v[144:159], a[56:59], v[72:75], v[144:159]
  v_exp_f32 v40, v40
  v_exp_f32 v41, v41
  v_cvt_pk_bf16_f32 v67, v38, v39
  v_exp_f32 v42, v42
  v_exp_f32 v43, v43
  v_cvt_pk_bf16_f32 v68, v40, v41
  v_mfma_f32_32x32x16_bf16 v[144:159], a[60:63], v[76:79], v[144:159]
  v_exp_f32 v44, v44
  v_exp_f32 v45, v45
  v_cvt_pk_bf16_f32 v69, v42, v43
  v_exp_f32 v46, v46
  v_exp_f32 v47, v47
  v_cvt_pk_bf16_f32 v70, v44, v45
  v_cvt_pk_bf16_f32 v71, v46, v47
  v_mfma_f32_32x32x16_bf16 v[32:47], a[0:3], v[176:179], 0
  v_exp_f32 v48, v48
  v_exp_f32 v49, v49
  v_exp_f32 v50, v50
  v_exp_f32 v51, v51
  v_cvt_pk_bf16_f32 v72, v48, v49
  v_mfma_f32_32x32x16_bf16 v[32:47], a[4:7], v[180:183], v[32:47]
  s_add_u32 s65, s80, 28672
  buffer_load_dwordx4 a[48:51], v1, s[40:43], s65 offen offset:0 sc1
  buffer_load_dwordx4 a[52:55], v1, s[40:43], s65 offen offset:1024 sc1
  buffer_load_dwordx4 a[56:59], v1, s[40:43], s65 offen offset:2048 sc1
  buffer_load_dwordx4 a[60:63], v1, s[40:43], s65 offen offset:3072 sc1
  v_exp_f32 v52, v52
  v_exp_f32 v53, v53
  v_cvt_pk_bf16_f32 v73, v50, v51
  v_exp_f32 v54, v54
  v_exp_f32 v55, v55
  v_cvt_pk_bf16_f32 v74, v52, v53
  v_mfma_f32_32x32x16_bf16 v[96:111], a[8:11], v[64:67], v[96:111]
  v_exp_f32 v56, v56
  v_exp_f32 v57, v57
  v_cvt_pk_bf16_f32 v75, v54, v55
  v_exp_f32 v58, v58
  v_exp_f32 v59, v59
  v_cvt_pk_bf16_f32 v76, v56, v57
  v_mfma_f32_32x32x16_bf16 v[96:111], a[12:15], v[68:71], v[96:111]
  v_exp_f32 v60, v60
  v_exp_f32 v61, v61
  v_cvt_pk_bf16_f32 v77, v58, v59
  v_exp_f32 v62, v62
  v_exp_f32 v63, v63
  v_cvt_pk_bf16_f32 v78, v60, v61
  v_cvt_pk_bf16_f32 v79, v62, v63
  v_mfma_f32_32x32x16_bf16 v[48:63], a[0:3], v[184:187], 0
  v_exp_f32 v32, v32
  v_exp_f32 v33, v33
  v_exp_f32 v34, v34
  v_exp_f32 v35, v35
  v_cvt_pk_bf16_f32 v64, v32, v33
  v_mfma_f32_32x32x16_bf16 v[48:63], a[4:7], v[188:191], v[48:63]
  v_exp_f32 v36, v36
  v_exp_f32 v37, v37
  v_cvt_pk_bf16_f32 v65, v34, v35
  v_exp_f32 v38, v38
  v_exp_f32 v39, v39
  v_cvt_pk_bf16_f32 v66, v36, v37
  v_mfma_f32_32x32x16_bf16 v[112:127], a[8:11], v[72:75], v[112:127]
  v_exp_f32 v40, v40
  v_exp_f32 v41, v41
  v_cvt_pk_bf16_f32 v67, v38, v39
  v_exp_f32 v42, v42
  v_exp_f32 v43, v43
  v_cvt_pk_bf16_f32 v68, v40, v41
  v_mfma_f32_32x32x16_bf16 v[112:127], a[12:15], v[76:79], v[112:127]
  v_exp_f32 v44, v44
  v_exp_f32 v45, v45
  v_cvt_pk_bf16_f32 v69, v42, v43
  v_exp_f32 v46, v46
  v_exp_f32 v47, v47
  v_cvt_pk_bf16_f32 v70, v44, v45
  v_cvt_pk_bf16_f32 v71, v46, v47
  s_waitcnt vmcnt(8)
  v_mfma_f32_32x32x16_bf16 v[32:47], a[16:19], v[160:163], 0
  v_exp_f32 v48, v48
  v_exp_f32 v49, v49
  v_exp_f32 v50, v50
  v_exp_f32 v51, v51
  v_cvt_pk_bf16_f32 v72, v48, v49
  v_mfma_f32_32x32x16_bf16 v[32:47], a[20:23], v[164:167], v[32:47]
  v_exp_f32 v52, v52
  v_exp_f32 v53, v53
  v_cvt_pk_bf16_f32 v73, v50, v51
  v_exp_f32 v54, v54
  v_exp_f32 v55, v55
  v_cvt_pk_bf16_f32 v74, v52, v53
  v_mfma_f32_32x32x16_bf16 v[128:143], a[8:11], v[64:67], v[128:143]
  v_exp_f32 v56, v56
  v_exp_f32 v57, v57
  v_cvt_pk_bf16_f32 v75, v54, v55
  v_exp_f32 v58, v58
  v_exp_f32 v59, v59
  v_cvt_pk_bf16_f32 v76, v56, v57
  v_mfma_f32_32x32x16_bf16 v[128:143], a[12:15], v[68:71], v[128:143]
  v_exp_f32 v60, v60
  v_exp_f32 v61, v61
  v_cvt_pk_bf16_f32 v77, v58, v59
  v_exp_f32 v62, v62
  v_exp_f32 v63, v63
  v_cvt_pk_bf16_f32 v78, v60, v61
  v_cvt_pk_bf16_f32 v79, v62, v63
  v_mfma_f32_32x32x16_bf16 v[48:63], a[16:19], v[168:171], 0
  v_exp_f32 v32, v32
  v_exp_f32 v33, v33
  v_exp_f32 v34, v34
  v_exp_f32 v35, v35
  v_cvt_pk_bf16_f32 v64, v32, v33
  v_mfma_f32_32x32x16_bf16 v[48:63], a[20:23], v[172:175], v[48:63]
  v_exp_f32 v36, v36
  v_exp_f32 v37, v37
  v_cvt_pk_bf16_f32 v65, v34, v35
  v_exp_f32 v38, v38
  v_exp_f32 v39, v39
  v_cvt_pk_bf16_f32 v66, v36, v37
  v_mfma_f32_32x32x16_bf16 v[144:159], a[8:11], v[72:75], v[144:159]
  v_exp_f32 v40, v40
  v_exp_f32 v41, v41
  v_cvt_pk_bf16_f32 v67, v38, v39
  v_exp_f32 v42, v42
  v_exp_f32 v43, v43
  v_cvt_pk_bf16_f32 v68, v40, v41
  v_mfma_f32_32x32x16_bf16 v[144:159], a[12:15], v[76:79], v[144:159]
  v_exp_f32 v44, v44
  v_exp_f32 v45, v45
  v_cvt_pk_bf16_f32 v69, v42, v43
  v_exp_f32 v46, v46
  v_exp_f32 v47, v47
  v_cvt_pk_bf16_f32 v70, v44, v45
  v_cvt_pk_bf16_f32 v71, v46, v47
  v_mfma_f32_32x32x16_bf16 v[32:47], a[16:19], v[176:179], 0
  v_exp_f32 v48, v48
  v_exp_f32 v49, v49
  v_exp_f32 v50, v50
  v_exp_f32 v51, v51
  v_cvt_pk_bf16_f32 v72, v48, v49
  v_mfma_f32_32x32x16_bf16 v[32:47], a[20:23], v[180:183], v[32:47]
  s_add_u32 s65, s80, 32768
  buffer_load_dwordx4 a[0:3], v1, s[40:43], s65 offen offset:0 sc1
  buffer_load_dwordx4 a[4:7], v1, s[40:43], s65 offen offset:1024 sc1
  buffer_load_dwordx4 a[8:11], v1, s[40:43], s65 offen offset:2048 sc1
  buffer_load_dwordx4 a[12:15], v1, s[40:43], s65 offen offset:3072 sc1
  v_exp_f32 v52, v52
  v_exp_f32 v53, v53
  v_cvt_pk_bf16_f32 v73, v50, v51
  v_exp_f32 v54, v54
  v_exp_f32 v55, v55
  v_cvt_pk_bf16_f32 v74, v52, v53
  v_mfma_f32_32x32x16_bf16 v[96:111], a[24:27], v[64:67], v[96:111]
  v_exp_f32 v56, v56
  v_exp_f32 v57, v57
  v_cvt_pk_bf16_f32 v75, v54, v55
  v_exp_f32 v58, v58
  v_exp_f32 v59, v59
  v_cvt_pk_bf16_f32 v76, v56, v57
  v_mfma_f32_32x32x16_bf16 v[96:111], a[28:31], v[68:71], v[96:111]
  v_exp_f32 v60, v60
  v_exp_f32 v61, v61
  v_cvt_pk_bf16_f32 v77, v58, v59
  v_exp_f32 v62, v62
  v_exp_f32 v63, v63
  v_cvt_pk_bf16_f32 v78, v60, v61
  v_cvt_pk_bf16_f32 v79, v62, v63
  v_mfma_f32_32x32x16_bf16 v[48:63], a[16:19], v[184:187], 0
  v_exp_f32 v32, v32
  v_exp_f32 v33, v33
  v_exp_f32 v34, v34
  v_exp_f32 v35, v35
  v_cvt_pk_bf16_f32 v64, v32, v33
  v_mfma_f32_32x32x16_bf16 v[48:63], a[20:23], v[188:191], v[48:63]
  v_exp_f32 v36, v36
  v_exp_f32 v37, v37
  v_cvt_pk_bf16_f32 v65, v34, v35
  v_exp_f32 v38, v38
  v_exp_f32 v39, v39
  v_cvt_pk_bf16_f32 v66, v36, v37
  v_mfma_f32_32x32x16_bf16 v[112:127], a[24:27], v[72:75], v[112:127]
  v_exp_f32 v40, v40
  v_exp_f32 v41, v41
  v_cvt_pk_bf16_f32 v67, v38, v39
  v_exp_f32 v42, v42
  v_exp_f32 v43, v43
  v_cvt_pk_bf16_f32 v68, v40, v41
  v_mfma_f32_32x32x16_bf16 v[112:127], a[28:31], v[76:79], v[112:127]
  v_exp_f32 v44, v44
  v_exp_f32 v45, v45
  v_cvt_pk_bf16_f32 v69, v42, v43
  v_exp_f32 v46, v46
  v_exp_f32 v47, v47
  v_cvt_pk_bf16_f32 v70, v44, v45
  v_cvt_pk_bf16_f32 v71, v46, v47
  s_waitcnt vmcnt(8)
  v_mfma_f32_32x32x16_bf16 v[32:47], a[32:35], v[160:163], 0
  s_cmp_lt_u32 s55, 2
  s_cbranch_scc1 L_nored_15
  s_waitcnt vmcnt(8)
  v_add_f32 v192, v192, v194
  v_add_f32 v193, v193, v195
  v_add_f32 v192, v192, v196
  v_add_f32 v193, v193, v197
  v_add_f32 v192, v192, v198
  v_add_f32 v193, v193, v199
  v_add_f32 v192, v192, v200
  v_add_f32 v193, v193, v201
  v_add_f32 v192, v192, v202
  v_add_f32 v193, v193, v203
  v_add_f32 v192, v192, v204
  v_add_f32 v193, v193, v205
  v_add_f32 v192, v192, v206
  v_add_f32 v193, v193, v207
  v_add_f32 v192, v192, v208
  v_add_f32 v193, v193, v209
  v_add_f32 v192, v192, v210
  v_add_f32 v193, v193, v211
  v_add_f32 v192, v192, v212
  v_add_f32 v193, v193, v213
  v_add_f32 v192, v192, v214
  v_add_f32 v193, v193, v215
  v_add_f32 v192, v192, v216
  v_add_f32 v193, v193, v217
  v_add_f32 v192, v192, v218
  v_add_f32 v193, v193, v219
  v_add_f32 v192, v192, v220
  v_add_f32 v193, v193, v221
  v_add_f32 v192, v192, v222
  v_add_f32 v193, v193, v223
  v_cvt_pk_bf16_f32 v192, v192, v193
  s_lshl_b32 s73, s91, 12
  s_lshr_b32 s74, s54, 2
  s_lshl_b32 s74, s74, 10
  s_add_u32 s73, s73, s74
  s_and_b32 s74, s54, 3
  s_lshl_b32 s74, s74, 2
  s_add_u32 s73, s73, s74
  s_add_u32 s73, s73, 65536
  buffer_store_dword v192, v1, s[40:43], s73 offen sc1
L_nored_15:
  v_exp_f32 v48, v48
  v_exp_f32 v49, v49
  v_exp_f32 v50, v50
  v_exp_f32 v51, v51
  v_cvt_pk_bf16_f32 v72, v48, v49
  v_mfma_f32_32x32x16_bf16 v[32:47], a[36:39], v[164:167], v[32:47]
  v_exp_f32 v52, v52
  v_exp_f32 v53, v53
  v_cvt_pk_bf16_f32 v73, v50, v51
  v_exp_f32 v54, v54
  v_exp_f32 v55, v55
  v_cvt_pk_bf16_f32 v74, v52, v53
  v_mfma_f32_32x32x16_bf16 v[128:143], a[24:27], v[64:67], v[128:143]
  v_exp_f32 v56, v56
  v_exp_f32 v57, v57
  v_cvt_pk_bf16_f32 v75, v54, v55
  v_exp_f32 v58, v58
  v_exp_f32 v59, v59
  v_cvt_pk_bf16_f32 v76, v56, v57
  v_mfma_f32_32x32x16_bf16 v[128:143], a[28:31], v[68:71], v[128:143]
  v_exp_f32 v60, v60
  v_exp_f32 v61, v61
  v_cvt_pk_bf16_f32 v77, v58, v59
  v_exp_f32 v62, v62
  v_exp_f32 v63, v63
  v_cvt_pk_bf16_f32 v78, v60, v61
  v_cvt_pk_bf16_f32 v79, v62, v63
  v_mfma_f32_32x32x16_bf16 v[48:63], a[32:35], v[168:171], 0
  v_exp_f32 v32, v32
  v_exp_f32 v33, v33
  v_exp_f32 v34, v34
  v_exp_f32 v35, v35
  v_cvt_pk_bf16_f32 v64, v32, v33
  v_mfma_f32_32x32x16_bf16 v[48:63], a[36:39], v[172:175], v[48:63]
  v_exp_f32 v36, v36
  v_exp_f32 v37, v37
  v_cvt_pk_bf16_f32 v65, v34, v35
  v_exp_f32 v38, v38
  v_exp_f32 v39, v39
  v_cvt_pk_bf16_f32 v66, v36, v37
  v_mfma_f32_32x32x16_bf16 v[144:159], a[24:27], v[72:75], v[144:159]
  v_exp_f32 v40, v40
  v_exp_f32 v41, v41
  v_cvt_pk_bf16_f32 v67, v38, v39
  v_exp_f32 v42, v42
  v_exp_f32 v43, v43
  v_cvt_pk_bf16_f32 v68, v40, v41
  v_mfma_f32_32x32x16_bf16 v[144:159], a[28:31], v[76:79], v[144:159]
  v_exp_f32 v44, v44
  v_exp_f32 v45, v45
  v_cvt_pk_bf16_f32 v69, v42, v43
  v_exp_f32 v46, v46
  v_exp_f32 v47, v47
  v_cvt_pk_bf16_f32 v70, v44, v45
  v_cvt_pk_bf16_f32 v71, v46, v47
  v_mfma_f32_32x32x16_bf16 v[32:47], a[32:35], v[176:179], 0
  v_exp_f32 v48, v48
  v_exp_f32 v49, v49
  v_exp_f32 v50, v50
  v_exp_f32 v51, v51
  v_cvt_pk_bf16_f32 v72, v48, v49
  v_mfma_f32_32x32x16_bf16 v[32:47], a[36:39], v[180:183], v[32:47]
  s_add_u32 s65, s80, 36864
  buffer_load_dwordx4 a[16:19], v1, s[40:43], s65 offen offset:0 sc1
  buffer_load_dwordx4 a[20:23], v1, s[40:43], s65 offen offset:1024 sc1
  buffer_load_dwordx4 a[24:27], v1, s[40:43], s65 offen offset:2048 sc1
  buffer_load_dwordx4 a[28:31], v1, s[40:43], s65 offen offset:3072 sc1
  v_exp_f32 v52, v52
  v_exp_f32 v53, v53
  v_cvt_pk_bf16_f32 v73, v50, v51
  v_exp_f32 v54, v54
  v_exp_f32 v55, v55
  v_cvt_pk_bf16_f32 v74, v52, v53
  v_mfma_f32_32x32x16_bf16 v[96:111], a[40:43], v[64:67], v[96:111]
  v_exp_f32 v56, v56
  v_exp_f32 v57, v57
  v_cvt_pk_bf16_f32 v75, v54, v55
  v_exp_f32 v58, v58
  v_exp_f32 v59, v59
  v_cvt_pk_bf16_f32 v76, v56, v57
  v_mfma_f32_32x32x16_bf16 v[96:111], a[44:47], v[68:71], v[96:111]
  v_exp_f32 v60, v60
  v_exp_f32 v61, v61
  v_cvt_pk_bf16_f32 v77, v58, v59
  v_exp_f32 v62, v62
  v_exp_f32 v63, v63
  v_cvt_pk_bf16_f32 v78, v60, v61
  v_cvt_pk_bf16_f32 v79, v62, v63
  v_mfma_f32_32x32x16_bf16 v[48:63], a[32:35], v[184:187], 0
  v_exp_f32 v32, v32
  v_exp_f32 v33, v33
  v_exp_f32 v34, v34
  v_exp_f32 v35, v35
  v_cvt_pk_bf16_f32 v64, v32, v33
  v_mfma_f32_32x32x16_bf16 v[48:63], a[36:39], v[188:191], v[48:63]
  v_exp_f32 v36, v36
  v_exp_f32 v37, v37
  v_cvt_pk_bf16_f32 v65, v34, v35
  v_exp_f32 v38, v38
  v_exp_f32 v39, v39
  v_cvt_pk_bf16_f32 v66, v36, v37
  v_mfma_f32_32x32x16_bf16 v[112:127], a[40:43], v[72:75], v[112:127]
  v_exp_f32 v40, v40
  v_exp_f32 v41, v41
  v_cvt_pk_bf16_f32 v67, v38, v39
  v_exp_f32 v42, v42
  v_exp_f32 v43, v43
  v_cvt_pk_bf16_f32 v68, v40, v41
  v_mfma_f32_32x32x16_bf16 v[112:127], a[44:47], v[76:79], v[112:127]
  v_exp_f32 v44, v44
  v_exp_f32 v45, v45
  v_cvt_pk_bf16_f32 v69, v42, v43
  v_exp_f32 v46, v46
  v_exp_f32 v47, v47
  v_cvt_pk_bf16_f32 v70, v44, v45
  v_cvt_pk_bf16_f32 v71, v46, v47
  s_waitcnt vmcnt(8)
  v_mfma_f32_32x32x16_bf16 v[32:47], a[48:51], v[160:163], 0
  v_lshrrev_b32 v80, 3, v0
  v_lshlrev_b32 v80, 7, v80
  v_and_b32 v81, 7, v0
  v_lshl_add_u32 v80, v81, 3, v80
  s_mov_b32 s89, 4096
  buffer_load_dwordx2 v[82:83], v80, s[40:43], s89 offen sc1
  v_exp_f32 v48, v48
  v_exp_f32 v49, v49
  v_exp_f32 v50, v50
  v_exp_f32 v51, v51
  v_cvt_pk_bf16_f32 v72, v48, v49
  v_mfma_f32_32x32x16_bf16 v[32:47], a[52:55], v[164:167], v[32:47]
  v_exp_f32 v52, v52
  v_exp_f32 v53, v53
  v_cvt_pk_bf16_f32 v73, v50, v51
  v_exp_f32 v54, v54
  v_exp_f32 v55, v55
  v_cvt_pk_bf16_f32 v74, v52, v53
  v_mfma_f32_32x32x16_bf16 v[128:143], a[40:43], v[64:67], v[128:143]
  v_exp_f32 v56, v56
  v_exp_f32 v57, v57
  v_cvt_pk_bf16_f32 v75, v54, v55
  v_exp_f32 v58, v58
  v_exp_f32 v59, v59
  v_cvt_pk_bf16_f32 v76, v56, v57
  v_mfma_f32_32x32x16_bf16 v[128:143], a[44:47], v[68:71], v[128:143]
  v_exp_f32 v60, v60
  v_exp_f32 v61, v61
  v_cvt_pk_bf16_f32 v77, v58, v59
  v_exp_f32 v62, v62
  v_exp_f32 v63, v63
  v_cvt_pk_bf16_f32 v78, v60, v61
  v_cvt_pk_bf16_f32 v79, v62, v63
  v_mfma_f32_32x32x16_bf16 v[48:63], a[48:51], v[168:171], 0
  s_cmp_lt_u32 s55, 2
  s_cbranch_scc1 L_nored_16
  s_waitcnt vmcnt(5)
  s_lshl_b32 s73, s91, 7
  s_lshl_b32 s74, s54, 2
  s_add_u32 s73, s73, s74
  s_add_u32 s73, s73, 16384
  v_mov_b32 v22, s73
  v_mov_b32 v23, s56
  s_mov_b64 exec, 1
  buffer_store_dword v23, v22, s[40:43], 0 offen sc1
  s_mov_b64 exec, -1
L_nored_16:
  v_exp_f32 v32, v32
  v_exp_f32 v33, v33
  v_exp_f32 v34, v34
  v_exp_f32 v35, v35
  v_cvt_pk_bf16_f32 v64, v32, v33
  v_mfma_f32_32x32x16_bf16 v[48:63], a[52:55], v[172:175], v[48:63]
  v_exp_f32 v36, v36
  v_exp_f32 v37, v37
  v_cvt_pk_bf16_f32 v65, v34, v35
  v_exp_f32 v38, v38
  v_exp_f32 v39, v39
  v_cvt_pk_bf16_f32 v66, v36, v37
  v_mfma_f32_32x32x16_bf16 v[144:159], a[40:43], v[72:75], v[144:159]
  v_exp_f32 v40, v40
  v_exp_f32 v41, v41
  v_cvt_pk_bf16_f32 v67, v38, v39
  v_exp_f32 v42, v42
  v_exp_f32 v43, v43
  v_cvt_pk_bf16_f32 v68, v40, v41
  v_mfma_f32_32x32x16_bf16 v[144:159], a[44:47], v[76:79], v[144:159]
  v_exp_f32 v44, v44
  v_exp_f32 v45, v45
  v_cvt_pk_bf16_f32 v69, v42, v43
  v_exp_f32 v46, v46
  v_exp_f32 v47, v47
  v_cvt_pk_bf16_f32 v70, v44, v45
  v_cvt_pk_bf16_f32 v71, v46, v47
  v_mfma_f32_32x32x16_bf16 v[32:47], a[48:51], v[176:179], 0
  v_exp_f32 v48, v48
  v_exp_f32 v49, v49
  v_exp_f32 v50, v50
  v_exp_f32 v51, v51
  v_cvt_pk_bf16_f32 v72, v48, v49
  v_mfma_f32_32x32x16_bf16 v[32:47], a[52:55], v[180:183], v[32:47]
  s_add_u32 s65, s80, 40960
  buffer_load_dwordx4 a[32:35], v1, s[40:43], s65 offen offset:0 sc1
  buffer_load_dwordx4 a[36:39], v1, s[40:43], s65 offen offset:1024 sc1
  buffer_load_dwordx4 a[40:43], v1, s[40:43], s65 offen offset:2048 sc1
  buffer_load_dwordx4 a[44:47], v1, s[40:43], s65 offen offset:3072 sc1
  v_exp_f32 v52, v52
  v_exp_f32 v53, v53
  v_cvt_pk_bf16_f32 v73, v50, v51
  v_exp_f32 v54, v54
  v_exp_f32 v55, v55
  v_cvt_pk_bf16_f32 v74, v52, v53
  v_mfma_f32_32x32x16_bf16 v[96:111], a[56:59], v[64:67], v[96:111]
  v_exp_f32 v56, v56
  v_exp_f32 v57, v57
  v_cvt_pk_bf16_f32 v75, v54, v55
  v_exp_f32 v58, v58
  v_exp_f32 v59, v59
  v_cvt_pk_bf16_f32 v76, v56, v57
  v_mfma_f32_32x32x16_bf16 v[96:111], a[60:63], v[68:71], v[96:111]
  v_exp_f32 v60, v60
  v_exp_f32 v61, v61
  v_cvt_pk_bf16_f32 v77, v58, v59
  v_exp_f32 v62, v62
  v_exp_f32 v63, v63
  v_cvt_pk_bf16_f32 v78, v60, v61
  v_cvt_pk_bf16_f32 v79, v62, v63
  v_mfma_f32_32x32x16_bf16 v[48:63], a[48:51], v[184:187], 0
  v_exp_f32 v32, v32
  v_exp_f32 v33, v33
  v_exp_f32 v34, v34
  v_exp_f32 v35, v35
  v_cvt_pk_bf16_f32 v64, v32, v33
  v_mfma_f32_32x32x16_bf16 v[48:63], a[52:55], v[188:191], v[48:63]
  v_exp_f32 v36, v36
  v_exp_f32 v37, v37
  v_cvt_pk_bf16_f32 v65, v34, v35
  v_exp_f32 v38, v38
  v_exp_f32 v39, v39
  v_cvt_pk_bf16_f32 v66, v36, v37
  v_mfma_f32_32x32x16_bf16 v[112:127], a[56:59], v[72:75], v[112:127]
  v_exp_f32 v40, v40
  v_exp_f32 v41, v41
  v_cvt_pk_bf16_f32 v67, v38, v39
  v_exp_f32 v42, v42
  v_exp_f32 v43, v43
  v_cvt_pk_bf16_f32 v68, v40, v41
  v_mfma_f32_32x32x16_bf16 v[112:127], a[60:63], v[76:79], v[112:127]
  v_exp_f32 v44, v44
  v_exp_f32 v45, v45
  v_cvt_pk_bf16_f32 v69, v42, v43
  v_exp_f32 v46, v46
  v_exp_f32 v47, v47
  v_cvt_pk_bf16_f32 v70, v44, v45
  v_cvt_pk_bf16_f32 v71, v46, v47
  s_waitcnt vmcnt(9)
  v_mfma_f32_32x32x16_bf16 v[32:47], a[0:3], v[160:163], 0
  v_exp_f32 v48, v48
  v_exp_f32 v49, v49
  v_exp_f32 v50, v50
  v_exp_f32 v51, v51
  v_cvt_pk_bf16_f32 v72, v48, v49
  v_mfma_f32_32x32x16_bf16 v[32:47], a[4:7], v[164:167], v[32:47]
  v_exp_f32 v52, v52
  v_exp_f32 v53, v53
  v_cvt_pk_bf16_f32 v73, v50, v51
  v_exp_f32 v54, v54
  v_exp_f32 v55, v55
  v_cvt_pk_bf16_f32 v74, v52, v53
  v_mfma_f32_32x32x16_bf16 v[128:143], a[56:59], v[64:67], v[128:143]
  v_exp_f32 v56, v56
  v_exp_f32 v57, v57
  v_cvt_pk_bf16_f32 v75, v54, v55
  v_exp_f32 v58, v58
  v_exp_f32 v59, v59
  v_cvt_pk_bf16_f32 v76, v56, v57
  v_mfma_f32_32x32x16_bf16 v[128:143], a[60:63], v[68:71], v[128:143]
  v_exp_f32 v60, v60
  v_exp_f32 v61, v61
  v_cvt_pk_bf16_f32 v77, v58, v59
  v_exp_f32 v62, v62
  v_exp_f32 v63, v63
  v_cvt_pk_bf16_f32 v78, v60, v61
  v_cvt_pk_bf16_f32 v79, v62, v63
  v_mfma_f32_32x32x16_bf16 v[48:63], a[0:3], v[168:171], 0
  v_exp_f32 v32, v32
  v_exp_f32 v33, v33
  v_exp_f32 v34, v34
  v_exp_f32 v35, v35
  v_cvt_pk_bf16_f32 v64, v32, v33
  v_mfma_f32_32x32x16_bf16 v[48:63], a[4:7], v[172:175], v[48:63]
  v_exp_f32 v36, v36
  v_exp_f32 v37, v37
  v_cvt_pk_bf16_f32 v65, v34, v35
  v_exp_f32 v38, v38
  v_exp_f32 v39, v39
  v_cvt_pk_bf16_f32 v66, v36, v37
  v_mfma_f32_32x32x16_bf16 v[144:159], a[56:59], v[72:75], v[144:159]
  v_exp_f32 v40, v40
  v_exp_f32 v41, v41
  v_cvt_pk_bf16_f32 v67, v38, v39
  v_exp_f32 v42, v42
  v_exp_f32 v43, v43
  v_cvt_pk_bf16_f32 v68, v40, v41
  v_mfma_f32_32x32x16_bf16 v[144:159], a[60:63], v[76:79], v[144:159]
  v_exp_f32 v44, v44
  v_exp_f32 v45, v45
  v_cvt_pk_bf16_f32 v69, v42, v43
  v_exp_f32 v46, v46
  v_exp_f32 v47, v47
  v_cvt_pk_bf16_f32 v70, v44, v45
  v_cvt_pk_bf16_f32 v71, v46, v47
  v_mfma_f32_32x32x16_bf16 v[32:47], a[0:3], v[176:179], 0
  s_waitcnt vmcnt(4)
  v_xor_b32 v82, s56, v82
  v_xor_b32 v83, s56, v83
  v_or_b32 v82, v82, v83
  v_cmp_ne_u32 vcc, 0, v82
  s_nop 1
  s_cbranch_vccnz L_spin_f0_18
L_back_f0_17:
  s_bfe_u32 s87, s2, 0x20003
  s_lshl_b32 s87, s87, 2
  s_add_u32 s87, s87, s55
  s_lshl_b32 s87, s87, 15
  s_add_u32 s87, s87, 11534336
  v_exp_f32 v48, v48
  v_exp_f32 v49, v49
  v_exp_f32 v50, v50
  v_exp_f32 v51, v51
  v_cvt_pk_bf16_f32 v72, v48, v49
  v_mfma_f32_32x32x16_bf16 v[32:47], a[4:7], v[180:183], v[32:47]
  s_add_u32 s65, s80, 45056
  buffer_load_dwordx4 a[48:51], v1, s[40:43], s65 offen offset:0 sc1
  buffer_load_dwordx4 a[52:55], v1, s[40:43], s65 offen offset:1024 sc1
  buffer_load_dwordx4 a[56:59], v1, s[40:43], s65 offen offset:2048 sc1
  buffer_load_dwordx4 a[60:63], v1, s[40:43], s65 offen offset:3072 sc1
  v_exp_f32 v52, v52
  v_exp_f32 v53, v53
  v_cvt_pk_bf16_f32 v73, v50, v51
  v_exp_f32 v54, v54
  v_exp_f32 v55, v55
  v_cvt_pk_bf16_f32 v74, v52, v53
  v_mfma_f32_32x32x16_bf16 v[96:111], a[8:11], v[64:67], v[96:111]
  v_exp_f32 v56, v56
  v_exp_f32 v57, v57
  v_cvt_pk_bf16_f32 v75, v54, v55
  v_exp_f32 v58, v58
  v_exp_f32 v59, v59
  v_cvt_pk_bf16_f32 v76, v56, v57
  v_mfma_f32_32x32x16_bf16 v[96:111], a[12:15], v[68:71], v[96:111]
  v_exp_f32 v60, v60
  v_exp_f32 v61, v61
  v_cvt_pk_bf16_f32 v77, v58, v59
  v_exp_f32 v62, v62
  v_exp_f32 v63, v63
  v_cvt_pk_bf16_f32 v78, v60, v61
  v_cvt_pk_bf16_f32 v79, v62, v63
  v_mfma_f32_32x32x16_bf16 v[48:63], a[0:3], v[184:187], 0
  s_add_u32 s88, s87, 0
  buffer_load_dwordx4 a[128:131], v1, s[40:43], s88 offen offset:0 sc1
  buffer_load_dwordx4 a[132:135], v1, s[40:43], s88 offen offset:1024 sc1
  buffer_load_dwordx4 a[136:139], v1, s[40:43], s88 offen offset:2048 sc1
  buffer_load_dwordx4 a[140:143], v1, s[40:43], s88 offen offset:3072 sc1
  v_exp_f32 v32, v32
  v_exp_f32 v33, v33
  v_exp_f32 v34, v34
  v_exp_f32 v35, v35
  v_cvt_pk_bf16_f32 v64, v32, v33
  v_mfma_f32_32x32x16_bf16 v[48:63], a[4:7], v[188:191], v[48:63]
  v_exp_f32 v36, v36
  v_exp_f32 v37, v37
  v_cvt_pk_bf16_f32 v65, v34, v35
  v_exp_f32 v38, v38
  v_exp_f32 v39, v39
  v_cvt_pk_bf16_f32 v66, v36, v37
  v_mfma_f32_32x32x16_bf16 v[112:127], a[8:11], v[72:75], v[112:127]
  v_exp_f32 v40, v40
  v_exp_f32 v41, v41
  v_cvt_pk_bf16_f32 v67, v38, v39
  v_exp_f32 v42, v42
  v_exp_f32 v43, v43
  v_cvt_pk_bf16_f32 v68, v40, v41
  v_mfma_f32_32x32x16_bf16 v[112:127], a[12:15], v[76:79], v[112:127]
  v_exp_f32 v44, v44
  v_exp_f32 v45, v45
  v_cvt_pk_bf16_f32 v69, v42, v43
  v_exp_f32 v46, v46
  v_exp_f32 v47, v47
  v_cvt_pk_bf16_f32 v70, v44, v45
  v_cvt_pk_bf16_f32 v71, v46, v47
  v_mfma_f32_32x32x16_bf16 v[32:47], a[16:19], v[160:163], 0
  s_add_u32 s88, s87, 4096
  buffer_load_dwordx4 a[144:147], v1, s[40:43], s88 offen offset:0 sc1
  buffer_load_dwordx4 a[148:151], v1, s[40:43], s88 offen offset:1024 sc1
  buffer_load_dwordx4 a[152:155], v1, s[40:43], s88 offen offset:2048 sc1
  buffer_load_dwordx4 a[156:159], v1, s[40:43], s88 offen offset:3072 sc1
  v_exp_f32 v48, v48
  v_exp_f32 v49, v49
  v_exp_f32 v50, v50
  v_exp_f32 v51, v51
  v_cvt_pk_bf16_f32 v72, v48, v49
  v_mfma_f32_32x32x16_bf16 v[32:47], a[20:23], v[164:167], v[32:47]
  v_exp_f32 v52, v52
  v_exp_f32 v53, v53
  v_cvt_pk_bf16_f32 v73, v50, v51
  v_exp_f32 v54, v54
  v_exp_f32 v55, v55
  v_cvt_pk_bf16_f32 v74, v52, v53
  v_mfma_f32_32x32x16_bf16 v[128:143], a[8:11], v[64:67], v[128:143]
  v_exp_f32 v56, v56
  v_exp_f32 v57, v57
  v_cvt_pk_bf16_f32 v75, v54, v55
  v_exp_f32 v58, v58
  v_exp_f32 v59, v59
  v_cvt_pk_bf16_f32 v76, v56, v57
  v_mfma_f32_32x32x16_bf16 v[128:143], a[12:15], v[68:71], v[128:143]
  v_exp_f32 v60, v60
  v_exp_f32 v61, v61
  v_cvt_pk_bf16_f32 v77, v58, v59
  v_exp_f32 v62, v62
  v_exp_f32 v63, v63
  v_cvt_pk_bf16_f32 v78, v60, v61
  v_cvt_pk_bf16_f32 v79, v62, v63
  v_mfma_f32_32x32x16_bf16 v[48:63], a[16:19], v[168:171], 0
  s_add_u32 s88, s87, 8192
  buffer_load_dwordx4 a[160:163], v1, s[40:43], s88 offen offset:0 sc1
  buffer_load_dwordx4 a[164:167], v1, s[40:43], s88 offen offset:1024 sc1
  buffer_load_dwordx4 a[168:171], v1, s[40:43], s88 offen offset:2048 sc1
  buffer_load_dwordx4 a[172:175], v1, s[40:43], s88 offen offset:3072 sc1
  v_exp_f32 v32, v32
  v_exp_f32 v33, v33
  v_exp_f32 v34, v34
  v_exp_f32 v35, v35
  v_cvt_pk_bf16_f32 v64, v32, v33
  v_mfma_f32_32x32x16_bf16 v[48:63], a[20:23], v[172:175], v[48:63]
  v_exp_f32 v36, v36
  v_exp_f32 v37, v37
  v_cvt_pk_bf16_f32 v65, v34, v35
  v_exp_f32 v38, v38
  v_exp_f32 v39, v39
  v_cvt_pk_bf16_f32 v66, v36, v37
  v_mfma_f32_32x32x16_bf16 v[144:159], a[8:11], v[72:75], v[144:159]
  v_exp_f32 v40, v40
  v_exp_f32 v41, v41
  v_cvt_pk_bf16_f32 v67, v38, v39
  v_exp_f32 v42, v42
  v_exp_f32 v43, v43
  v_cvt_pk_bf16_f32 v68, v40, v41
  v_mfma_f32_32x32x16_bf16 v[144:159], a[12:15], v[76:79], v[144:159]
  v_exp_f32 v44, v44
  v_exp_f32 v45, v45
  v_cvt_pk_bf16_f32 v69, v42, v43
  v_exp_f32 v46, v46
  v_exp_f32 v47, v47
  v_cvt_pk_bf16_f32 v70, v44, v45
  v_cvt_pk_bf16_f32 v71, v46, v47
  v_mfma_f32_32x32x16_bf16 v[32:47], a[16:19], v[176:179], 0
  v_exp_f32 v48, v48
  v_exp_f32 v49, v49
  v_exp_f32 v50, v50
  v_exp_f32 v51, v51
  v_cvt_pk_bf16_f32 v72, v48, v49
  v_mfma_f32_32x32x16_bf16 v[32:47], a[20:23], v[180:183], v[32:47]
  s_add_u32 s65, s80, 49152
  buffer_load_dwordx4 a[0:3], v1, s[40:43], s65 offen offset:0 sc1
  buffer_load_dwordx4 a[4:7], v1, s[40:43], s65 offen offset:1024 sc1
  buffer_load_dwordx4 a[8:11], v1, s[40:43], s65 offen offset:2048 sc1
  buffer_load_dwordx4 a[12:15], v1, s[40:43], s65 offen offset:3072 sc1
  v_exp_f32 v52, v52
  v_exp_f32 v53, v53
  v_cvt_pk_bf16_f32 v73, v50, v51
  v_exp_f32 v54, v54
  v_exp_f32 v55, v55
  v_cvt_pk_bf16_f32 v74, v52, v53
  v_mfma_f32_32x32x16_bf16 v[96:111], a[24:27], v[64:67], v[96:111]
  v_exp_f32 v56, v56
  v_exp_f32 v57, v57
  v_cvt_pk_bf16_f32 v75, v54, v55
  v_exp_f32 v58, v58
  v_exp_f32 v59, v59
  v_cvt_pk_bf16_f32 v76, v56, v57
  v_mfma_f32_32x32x16_bf16 v[96:111], a[28:31], v[68:71], v[96:111]
  v_exp_f32 v60, v60
  v_exp_f32 v61, v61
  v_cvt_pk_bf16_f32 v77, v58, v59
  v_exp_f32 v62, v62
  v_exp_f32 v63, v63
  v_cvt_pk_bf16_f32 v78, v60, v61
  v_cvt_pk_bf16_f32 v79, v62, v63
  v_mfma_f32_32x32x16_bf16 v[48:63], a[16:19], v[184:187], 0
  s_add_u32 s88, s87, 12288
  buffer_load_dwordx4 a[176:179], v1, s[40:43], s88 offen offset:0 sc1
  buffer_load_dwordx4 a[180:183], v1, s[40:43], s88 offen offset:1024 sc1
  buffer_load_dwordx4 a[184:187], v1, s[40:43], s88 offen offset:2048 sc1
  buffer_load_dwordx4 a[188:191], v1, s[40:43], s88 offen offset:3072 sc1
  v_exp_f32 v32, v32
  v_exp_f32 v33, v33
  v_exp_f32 v34, v34
  v_exp_f32 v35, v35
  v_cvt_pk_bf16_f32 v64, v32, v33
  v_mfma_f32_32x32x16_bf16 v[48:63], a[20:23], v[188:191], v[48:63]
  v_exp_f32 v36, v36
  v_exp_f32 v37, v37
  v_cvt_pk_bf16_f32 v65, v34, v35
  v_exp_f32 v38, v38
  v_exp_f32 v39, v39
  v_cvt_pk_bf16_f32 v66, v36, v37
  v_mfma_f32_32x32x16_bf16 v[112:127], a[24:27], v[72:75], v[112:127]
  v_exp_f32 v40, v40
  v_exp_f32 v41, v41
  v_cvt_pk_bf16_f32 v67, v38, v39
  v_exp_f32 v42, v42
  v_exp_f32 v43, v43
  v_cvt_pk_bf16_f32 v68, v40, v41
  v_mfma_f32_32x32x16_bf16 v[112:127], a[28:31], v[76:79], v[112:127]
  v_exp_f32 v44, v44
  v_exp_f32 v45, v45
  v_cvt_pk_bf16_f32 v69, v42, v43
  v_exp_f32 v46, v46
  v_exp_f32 v47, v47
  v_cvt_pk_bf16_f32 v70, v44, v45
  v_cvt_pk_bf16_f32 v71, v46, v47
  s_waitcnt vmcnt(24)
  v_mfma_f32_32x32x16_bf16 v[32:47], a[32:35], v[160:163], 0
  s_add_u32 s88, s87, 16384
  buffer_load_dwordx4 a[192:195], v1, s[40:43], s88 offen offset:0 sc1
  buffer_load_dwordx4 a[196:199], v1, s[40:43], s88 offen offset:1024 sc1
  buffer_load_dwordx4 a[200:203], v1, s[40:43], s88 offen offset:2048 sc1
  buffer_load_dwordx4 a[204:207], v1, s[40:43], s88 offen offset:3072 sc1
  v_exp_f32 v48, v48
  v_exp_f32 v49, v49
  v_exp_f32 v50, v50
  v_exp_f32 v51, v51
  v_cvt_pk_bf16_f32 v72, v48, v49
  v_mfma_f32_32x32x16_bf16 v[32:47], a[36:39], v[164:167], v[32:47]
  v_exp_f32 v52, v52
  v_exp_f32 v53, v53
  v_cvt_pk_bf16_f32 v73, v50, v51
  v_exp_f32 v54, v54
  v_exp_f32 v55, v55
  v_cvt_pk_bf16_f32 v74, v52, v53
  v_mfma_f32_32x32x16_bf16 v[128:143], a[24:27], v[64:67], v[128:143]
  v_exp_f32 v56, v56
  v_exp_f32 v57, v57
  v_cvt_pk_bf16_f32 v75, v54, v55
  v_exp_f32 v58, v58
  v_exp_f32 v59, v59
  v_cvt_pk_bf16_f32 v76, v56, v57
  v_mfma_f32_32x32x16_bf16 v[128:143], a[28:31], v[68:71], v[128:143]
  v_exp_f32 v60, v60
  v_exp_f32 v61, v61
  v_cvt_pk_bf16_f32 v77, v58, v59
  v_exp_f32 v62, v62
  v_exp_f32 v63, v63
  v_cvt_pk_bf16_f32 v78, v60, v61
  v_cvt_pk_bf16_f32 v79, v62, v63
  v_mfma_f32_32x32x16_bf16 v[48:63], a[32:35], v[168:171], 0
  s_add_u32 s88, s87, 20480
  buffer_load_dwordx4 a[208:211], v1, s[40:43], s88 offen offset:0 sc1
  buffer_load_dwordx4 a[212:215], v1, s[40:43], s88 offen offset:1024 sc1
  buffer_load_dwordx4 a[216:219], v1, s[40:43], s88 offen offset:2048 sc1
  buffer_load_dwordx4 a[220:223], v1, s[40:43], s88 offen offset:3072 sc1
  v_exp_f32 v32, v32
  v_exp_f32 v33, v33
  v_exp_f32 v34, v34
  v_exp_f32 v35, v35
  v_cvt_pk_bf16_f32 v64, v32, v33
  v_mfma_f32_32x32x16_bf16 v[48:63], a[36:39], v[172:175], v[48:63]
  v_exp_f32 v36, v36
  v_exp_f32 v37, v37
  v_cvt_pk_bf16_f32 v65, v34, v35
  v_exp_f32 v38, v38
  v_exp_f32 v39, v39
  v_cvt_pk_bf16_f32 v66, v36, v37
  v_mfma_f32_32x32x16_bf16 v[144:159], a[24:27], v[72:75], v[144:159]
  v_exp_f32 v40, v40
  v_exp_f32 v41, v41
  v_cvt_pk_bf16_f32 v67, v38, v39
  v_exp_f32 v42, v42
  v_exp_f32 v43, v43
  v_cvt_pk_bf16_f32 v68, v40, v41
  v_mfma_f32_32x32x16_bf16 v[144:159], a[28:31], v[76:79], v[144:159]
  v_exp_f32 v44, v44
  v_exp_f32 v45, v45
  v_cvt_pk_bf16_f32 v69, v42, v43
  v_exp_f32 v46, v46
  v_exp_f32 v47, v47
  v_cvt_pk_bf16_f32 v70, v44, v45
  v_cvt_pk_bf16_f32 v71, v46, v47
  v_mfma_f32_32x32x16_bf16 v[32:47], a[32:35], v[176:179], 0
  v_exp_f32 v48, v48
  v_exp_f32 v49, v49
  v_exp_f32 v50, v50
  v_exp_f32 v51, v51
  v_cvt_pk_bf16_f32 v72, v48, v49
  v_mfma_f32_32x32x16_bf16 v[32:47], a[36:39], v[180:183], v[32:47]
  s_add_u32 s65, s80, 53248
  buffer_load_dwordx4 a[16:19], v1, s[40:43], s65 offen offset:0 sc1
  buffer_load_dwordx4 a[20:23], v1, s[40:43], s65 offen offset:1024 sc1
  buffer_load_dwordx4 a[24:27], v1, s[40:43], s65 offen offset:2048 sc1
  buffer_load_dwordx4 a[28:31], v1, s[40:43], s65 offen offset:3072 sc1
  v_exp_f32 v52, v52
  v_exp_f32 v53, v53
  v_cvt_pk_bf16_f32 v73, v50, v51
  v_exp_f32 v54, v54
  v_exp_f32 v55, v55
  v_cvt_pk_bf16_f32 v74, v52, v53
  v_mfma_f32_32x32x16_bf16 v[96:111], a[40:43], v[64:67], v[96:111]
  v_exp_f32 v56, v56
  v_exp_f32 v57, v57
  v_cvt_pk_bf16_f32 v75, v54, v55
  v_exp_f32 v58, v58
  v_exp_f32 v59, v59
  v_cvt_pk_bf16_f32 v76, v56, v57
  v_mfma_f32_32x32x16_bf16 v[96:111], a[44:47], v[68:71], v[96:111]
  v_exp_f32 v60, v60
  v_exp_f32 v61, v61
  v_cvt_pk_bf16_f32 v77, v58, v59
  v_exp_f32 v62, v62
  v_exp_f32 v63, v63
  v_cvt_pk_bf16_f32 v78, v60, v61
  v_cvt_pk_bf16_f32 v79, v62, v63
  v_mfma_f32_32x32x16_bf16 v[48:63], a[32:35], v[184:187], 0
  s_add_u32 s88, s87, 24576
  buffer_load_dwordx4 a[224:227], v1, s[40:43], s88 offen offset:0 sc1
  buffer_load_dwordx4 a[228:231], v1, s[40:43], s88 offen offset:1024 sc1
  buffer_load_dwordx4 a[232:235], v1, s[40:43], s88 offen offset:2048 sc1
  buffer_load_dwordx4 a[236:239], v1, s[40:43], s88 offen offset:3072 sc1
  v_exp_f32 v32, v32
  v_exp_f32 v33, v33
  v_exp_f32 v34, v34
  v_exp_f32 v35, v35
  v_cvt_pk_bf16_f32 v64, v32, v33
  v_mfma_f32_32x32x16_bf16 v[48:63], a[36:39], v[188:191], v[48:63]
  v_exp_f32 v36, v36
  v_exp_f32 v37, v37
  v_cvt_pk_bf16_f32 v65, v34, v35
  v_exp_f32 v38, v38
  v_exp_f32 v39, v39
  v_cvt_pk_bf16_f32 v66, v36, v37
  v_mfma_f32_32x32x16_bf16 v[112:127], a[40:43], v[72:75], v[112:127]
  v_exp_f32 v40, v40
  v_exp_f32 v41, v41
  v_cvt_pk_bf16_f32 v67, v38, v39
  v_exp_f32 v42, v42
  v_exp_f32 v43, v43
  v_cvt_pk_bf16_f32 v68, v40, v41
  v_mfma_f32_32x32x16_bf16 v[112:127], a[44:47], v[76:79], v[112:127]
  v_exp_f32 v44, v44
  v_exp_f32 v45, v45
  v_cvt_pk_bf16_f32 v69, v42, v43
  v_exp_f32 v46, v46
  v_exp_f32 v47, v47
  v_cvt_pk_bf16_f32 v70, v44, v45
  v_cvt_pk_bf16_f32 v71, v46, v47
  s_waitcnt vmcnt(36)
  v_mfma_f32_32x32x16_bf16 v[32:47], a[48:51], v[160:163], 0
  s_add_u32 s88, s87, 28672
  buffer_load_dwordx4 a[240:243], v1, s[40:43], s88 offen offset:0 sc1
  buffer_load_dwordx4 a[244:247], v1, s[40:43], s88 offen offset:1024 sc1
  buffer_load_dwordx4 a[248:251], v1, s[40:43], s88 offen offset:2048 sc1
  buffer_load_dwordx4 a[252:255], v1, s[40:43], s88 offen offset:3072 sc1
  v_exp_f32 v48, v48
  v_exp_f32 v49, v49
  v_exp_f32 v50, v50
  v_exp_f32 v51, v51
  v_cvt_pk_bf16_f32 v72, v48, v49
  v_mfma_f32_32x32x16_bf16 v[32:47], a[52:55], v[164:167], v[32:47]
  v_exp_f32 v52, v52
  v_exp_f32 v53, v53
  v_cvt_pk_bf16_f32 v73, v50, v51
  v_exp_f32 v54, v54
  v_exp_f32 v55, v55
  v_cvt_pk_bf16_f32 v74, v52, v53
  v_mfma_f32_32x32x16_bf16 v[128:143], a[40:43], v[64:67], v[128:143]
  v_exp_f32 v56, v56
  v_exp_f32 v57, v57
  v_cvt_pk_bf16_f32 v75, v54, v55
  v_exp_f32 v58, v58
  v_exp_f32 v59, v59
  v_cvt_pk_bf16_f32 v76, v56, v57
  v_mfma_f32_32x32x16_bf16 v[128:143], a[44:47], v[68:71], v[128:143]
  v_exp_f32 v60, v60
  v_exp_f32 v61, v61
  v_cvt_pk_bf16_f32 v77, v58, v59
  v_exp_f32 v62, v62
  v_exp_f32 v63, v63
  v_cvt_pk_bf16_f32 v78, v60, v61
  v_cvt_pk_bf16_f32 v79, v62, v63
  v_mfma_f32_32x32x16_bf16 v[48:63], a[48:51], v[168:171], 0
  s_add_u32 s88, s87, 524288
  buffer_load_dwordx4 a[64:67], v1, s[40:43], s88 offen offset:0 sc1
  buffer_load_dwordx4 a[68:71], v1, s[40:43], s88 offen offset:1024 sc1
  buffer_load_dwordx4 a[72:75], v1, s[40:43], s88 offen offset:2048 sc1
  buffer_load_dwordx4 a[76:79], v1, s[40:43], s88 offen offset:3072 sc1
  v_exp_f32 v32, v32
  v_exp_f32 v33, v33
  v_exp_f32 v34, v34
  v_exp_f32 v35, v35
  v_cvt_pk_bf16_f32 v64, v32, v33
  v_mfma_f32_32x32x16_bf16 v[48:63], a[52:55], v[172:175], v[48:63]
  v_exp_f32 v36, v36
  v_exp_f32 v37, v37
  v_cvt_pk_bf16_f32 v65, v34, v35
  v_exp_f32 v38, v38
  v_exp_f32 v39, v39
  v_cvt_pk_bf16_f32 v66, v36, v37
  v_mfma_f32_32x32x16_bf16 v[144:159], a[40:43], v[72:75], v[144:159]
  v_exp_f32 v40, v40
  v_exp_f32 v41, v41
  v_cvt_pk_bf16_f32 v67, v38, v39
  v_exp_f32 v42, v42
  v_exp_f32 v43, v43
  v_cvt_pk_bf16_f32 v68, v40, v41
  v_mfma_f32_32x32x16_bf16 v[144:159], a[44:47], v[76:79], v[144:159]
  v_exp_f32 v44, v44
  v_exp_f32 v45, v45
  v_cvt_pk_bf16_f32 v69, v42, v43
  v_exp_f32 v46, v46
  v_exp_f32 v47, v47
  v_cvt_pk_bf16_f32 v70, v44, v45
  v_cvt_pk_bf16_f32 v71, v46, v47
  v_mfma_f32_32x32x16_bf16 v[32:47], a[48:51], v[176:179], 0
  v_exp_f32 v48, v48
  v_exp_f32 v49, v49
  v_exp_f32 v50, v50
  v_exp_f32 v51, v51
  v_cvt_pk_bf16_f32 v72, v48, v49
  v_mfma_f32_32x32x16_bf16 v[32:47], a[52:55], v[180:183], v[32:47]
  s_add_u32 s65, s80, 57344
  buffer_load_dwordx4 a[32:35], v1, s[40:43], s65 offen offset:0 sc1
  buffer_load_dwordx4 a[36:39], v1, s[40:43], s65 offen offset:1024 sc1
  buffer_load_dwordx4 a[40:43], v1, s[40:43], s65 offen offset:2048 sc1
  buffer_load_dwordx4 a[44:47], v1, s[40:43], s65 offen offset:3072 sc1
  v_exp_f32 v52, v52
  v_exp_f32 v53, v53
  v_cvt_pk_bf16_f32 v73, v50, v51
  v_exp_f32 v54, v54
  v_exp_f32 v55, v55
  v_cvt_pk_bf16_f32 v74, v52, v53
  v_mfma_f32_32x32x16_bf16 v[96:111], a[56:59], v[64:67], v[96:111]
  v_exp_f32 v56, v56
  v_exp_f32 v57, v57
  v_cvt_pk_bf16_f32 v75, v54, v55
  v_exp_f32 v58, v58
  v_exp_f32 v59, v59
  v_cvt_pk_bf16_f32 v76, v56, v57
  v_mfma_f32_32x32x16_bf16 v[96:111], a[60:63], v[68:71], v[96:111]
  v_exp_f32 v60, v60
  v_exp_f32 v61, v61
  v_cvt_pk_bf16_f32 v77, v58, v59
  v_exp_f32 v62, v62
  v_exp_f32 v63, v63
  v_cvt_pk_bf16_f32 v78, v60, v61
  v_cvt_pk_bf16_f32 v79, v62, v63
  v_mfma_f32_32x32x16_bf16 v[48:63], a[48:51], v[184:187], 0
  s_add_u32 s88, s87, 528384
  buffer_load_dwordx4 a[80:83], v1, s[40:43], s88 offen offset:0 sc1
  buffer_load_dwordx4 a[84:87], v1, s[40:43], s88 offen offset:1024 sc1
  buffer_load_dwordx4 a[88:91], v1, s[40:43], s88 offen offset:2048 sc1
  buffer_load_dwordx4 a[92:95], v1, s[40:43], s88 offen offset:3072 sc1
  v_exp_f32 v32, v32
  v_exp_f32 v33, v33
  v_exp_f32 v34, v34
  v_exp_f32 v35, v35
  v_cvt_pk_bf16_f32 v64, v32, v33
  v_mfma_f32_32x32x16_bf16 v[48:63], a[52:55], v[188:191], v[48:63]
  v_exp_f32 v36, v36
  v_exp_f32 v37, v37
  v_cvt_pk_bf16_f32 v65, v34, v35
  v_exp_f32 v38, v38
  v_exp_f32 v39, v39
  v_cvt_pk_bf16_f32 v66, v36, v37
  v_mfma_f32_32x32x16_bf16 v[112:127], a[56:59], v[72:75], v[112:127]
  v_exp_f32 v40, v40
  v_exp_f32 v41, v41
  v_cvt_pk_bf16_f32 v67, v38, v39
  v_exp_f32 v42, v42
  v_exp_f32 v43, v43
  v_cvt_pk_bf16_f32 v68, v40, v41
  v_mfma_f32_32x32x16_bf16 v[112:127], a[60:63], v[76:79], v[112:127]
  v_exp_f32 v44, v44
  v_exp_f32 v45, v45
  v_cvt_pk_bf16_f32 v69, v42, v43
  v_exp_f32 v46, v46
  v_exp_f32 v47, v47
  v_cvt_pk_bf16_f32 v70, v44, v45
  v_cvt_pk_bf16_f32 v71, v46, v47
  s_waitcnt vmcnt(36)
  v_mfma_f32_32x32x16_bf16 v[32:47], a[0:3], v[160:163], 0
  s_add_u32 s88, s87, 532480
  buffer_load_dwordx4 a[96:99], v1, s[40:43], s88 offen offset:0 sc1
  buffer_load_dwordx4 a[100:103], v1, s[40:43], s88 offen offset:1024 sc1
  buffer_load_dwordx4 a[104:107], v1, s[40:43], s88 offen offset:2048 sc1
  buffer_load_dwordx4 a[108:111], v1, s[40:43], s88 offen offset:3072 sc1
  v_exp_f32 v48, v48
  v_exp_f32 v49, v49
  v_exp_f32 v50, v50
  v_exp_f32 v51, v51
  v_cvt_pk_bf16_f32 v72, v48, v49
  v_mfma_f32_32x32x16_bf16 v[32:47], a[4:7], v[164:167], v[32:47]
  v_exp_f32 v52, v52
  v_exp_f32 v53, v53
  v_cvt_pk_bf16_f32 v73, v50, v51
  v_exp_f32 v54, v54
  v_exp_f32 v55, v55
  v_cvt_pk_bf16_f32 v74, v52, v53
  v_mfma_f32_32x32x16_bf16 v[128:143], a[56:59], v[64:67], v[128:143]
  v_exp_f32 v56, v56
  v_exp_f32 v57, v57
  v_cvt_pk_bf16_f32 v75, v54, v55
  v_exp_f32 v58, v58
  v_exp_f32 v59, v59
  v_cvt_pk_bf16_f32 v76, v56, v57
  v_mfma_f32_32x32x16_bf16 v[128:143], a[60:63], v[68:71], v[128:143]
  v_exp_f32 v60, v60
  v_exp_f32 v61, v61
  v_cvt_pk_bf16_f32 v77, v58, v59
  v_exp_f32 v62, v62
  v_exp_f32 v63, v63
  v_cvt_pk_bf16_f32 v78, v60, v61
  v_cvt_pk_bf16_f32 v79, v62, v63
  v_mfma_f32_32x32x16_bf16 v[48:63], a[0:3], v[168:171], 0
  s_add_u32 s88, s87, 536576
  buffer_load_dwordx4 a[112:115], v1, s[40:43], s88 offen offset:0 sc1
  buffer_load_dwordx4 a[116:119], v1, s[40:43], s88 offen offset:1024 sc1
  buffer_load_dwordx4 a[120:123], v1, s[40:43], s88 offen offset:2048 sc1
  buffer_load_dwordx4 a[124:127], v1, s[40:43], s88 offen offset:3072 sc1
  v_exp_f32 v32, v32
  v_exp_f32 v33, v33
  v_exp_f32 v34, v34
  v_exp_f32 v35, v35
  v_cvt_pk_bf16_f32 v64, v32, v33
  v_mfma_f32_32x32x16_bf16 v[48:63], a[4:7], v[172:175], v[48:63]
  v_exp_f32 v36, v36
  v_exp_f32 v37, v37
  v_cvt_pk_bf16_f32 v65, v34, v35
  v_exp_f32 v38, v38
  v_exp_f32 v39, v39
  v_cvt_pk_bf16_f32 v66, v36, v37
  v_mfma_f32_32x32x16_bf16 v[144:159], a[56:59], v[72:75], v[144:159]
  v_exp_f32 v40, v40
  v_exp_f32 v41, v41
  v_cvt_pk_bf16_f32 v67, v38, v39
  v_exp_f32 v42, v42
  v_exp_f32 v43, v43
  v_cvt_pk_bf16_f32 v68, v40, v41
  v_mfma_f32_32x32x16_bf16 v[144:159], a[60:63], v[76:79], v[144:159]
  v_exp_f32 v44, v44
  v_exp_f32 v45, v45
  v_cvt_pk_bf16_f32 v69, v42, v43
  v_exp_f32 v46, v46
  v_exp_f32 v47, v47
  v_cvt_pk_bf16_f32 v70, v44, v45
  v_cvt_pk_bf16_f32 v71, v46, v47
  v_mfma_f32_32x32x16_bf16 v[32:47], a[0:3], v[176:179], 0
  v_exp_f32 v48, v48
  v_exp_f32 v49, v49
  v_exp_f32 v50, v50
  v_exp_f32 v51, v51
  v_cvt_pk_bf16_f32 v72, v48, v49
  v_mfma_f32_32x32x16_bf16 v[32:47], a[4:7], v[180:183], v[32:47]
  s_add_u32 s65, s80, 61440
  buffer_load_dwordx4 a[48:51], v1, s[40:43], s65 offen offset:0 sc1
  buffer_load_dwordx4 a[52:55], v1, s[40:43], s65 offen offset:1024 sc1
  buffer_load_dwordx4 a[56:59], v1, s[40:43], s65 offen offset:2048 sc1
  buffer_load_dwordx4 a[60:63], v1, s[40:43], s65 offen offset:3072 sc1
  v_exp_f32 v52, v52
  v_exp_f32 v53, v53
  v_cvt_pk_bf16_f32 v73, v50, v51
  v_exp_f32 v54, v54
  v_exp_f32 v55, v55
  v_cvt_pk_bf16_f32 v74, v52, v53
  v_mfma_f32_32x32x16_bf16 v[96:111], a[8:11], v[64:67], v[96:111]
  v_exp_f32 v56, v56
  v_exp_f32 v57, v57
  v_cvt_pk_bf16_f32 v75, v54, v55
  v_exp_f32 v58, v58
  v_exp_f32 v59, v59
  v_cvt_pk_bf16_f32 v76, v56, v57
  v_mfma_f32_32x32x16_bf16 v[96:111], a[12:15], v[68:71], v[96:111]
  v_exp_f32 v60, v60
  v_exp_f32 v61, v61
  v_cvt_pk_bf16_f32 v77, v58, v59
  v_exp_f32 v62, v62
  v_exp_f32 v63, v63
  v_cvt_pk_bf16_f32 v78, v60, v61
  v_cvt_pk_bf16_f32 v79, v62, v63
  v_mfma_f32_32x32x16_bf16 v[48:63], a[0:3], v[184:187], 0
  v_exp_f32 v32, v32
  v_exp_f32 v33, v33
  v_exp_f32 v34, v34
  v_exp_f32 v35, v35
  v_cvt_pk_bf16_f32 v64, v32, v33
  v_mfma_f32_32x32x16_bf16 v[48:63], a[4:7], v[188:191], v[48:63]
  v_exp_f32 v36, v36
  v_exp_f32 v37, v37
  v_cvt_pk_bf16_f32 v65, v34, v35
  v_exp_f32 v38, v38
  v_exp_f32 v39, v39
  v_cvt_pk_bf16_f32 v66, v36, v37
  v_mfma_f32_32x32x16_bf16 v[112:127], a[8:11], v[72:75], v[112:127]
  v_exp_f32 v40, v40
  v_exp_f32 v41, v41
  v_cvt_pk_bf16_f32 v67, v38, v39
  v_exp_f32 v42, v42
  v_exp_f32 v43, v43
  v_cvt_pk_bf16_f32 v68, v40, v41
  v_mfma_f32_32x32x16_bf16 v[112:127], a[12:15], v[76:79], v[112:127]
  v_exp_f32 v44, v44
  v_exp_f32 v45, v45
  v_cvt_pk_bf16_f32 v69, v42, v43
  v_exp_f32 v46, v46
  v_exp_f32 v47, v47
  v_cvt_pk_bf16_f32 v70, v44, v45
  v_cvt_pk_bf16_f32 v71, v46, v47
  s_waitcnt vmcnt(32)
  v_mfma_f32_32x32x16_bf16 v[32:47], a[16:19], v[160:163], 0
  v_exp_f32 v48, v48
  v_exp_f32 v49, v49
  v_exp_f32 v50, v50
  v_exp_f32 v51, v51
  v_cvt_pk_bf16_f32 v72, v48, v49
  v_mfma_f32_32x32x16_bf16 v[32:47], a[20:23], v[164:167], v[32:47]
  v_exp_f32 v52, v52
  v_exp_f32 v53, v53
  v_cvt_pk_bf16_f32 v73, v50, v51
  v_exp_f32 v54, v54
  v_exp_f32 v55, v55
  v_cvt_pk_bf16_f32 v74, v52, v53
  v_mfma_f32_32x32x16_bf16 v[128:143], a[8:11], v[64:67], v[128:143]
  v_exp_f32 v56, v56
  v_exp_f32 v57, v57
  v_cvt_pk_bf16_f32 v75, v54, v55
  v_exp_f32 v58, v58
  v_exp_f32 v59, v59
  v_cvt_pk_bf16_f32 v76, v56, v57
  v_mfma_f32_32x32x16_bf16 v[128:143], a[12:15], v[68:71], v[128:143]
  v_exp_f32 v60, v60
  v_exp_f32 v61, v61
  v_cvt_pk_bf16_f32 v77, v58, v59
  v_exp_f32 v62, v62
  v_exp_f32 v63, v63
  v_cvt_pk_bf16_f32 v78, v60, v61
  v_cvt_pk_bf16_f32 v79, v62, v63
  v_mfma_f32_32x32x16_bf16 v[48:63], a[16:19], v[168:171], 0
  v_exp_f32 v32, v32
  v_exp_f32 v33, v33
  v_exp_f32 v34, v34
  v_exp_f32 v35, v35
  v_cvt_pk_bf16_f32 v64, v32, v33
  v_mfma_f32_32x32x16_bf16 v[48:63], a[20:23], v[172:175], v[48:63]
  v_exp_f32 v36, v36
  v_exp_f32 v37, v37
  v_cvt_pk_bf16_f32 v65, v34, v35
  v_exp_f32 v38, v38
  v_exp_f32 v39, v39
  v_cvt_pk_bf16_f32 v66, v36, v37
  v_mfma_f32_32x32x16_bf16 v[144:159], a[8:11], v[72:75], v[144:159]
  v_exp_f32 v40, v40
  v_exp_f32 v41, v41
  v_cvt_pk_bf16_f32 v67, v38, v39
  v_exp_f32 v42, v42
  v_exp_f32 v43, v43
  v_cvt_pk_bf16_f32 v68, v40, v41
  v_mfma_f32_32x32x16_bf16 v[144:159], a[12:15], v[76:79], v[144:159]
  v_exp_f32 v44, v44
  v_exp_f32 v45, v45
  v_cvt_pk_bf16_f32 v69, v42, v43
  v_exp_f32 v46, v46
  v_exp_f32 v47, v47
  v_cvt_pk_bf16_f32 v70, v44, v45
  v_cvt_pk_bf16_f32 v71, v46, v47
  v_mfma_f32_32x32x16_bf16 v[32:47], a[16:19], v[176:179], 0
  v_exp_f32 v48, v48
  v_exp_f32 v49, v49
  v_exp_f32 v50, v50
  v_exp_f32 v51, v51
  v_cvt_pk_bf16_f32 v72, v48, v49
  v_mfma_f32_32x32x16_bf16 v[32:47], a[20:23], v[180:183], v[32:47]
  v_exp_f32 v52, v52
  v_exp_f32 v53, v53
  v_cvt_pk_bf16_f32 v73, v50, v51
  v_exp_f32 v54, v54
  v_exp_f32 v55, v55
  v_cvt_pk_bf16_f32 v74, v52, v53
  v_mfma_f32_32x32x16_bf16 v[96:111], a[24:27], v[64:67], v[96:111]
  v_exp_f32 v56, v56
  v_exp_f32 v57, v57
  v_cvt_pk_bf16_f32 v75, v54, v55
  v_exp_f32 v58, v58
  v_exp_f32 v59, v59
  v_cvt_pk_bf16_f32 v76, v56, v57
  v_mfma_f32_32x32x16_bf16 v[96:111], a[28:31], v[68:71], v[96:111]
  v_exp_f32 v60, v60
  v_exp_f32 v61, v61
  v_cvt_pk_bf16_f32 v77, v58, v59
  v_exp_f32 v62, v62
  v_exp_f32 v63, v63
  v_cvt_pk_bf16_f32 v78, v60, v61
  v_cvt_pk_bf16_f32 v79, v62, v63
  v_mfma_f32_32x32x16_bf16 v[48:63], a[16:19], v[184:187], 0
  s_add_u32 s88, s87, 540672
  buffer_load_dwordx4 a[0:3], v1, s[40:43], s88 offen offset:0 sc1
  buffer_load_dwordx4 a[4:7], v1, s[40:43], s88 offen offset:1024 sc1
  buffer_load_dwordx4 a[8:11], v1, s[40:43], s88 offen offset:2048 sc1
  buffer_load_dwordx4 a[12:15], v1, s[40:43], s88 offen offset:3072 sc1
  v_exp_f32 v32, v32
  v_exp_f32 v33, v33
  v_exp_f32 v34, v34
  v_exp_f32 v35, v35
  v_cvt_pk_bf16_f32 v64, v32, v33
  v_mfma_f32_32x32x16_bf16 v[48:63], a[20:23], v[188:191], v[48:63]
  v_exp_f32 v36, v36
  v_exp_f32 v37, v37
  v_cvt_pk_bf16_f32 v65, v34, v35
  v_exp_f32 v38, v38
  v_exp_f32 v39, v39
  v_cvt_pk_bf16_f32 v66, v36, v37
  v_mfma_f32_32x32x16_bf16 v[112:127], a[24:27], v[72:75], v[112:127]
  v_exp_f32 v40, v40
  v_exp_f32 v41, v41
  v_cvt_pk_bf16_f32 v67, v38, v39
  v_exp_f32 v42, v42
  v_exp_f32 v43, v43
  v_cvt_pk_bf16_f32 v68, v40, v41
  v_mfma_f32_32x32x16_bf16 v[112:127], a[28:31], v[76:79], v[112:127]
  v_exp_f32 v44, v44
  v_exp_f32 v45, v45
  v_cvt_pk_bf16_f32 v69, v42, v43
  v_exp_f32 v46, v46
  v_exp_f32 v47, v47
  v_cvt_pk_bf16_f32 v70, v44, v45
  v_cvt_pk_bf16_f32 v71, v46, v47
  s_waitcnt vmcnt(20)
  v_mfma_f32_32x32x16_bf16 v[32:47], a[32:35], v[160:163], 0
  v_exp_f32 v48, v48
  v_exp_f32 v49, v49
  v_exp_f32 v50, v50
  v_exp_f32 v51, v51
  v_cvt_pk_bf16_f32 v72, v48, v49
  v_mfma_f32_32x32x16_bf16 v[32:47], a[36:39], v[164:167], v[32:47]
  v_exp_f32 v52, v52
  v_exp_f32 v53, v53
  v_cvt_pk_bf16_f32 v73, v50, v51
  v_exp_f32 v54, v54
  v_exp_f32 v55, v55
  v_cvt_pk_bf16_f32 v74, v52, v53
  v_mfma_f32_32x32x16_bf16 v[128:143], a[24:27], v[64:67], v[128:143]
  v_exp_f32 v56, v56
  v_exp_f32 v57, v57
  v_cvt_pk_bf16_f32 v75, v54, v55
  v_exp_f32 v58, v58
  v_exp_f32 v59, v59
  v_cvt_pk_bf16_f32 v76, v56, v57
  v_mfma_f32_32x32x16_bf16 v[128:143], a[28:31], v[68:71], v[128:143]
  v_exp_f32 v60, v60
  v_exp_f32 v61, v61
  v_cvt_pk_bf16_f32 v77, v58, v59
  v_exp_f32 v62, v62
  v_exp_f32 v63, v63
  v_cvt_pk_bf16_f32 v78, v60, v61
  v_cvt_pk_bf16_f32 v79, v62, v63
  v_mfma_f32_32x32x16_bf16 v[48:63], a[32:35], v[168:171], 0
  v_exp_f32 v32, v32
  v_exp_f32 v33, v33
  v_exp_f32 v34, v34
  v_exp_f32 v35, v35
  v_cvt_pk_bf16_f32 v64, v32, v33
  v_mfma_f32_32x32x16_bf16 v[48:63], a[36:39], v[172:175], v[48:63]
  v_exp_f32 v36, v36
  v_exp_f32 v37, v37
  v_cvt_pk_bf16_f32 v65, v34, v35
  v_exp_f32 v38, v38
  v_exp_f32 v39, v39
  v_cvt_pk_bf16_f32 v66, v36, v37
  v_mfma_f32_32x32x16_bf16 v[144:159], a[24:27], v[72:75], v[144:159]
  v_exp_f32 v40, v40
  v_exp_f32 v41, v41
  v_cvt_pk_bf16_f32 v67, v38, v39
  v_exp_f32 v42, v42
  v_exp_f32 v43, v43
  v_cvt_pk_bf16_f32 v68, v40, v41
  v_mfma_f32_32x32x16_bf16 v[144:159], a[28:31], v[76:79], v[144:159]
  v_exp_f32 v44, v44
  v_exp_f32 v45, v45
  v_cvt_pk_bf16_f32 v69, v42, v43
  v_exp_f32 v46, v46
  v_exp_f32 v47, v47
  v_cvt_pk_bf16_f32 v70, v44, v45
  v_cvt_pk_bf16_f32 v71, v46, v47
  v_mfma_f32_32x32x16_bf16 v[32:47], a[32:35], v[176:179], 0
  v_exp_f32 v48, v48
  v_exp_f32 v49, v49
  v_exp_f32 v50, v50
  v_exp_f32 v51, v51
  v_cvt_pk_bf16_f32 v72, v48, v49
  v_mfma_f32_32x32x16_bf16 v[32:47], a[36:39], v[180:183], v[32:47]
  v_exp_f32 v52, v52
  v_exp_f32 v53, v53
  v_cvt_pk_bf16_f32 v73, v50, v51
  v_exp_f32 v54, v54
  v_exp_f32 v55, v55
  v_cvt_pk_bf16_f32 v74, v52, v53
  v_mfma_f32_32x32x16_bf16 v[96:111], a[40:43], v[64:67], v[96:111]
  v_exp_f32 v56, v56
  v_exp_f32 v57, v57
  v_cvt_pk_bf16_f32 v75, v54, v55
  v_exp_f32 v58, v58
  v_exp_f32 v59, v59
  v_cvt_pk_bf16_f32 v76, v56, v57
  v_mfma_f32_32x32x16_bf16 v[96:111], a[44:47], v[68:71], v[96:111]
  v_exp_f32 v60, v60
  v_exp_f32 v61, v61
  v_cvt_pk_bf16_f32 v77, v58, v59
  v_exp_f32 v62, v62
  v_exp_f32 v63, v63
  v_cvt_pk_bf16_f32 v78, v60, v61
  v_cvt_pk_bf16_f32 v79, v62, v63
  v_mfma_f32_32x32x16_bf16 v[48:63], a[32:35], v[184:187], 0
  s_add_u32 s88, s87, 544768
  buffer_load_dwordx4 a[16:19], v1, s[40:43], s88 offen offset:0 sc1
  buffer_load_dwordx4 a[20:23], v1, s[40:43], s88 offen offset:1024 sc1
  buffer_load_dwordx4 a[24:27], v1, s[40:43], s88 offen offset:2048 sc1
  buffer_load_dwordx4 a[28:31], v1, s[40:43], s88 offen offset:3072 sc1
  v_exp_f32 v32, v32
  v_exp_f32 v33, v33
  v_exp_f32 v34, v34
  v_exp_f32 v35, v35
  v_cvt_pk_bf16_f32 v64, v32, v33
  v_mfma_f32_32x32x16_bf16 v[48:63], a[36:39], v[188:191], v[48:63]
  v_exp_f32 v36, v36
  v_exp_f32 v37, v37
  v_cvt_pk_bf16_f32 v65, v34, v35
  v_exp_f32 v38, v38
  v_exp_f32 v39, v39
  v_cvt_pk_bf16_f32 v66, v36, v37
  v_mfma_f32_32x32x16_bf16 v[112:127], a[40:43], v[72:75], v[112:127]
  v_exp_f32 v40, v40
  v_exp_f32 v41, v41
  v_cvt_pk_bf16_f32 v67, v38, v39
  v_exp_f32 v42, v42
  v_exp_f32 v43, v43
  v_cvt_pk_bf16_f32 v68, v40, v41
  v_mfma_f32_32x32x16_bf16 v[112:127], a[44:47], v[76:79], v[112:127]
  v_exp_f32 v44, v44
  v_exp_f32 v45, v45
  v_cvt_pk_bf16_f32 v69, v42, v43
  v_exp_f32 v46, v46
  v_exp_f32 v47, v47
  v_cvt_pk_bf16_f32 v70, v44, v45
  v_cvt_pk_bf16_f32 v71, v46, v47
  s_waitcnt vmcnt(8)
  v_mfma_f32_32x32x16_bf16 v[32:47], a[48:51], v[160:163], 0
  s_lshr_b32 s89, s2, 5
  s_lshl_b32 s89, s89, 3
  s_and_b32 s72, s2, 7
  s_add_u32 s89, s89, s72
  s_lshl_b32 s72, s89, 15
  s_lshl_b32 s73, s55, 13
  s_add_u32 s72, s72, s73
  s_add_u32 s83, s72, 7340032
  s_add_u32 s84, s83, 4096
  s_add_u32 s98, s73, 86016
  s_add_u32 m0, s98, 0
  s_nop 0
  buffer_load_dwordx4 v1, s[40:43], s83 offen offset:0 sc1 lds
  buffer_load_dwordx4 v1, s[40:43], s83 offen offset:1024 sc1 lds
  buffer_load_dwordx4 v1, s[40:43], s83 offen offset:2048 sc1 lds
  buffer_load_dwordx4 v1, s[40:43], s83 offen offset:3072 sc1 lds
  s_add_u32 m0, s98, 4096
  s_nop 0
  buffer_load_dwordx4 v1, s[40:43], s84 offen offset:0 sc1 lds
  buffer_load_dwordx4 v1, s[40:43], s84 offen offset:1024 sc1 lds
  buffer_load_dwordx4 v1, s[40:43], s84 offen offset:2048 sc1 lds
  buffer_load_dwordx4 v1, s[40:43], s84 offen offset:3072 sc1 lds
  v_exp_f32 v48, v48
  v_exp_f32 v49, v49
  v_exp_f32 v50, v50
  v_exp_f32 v51, v51
  v_cvt_pk_bf16_f32 v72, v48, v49
  v_mfma_f32_32x32x16_bf16 v[32:47], a[52:55], v[164:167], v[32:47]
  v_exp_f32 v52, v52
  v_exp_f32 v53, v53
  v_cvt_pk_bf16_f32 v73, v50, v51
  v_exp_f32 v54, v54
  v_exp_f32 v55, v55
  v_cvt_pk_bf16_f32 v74, v52, v53
  v_mfma_f32_32x32x16_bf16 v[128:143], a[40:43], v[64:67], v[128:143]
  v_exp_f32 v56, v56
  v_exp_f32 v57, v57
  v_cvt_pk_bf16_f32 v75, v54, v55
  v_exp_f32 v58, v58
  v_exp_f32 v59, v59
  v_cvt_pk_bf16_f32 v76, v56, v57
  v_mfma_f32_32x32x16_bf16 v[128:143], a[44:47], v[68:71], v[128:143]
  v_exp_f32 v60, v60
  v_exp_f32 v61, v61
  v_cvt_pk_bf16_f32 v77, v58, v59
  v_exp_f32 v62, v62
  v_exp_f32 v63, v63
  v_cvt_pk_bf16_f32 v78, v60, v61
  v_cvt_pk_bf16_f32 v79, v62, v63
  v_mfma_f32_32x32x16_bf16 v[48:63], a[48:51], v[168:171], 0
  v_exp_f32 v32, v32
  v_exp_f32 v33, v33
  v_exp_f32 v34, v34
  v_exp_f32 v35, v35
  v_cvt_pk_bf16_f32 v64, v32, v33
  v_mfma_f32_32x32x16_bf16 v[48:63], a[52:55], v[172:175], v[48:63]
  v_exp_f32 v36, v36
  v_exp_f32 v37, v37
  v_cvt_pk_bf16_f32 v65, v34, v35
  v_exp_f32 v38, v38
  v_exp_f32 v39, v39
  v_cvt_pk_bf16_f32 v66, v36, v37
  v_mfma_f32_32x32x16_bf16 v[144:159], a[40:43], v[72:75], v[144:159]
  v_exp_f32 v40, v40
  v_exp_f32 v41, v41
  v_cvt_pk_bf16_f32 v67, v38, v39
  v_exp_f32 v42, v42
  v_exp_f32 v43, v43
  v_cvt_pk_bf16_f32 v68, v40, v41
  v_mfma_f32_32x32x16_bf16 v[144:159], a[44:47], v[76:79], v[144:159]
  v_exp_f32 v44, v44
  v_exp_f32 v45, v45
  v_cvt_pk_bf16_f32 v69, v42, v43
  v_exp_f32 v46, v46
  v_exp_f32 v47, v47
  v_cvt_pk_bf16_f32 v70, v44, v45
  v_cvt_pk_bf16_f32 v71, v46, v47
  v_mfma_f32_32x32x16_bf16 v[32:47], a[48:51], v[176:179], 0
  v_exp_f32 v48, v48
  v_exp_f32 v49, v49
  v_exp_f32 v50, v50
  v_exp_f32 v51, v51
  v_cvt_pk_bf16_f32 v72, v48, v49
  v_mfma_f32_32x32x16_bf16 v[32:47], a[52:55], v[180:183], v[32:47]
  v_exp_f32 v52, v52
  v_exp_f32 v53, v53
  v_cvt_pk_bf16_f32 v73, v50, v51
  v_exp_f32 v54, v54
  v_exp_f32 v55, v55
  v_cvt_pk_bf16_f32 v74, v52, v53
  v_mfma_f32_32x32x16_bf16 v[96:111], a[56:59], v[64:67], v[96:111]
  s_add_u32 s72, s55, 1
  s_and_b32 s72, s72, 3
  s_mul_i32 s72, s72, 12288
  s_add_u32 s72, s72, 0
  v_add_u32 v17, s72, v1
  s_add_u32 s72, s55, 2
  s_and_b32 s72, s72, 3
  s_mul_i32 s72, s72, 12288
  s_add_u32 s72, s72, 4096
  v_add_u32 v18, s72, v1
  s_add_u32 s72, s55, 3
  s_and_b32 s72, s72, 3
  s_mul_i32 s72, s72, 12288
  s_add_u32 s72, s72, 8192
  v_add_u32 v19, s72, v1
  s_mul_i32 s72, s55, 12288
  s_add_u32 s72, s72, 0
  v_add_u32 v20, s72, v1
  v_exp_f32 v56, v56
  v_exp_f32 v57, v57
  v_cvt_pk_bf16_f32 v75, v54, v55
  v_exp_f32 v58, v58
  v_exp_f32 v59, v59
  v_cvt_pk_bf16_f32 v76, v56, v57
  v_mfma_f32_32x32x16_bf16 v[96:111], a[60:63], v[68:71], v[96:111]
  v_exp_f32 v60, v60
  v_exp_f32 v61, v61
  v_cvt_pk_bf16_f32 v77, v58, v59
  v_exp_f32 v62, v62
  v_exp_f32 v63, v63
  v_cvt_pk_bf16_f32 v78, v60, v61
  v_cvt_pk_bf16_f32 v79, v62, v63
  v_mfma_f32_32x32x16_bf16 v[48:63], a[48:51], v[184:187], 0
  s_add_u32 s88, s87, 548864
  buffer_load_dwordx4 a[32:35], v1, s[40:43], s88 offen offset:0 sc1
  buffer_load_dwordx4 a[36:39], v1, s[40:43], s88 offen offset:1024 sc1
  buffer_load_dwordx4 a[40:43], v1, s[40:43], s88 offen offset:2048 sc1
  buffer_load_dwordx4 a[44:47], v1, s[40:43], s88 offen offset:3072 sc1
  v_exp_f32 v32, v32
  v_exp_f32 v33, v33
  v_exp_f32 v34, v34
  v_exp_f32 v35, v35
  v_cvt_pk_bf16_f32 v64, v32, v33
  v_mfma_f32_32x32x16_bf16 v[48:63], a[52:55], v[188:191], v[48:63]
  v_exp_f32 v36, v36
  v_exp_f32 v37, v37
  v_cvt_pk_bf16_f32 v65, v34, v35
  v_exp_f32 v38, v38
  v_exp_f32 v39, v39
  v_cvt_pk_bf16_f32 v66, v36, v37
  v_mfma_f32_32x32x16_bf16 v[112:127], a[56:59], v[72:75], v[112:127]
  ds_write_b128 v17, v[96:99] offset:0
  ds_write_b128 v17, v[100:103] offset:1024
  v_exp_f32 v40, v40
  v_exp_f32 v41, v41
  v_cvt_pk_bf16_f32 v67, v38, v39
  v_exp_f32 v42, v42
  v_exp_f32 v43, v43
  v_cvt_pk_bf16_f32 v68, v40, v41
  v_mfma_f32_32x32x16_bf16 v[112:127], a[60:63], v[76:79], v[112:127]
  ds_write_b128 v17, v[104:107] offset:2048
  ds_write_b128 v17, v[108:111] offset:3072
  v_exp_f32 v44, v44
  v_exp_f32 v45, v45
  v_cvt_pk_bf16_f32 v69, v42, v43
  v_exp_f32 v46, v46
  v_exp_f32 v47, v47
  v_cvt_pk_bf16_f32 v70, v44, v45
  v_cvt_pk_bf16_f32 v71, v46, v47
  v_exp_f32 v48, v48
  v_exp_f32 v49, v49
  v_exp_f32 v50, v50
  v_exp_f32 v51, v51
  v_cvt_pk_bf16_f32 v72, v48, v49
  v_exp_f32 v52, v52
  v_exp_f32 v53, v53
  v_cvt_pk_bf16_f32 v73, v50, v51
  v_exp_f32 v54, v54
  v_exp_f32 v55, v55
  v_cvt_pk_bf16_f32 v74, v52, v53
  v_mfma_f32_32x32x16_bf16 v[128:143], a[56:59], v[64:67], v[128:143]
  ds_write_b128 v18, v[112:115] offset:0
  ds_write_b128 v18, v[116:119] offset:1024
  v_exp_f32 v56, v56
  v_exp_f32 v57, v57
  v_cvt_pk_bf16_f32 v75, v54, v55
  v_exp_f32 v58, v58
  v_exp_f32 v59, v59
  v_cvt_pk_bf16_f32 v76, v56, v57
  v_mfma_f32_32x32x16_bf16 v[128:143], a[60:63], v[68:71], v[128:143]
  ds_write_b128 v18, v[120:123] offset:2048
  ds_write_b128 v18, v[124:127] offset:3072
  v_exp_f32 v60, v60
  v_exp_f32 v61, v61
  v_cvt_pk_bf16_f32 v77, v58, v59
  v_exp_f32 v62, v62
  v_exp_f32 v63, v63
  v_cvt_pk_bf16_f32 v78, v60, v61
  v_cvt_pk_bf16_f32 v79, v62, v63
  s_nop 0
  v_mfma_f32_32x32x16_bf16 v[144:159], a[56:59], v[72:75], v[144:159]
  v_mfma_f32_32x32x16_bf16 v[144:159], a[60:63], v[76:79], v[144:159]
  s_branch L_roles_done
L_roleA:
  s_waitcnt vmcnt(8)
  s_waitcnt lgkmcnt(0)
  s_barrier
  ds_read_b128 a[0:3], v5 offset:0
  ds_read_b128 a[4:7], v5 offset:4096
  ds_read_b64_tr_b16 a[8:9], v14 offset:32768
  ds_read_b64_tr_b16 a[10:11], v14 offset:33280
  ds_read_b128 a[12:15], v6 offset:0
  ds_read_b128 a[16:19], v6 offset:4096
  ds_read_b64_tr_b16 a[20:21], v14 offset:34816
  ds_read_b64_tr_b16 a[22:23], v14 offset:35328
  ds_read_b128 a[24:27], v7 offset:0
  ds_read_b128 a[28:31], v7 offset:4096
  ds_read_b64_tr_b16 a[32:33], v14 offset:36864
  ds_read_b64_tr_b16 a[34:35], v14 offset:37376
  ds_read_b128 a[36:39], v8 offset:0
  ds_read_b128 a[40:43], v8 offset:4096
  ds_read_b64_tr_b16 a[44:45], v14 offset:38912
  ds_read_b64_tr_b16 a[46:47], v14 offset:39424
  v_cvt_pk_bf16_f32 v32, v96, v97
  v_cvt_pk_bf16_f32 v33, v98, v99
  v_cvt_pk_bf16_f32 v34, v100, v101
  v_cvt_pk_bf16_f32 v35, v102, v103
  v_cvt_pk_bf16_f32 v36, v104, v105
  v_cvt_pk_bf16_f32 v37, v106, v107
  v_cvt_pk_bf16_f32 v38, v108, v109
  v_cvt_pk_bf16_f32 v39, v110, v111
  v_cvt_pk_bf16_f32 v40, v112, v113
  v_cvt_pk_bf16_f32 v41, v114, v115
  v_cvt_pk_bf16_f32 v42, v116, v117
  v_cvt_pk_bf16_f32 v43, v118, v119
  v_cvt_pk_bf16_f32 v44, v120, v121
  v_cvt_pk_bf16_f32 v45, v122, v123
  v_cvt_pk_bf16_f32 v46, v124, v125
  v_cvt_pk_bf16_f32 v47, v126, v127
  s_mov_b32 exec_lo, 0
  v_mov_b32 v38, 0
  v_mov_b32 v39, 0
  v_mov_b32 v46, 0
  v_mov_b32 v47, 0
  s_mov_b32 exec_lo, -1
  s_nop 0
  v_mfma_f32_32x32x16_bf16 v[48:63], v[208:211], v[32:35], 0
  v_mfma_f32_32x32x16_bf16 v[48:63], v[212:215], v[36:39], v[48:63]
  v_mfma_f32_32x32x16_bf16 v[64:79], v[208:211], v[40:43], 0
  v_mfma_f32_32x32x16_bf16 v[64:79], v[212:215], v[44:47], v[64:79]
  v_cvt_pk_bf16_f32 v128, v128, v129
  v_cvt_pk_bf16_f32 v129, v130, v131
  v_cvt_pk_bf16_f32 v130, v132, v133
  v_cvt_pk_bf16_f32 v131, v134, v135
  v_cvt_pk_bf16_f32 v132, v136, v137
  s_waitcnt vmcnt(6)
  s_barrier
  s_waitcnt lgkmcnt(12)
  v_mfma_f32_32x32x16_bf16 v[160:175], a[8:11], a[0:3], 0
  ds_read_b128 a[48:51], v5 offset:16384
  ds_read_b128 a[52:55], v5 offset:20480
  v_cvt_pk_bf16_f32 v133, v138, v139
  v_cvt_pk_bf16_f32 v134, v140, v141
  v_cvt_pk_bf16_f32 v135, v142, v143
  v_cvt_pk_bf16_f32 v144, v144, v145
  v_cvt_pk_bf16_f32 v145, v146, v147
  v_cvt_pk_bf16_f32 v146, v148, v149
  v_cvt_pk_bf16_f32 v147, v150, v151
  v_cvt_pk_bf16_f32 v148, v152, v153
  v_cvt_pk_bf16_f32 v149, v154, v155
  v_mfma_f32_32x32x16_bf16 v[176:191], a[8:11], a[4:7], 0
  ds_read_b64_tr_b16 a[56:57], v14 offset:0
  ds_read_b64_tr_b16 a[58:59], v14 offset:512
  v_cvt_pk_bf16_f32 v150, v156, v157
  v_cvt_pk_bf16_f32 v151, v158, v159
  s_mov_b32 exec_lo, 0x10000000
  s_mov_b32 exec_hi, 0x10000000
  v_mov_b32 v128, 0x3f803f80
  v_mov_b32 v129, 0x3f803f80
  v_mov_b32 v130, 0x3f803f80
  v_mov_b32 v131, 0x3f803f80
  v_mov_b32 v132, 0x3f803f80
  v_mov_b32 v133, 0x3f803f80
  v_mov_b32 v134, 0x3f803f80
  v_mov_b32 v135, 0x3f803f80
  v_mov_b32 v144, 0x3f803f80
  v_mov_b32 v145, 0x3f803f80
  v_mov_b32 v146, 0x3f803f80
  v_mov_b32 v147, 0x3f803f80
  v_mov_b32 v148, 0x3f803f80
  v_mov_b32 v149, 0x3f803f80
  v_mov_b32 v150, 0x3f803f80
  v_mov_b32 v151, 0x3f803f80
  s_mov_b64 exec, -1
  s_waitcnt lgkmcnt(12)
  v_mfma_f32_32x32x16_bf16 v[160:175], a[20:23], a[12:15], v[160:175]
  ds_read_b128 a[60:63], v6 offset:16384
  ds_read_b128 a[64:67], v6 offset:20480
  v_max3_f32 v24, v48, v49, v50
  v_min3_f32 v26, v48, v49, v50
  v_max3_f32 v24, v24, v51, v52
  v_min3_f32 v26, v26, v51, v52
  v_max3_f32 v24, v24, v53, v54
  v_min3_f32 v26, v26, v53, v54
  v_max3_f32 v24, v24, v55, v56
  v_min3_f32 v26, v26, v55, v56
  v_max3_f32 v24, v24, v57, v58
  v_mfma_f32_32x32x16_bf16 v[176:191], a[20:23], a[16:19], v[176:191]
  ds_read_b64_tr_b16 a[68:69], v14 offset:2048
  ds_read_b64_tr_b16 a[70:71], v14 offset:2560
  v_min3_f32 v26, v26, v57, v58
  v_max3_f32 v24, v24, v59, v60
  v_min3_f32 v26, v26, v59, v60
  v_max3_f32 v24, v24, v61, v62
  v_min3_f32 v26, v26, v61, v62
  v_max_f32 v24, v24, v63
  v_min_f32 v26, v26, v63
  v_mov_b32 v25, v24
  v_mov_b32 v27, v26
  s_waitcnt lgkmcnt(12)
  v_mfma_f32_32x32x16_bf16 v[160:175], a[32:35], a[24:27], v[160:175]
  ds_read_b128 a[72:75], v7 offset:16384
  ds_read_b128 a[76:79], v7 offset:20480
  s_nop 0
  v_permlane32_swap_b32 v24, v25
  v_permlane32_swap_b32 v26, v27
  v_max_f32 v24, v24, v25
  v_min_f32 v26, v26, v27
  v_mul_f32 v28, s70, v24
  v_mul_f32 v30, s70, v26
  v_fma_f32 v80, v48, s70, -v28
  v_fma_f32 v32, -v48, s70, v30
  v_mfma_f32_32x32x16_bf16 v[176:191], a[32:35], a[28:31], v[176:191]
  ds_read_b64_tr_b16 a[80:81], v14 offset:4096
  ds_read_b64_tr_b16 a[82:83], v14 offset:4608
  v_fma_f32 v81, v49, s70, -v28
  v_fma_f32 v33, -v49, s70, v30
  v_fma_f32 v82, v50, s70, -v28
  v_fma_f32 v34, -v50, s70, v30
  v_fma_f32 v83, v51, s70, -v28
  v_fma_f32 v35, -v51, s70, v30
  v_fma_f32 v84, v52, s70, -v28
  v_fma_f32 v36, -v52, s70, v30
  v_fma_f32 v85, v53, s70, -v28
  s_waitcnt lgkmcnt(12)
  v_mfma_f32_32x32x16_bf16 v[160:175], a[44:47], a[36:39], v[160:175]
  ds_read_b128 a[84:87], v8 offset:16384
  ds_read_b128 a[88:91], v8 offset:20480
  v_fma_f32 v37, -v53, s70, v30
  v_fma_f32 v86, v54, s70, -v28
  v_fma_f32 v38, -v54, s70, v30
  v_fma_f32 v87, v55, s70, -v28
  v_fma_f32 v39, -v55, s70, v30
  v_fma_f32 v88, v56, s70, -v28
  v_fma_f32 v40, -v56, s70, v30
  v_fma_f32 v89, v57, s70, -v28
  v_fma_f32 v41, -v57, s70, v30
  v_mfma_f32_32x32x16_bf16 v[176:191], a[44:47], a[40:43], v[176:191]
  ds_read_b64_tr_b16 a[92:93], v14 offset:6144
  ds_read_b64_tr_b16 a[94:95], v14 offset:6656
  v_fma_f32 v90, v58, s70, -v28
  v_fma_f32 v42, -v58, s70, v30
  v_fma_f32 v91, v59, s70, -v28
  v_fma_f32 v43, -v59, s70, v30
  v_fma_f32 v92, v60, s70, -v28
  v_fma_f32 v44, -v60, s70, v30
  v_fma_f32 v93, v61, s70, -v28
  v_fma_f32 v45, -v61, s70, v30
  v_fma_f32 v94, v62, s70, -v28
  s_waitcnt vmcnt(4)
  s_barrier
  s_waitcnt lgkmcnt(12)
  v_mfma_f32_32x32x16_bf16 v[160:175], a[56:59], a[48:51], v[160:175]
  s_add_u32 m0, s64, 32768
  s_add_u32 s66, s93, 860160
  buffer_load_dwordx4 v2, s[28:31], s66 offen lds
  buffer_load_dwordx4 v4, s[28:31], s66 offen offset:1024 lds
  ds_read_b128 a[0:3], v5 offset:32768
  ds_read_b128 a[4:7], v5 offset:36864
  v_fma_f32 v46, -v62, s70, v30
  v_fma_f32 v95, v63, s70, -v28
  v_fma_f32 v47, -v63, s70, v30
  v_exp_f32 v80, v80
  v_exp_f32 v81, v81
  v_exp_f32 v82, v82
  v_mfma_f32_32x32x16_bf16 v[176:191], a[56:59], a[52:55], v[176:191]
  ds_read_b64_tr_b16 a[8:9], v14 offset:8192
  ds_read_b64_tr_b16 a[10:11], v14 offset:8704
  v_exp_f32 v83, v83
  v_exp_f32 v84, v84
  v_exp_f32 v85, v85
  v_exp_f32 v86, v86
  v_exp_f32 v87, v87
  s_waitcnt lgkmcnt(12)
  v_mfma_f32_32x32x16_bf16 v[160:175], a[68:71], a[60:63], v[160:175]
  ds_read_b128 a[12:15], v6 offset:32768
  ds_read_b128 a[16:19], v6 offset:36864
  v_exp_f32 v88, v88
  v_exp_f32 v89, v89
  v_exp_f32 v90, v90
  v_exp_f32 v91, v91
  v_exp_f32 v92, v92
  v_mfma_f32_32x32x16_bf16 v[176:191], a[68:71], a[64:67], v[176:191]
  ds_read_b64_tr_b16 a[20:21], v14 offset:10240
  ds_read_b64_tr_b16 a[22:23], v14 offset:10752
  v_exp_f32 v93, v93
  v_exp_f32 v94, v94
  v_exp_f32 v95, v95
  v_exp_f32 v32, v32
  v_exp_f32 v33, v33
  s_waitcnt lgkmcnt(12)
  v_mfma_f32_32x32x16_bf16 v[160:175], a[80:83], a[72:75], v[160:175]
  ds_read_b128 a[24:27], v7 offset:32768
  ds_read_b128 a[28:31], v7 offset:36864
  v_exp_f32 v34, v34
  v_exp_f32 v35, v35
  v_exp_f32 v36, v36
  v_exp_f32 v37, v37
  v_exp_f32 v38, v38
  v_mfma_f32_32x32x16_bf16 v[176:191], a[80:83], a[76:79], v[176:191]
  ds_read_b64_tr_b16 a[32:33], v14 offset:12288
  ds_read_b64_tr_b16 a[34:35], v14 offset:12800
  v_exp_f32 v39, v39
  v_exp_f32 v40, v40
  v_exp_f32 v41, v41
  v_exp_f32 v42, v42
  v_exp_f32 v43, v43
  s_waitcnt lgkmcnt(12)
  v_mfma_f32_32x32x16_bf16 v[160:175], a[92:95], a[84:87], v[160:175]
  ds_read_b128 a[36:39], v8 offset:32768
  ds_read_b128 a[40:43], v8 offset:36864
  v_exp_f32 v44, v44
  v_exp_f32 v45, v45
  v_exp_f32 v46, v46
  v_exp_f32 v47, v47
  s_mov_b32 exec_lo, 0
  v_mov_b32 v92, 0
  v_mov_b32 v44, 0
  v_mov_b32 v93, 0
  v_mov_b32 v45, 0
  v_mov_b32 v94, 0
  v_mov_b32 v46, 0
  v_mov_b32 v95, 0
  v_mov_b32 v47, 0
  s_mov_b32 exec_lo, -1
  v_mfma_f32_32x32x16_bf16 v[176:191], a[92:95], a[88:91], v[176:191]
  ds_read_b64_tr_b16 a[44:45], v14 offset:14336
  ds_read_b64_tr_b16 a[46:47], v14 offset:14848
  v_add_f32 v24, v80, v81
  v_add_f32 v48, v82, v83
  v_add_f32 v24, v24, v84
  v_add_f32 v48, v48, v85
  v_add_f32 v24, v24, v86
  v_add_f32 v48, v48, v87
  v_add_f32 v24, v24, v88
  v_add_f32 v48, v48, v89
  v_add_f32 v24, v24, v90
  s_waitcnt vmcnt(4)
  s_barrier
  s_waitcnt lgkmcnt(12)
  v_mfma_f32_32x32x16_bf16 v[160:175], a[8:11], a[0:3], v[160:175]
  s_add_u32 m0, s64, 0
  s_add_u32 s66, s93, 1032192
  buffer_load_dwordx4 v2, s[28:31], s66 offen lds
  buffer_load_dwordx4 v4, s[28:31], s66 offen offset:1024 lds
  ds_read_b128 a[48:51], v5 offset:49152
  ds_read_b128 a[52:55], v5 offset:53248
  v_add_f32 v48, v48, v91
  v_add_f32 v24, v24, v92
  v_add_f32 v48, v48, v93
  v_add_f32 v24, v24, v94
  v_add_f32 v48, v48, v95
  v_add_f32 v24, v24, v48
  v_add_f32 v26, v32, v33
  v_add_f32 v56, v34, v35
  v_add_f32 v26, v26, v36
  v_mfma_f32_32x32x16_bf16 v[176:191], a[8:11], a[4:7], v[176:191]
  ds_read_b64_tr_b16 a[56:57], v14 offset:16384
  ds_read_b64_tr_b16 a[58:59], v14 offset:16896
  v_add_f32 v56, v56, v37
  v_add_f32 v26, v26, v38
  v_add_f32 v56, v56, v39
  v_add_f32 v26, v26, v40
  v_add_f32 v56, v56, v41
  v_add_f32 v26, v26, v42
  v_add_f32 v56, v56, v43
  v_add_f32 v26, v26, v44
  v_add_f32 v56, v56, v45
  s_waitcnt lgkmcnt(12)
  v_mfma_f32_32x32x16_bf16 v[160:175], a[20:23], a[12:15], v[160:175]
  ds_read_b128 a[60:63], v6 offset:49152
  ds_read_b128 a[64:67], v6 offset:53248
  v_add_f32 v26, v26, v46
  v_add_f32 v56, v56, v47
  v_add_f32 v26, v26, v56
  v_mov_b32 v25, v24
  v_mov_b32 v27, v26
  s_nop 0
  v_permlane32_swap_b32 v24, v25
  v_permlane32_swap_b32 v26, v27
  v_add_f32 v24, v24, v25
  v_mfma_f32_32x32x16_bf16 v[176:191], a[20:23], a[16:19], v[176:191]
  ds_read_b64_tr_b16 a[68:69], v14 offset:18432
  ds_read_b64_tr_b16 a[70:71], v14 offset:18944
  v_add_f32 v26, v26, v27
  v_rcp_f32 v28, v24
  v_rcp_f32 v30, v26
  s_nop 0
  v_mul_f32 v80, v28, v80
  v_mul_f32 v81, v28, v81
  v_mul_f32 v82, v28, v82
  s_waitcnt lgkmcnt(12)
  v_mfma_f32_32x32x16_bf16 v[160:175], a[32:35], a[24:27], v[160:175]
  ds_read_b128 a[72:75], v7 offset:49152
  ds_read_b128 a[76:79], v7 offset:53248
  v_mul_f32 v83, v28, v83
  v_mul_f32 v84, v28, v84
  v_mul_f32 v85, v28, v85
  v_mul_f32 v86, v28, v86
  v_mul_f32 v87, v28, v87
  v_mul_f32 v88, v28, v88
  v_mul_f32 v89, v28, v89
  v_mul_f32 v90, v28, v90
  v_mul_f32 v91, v28, v91
  v_mfma_f32_32x32x16_bf16 v[176:191], a[32:35], a[28:31], v[176:191]
  ds_read_b64_tr_b16 a[80:81], v14 offset:20480
  ds_read_b64_tr_b16 a[82:83], v14 offset:20992
  v_mul_f32 v92, v28, v92
  v_mul_f32 v93, v28, v93
  v_mul_f32 v94, v28, v94
  v_mul_f32 v95, v28, v95
  v_mul_f32 v32, v30, v32
  v_mul_f32 v33, v30, v33
  v_mul_f32 v34, v30, v34
  v_mul_f32 v35, v30, v35
  v_mul_f32 v36, v30, v36
  s_waitcnt lgkmcnt(12)
  v_mfma_f32_32x32x16_bf16 v[160:175], a[44:47], a[36:39], v[160:175]
  ds_read_b128 a[84:87], v8 offset:49152
  ds_read_b128 a[88:91], v8 offset:53248
  v_mul_f32 v37, v30, v37
  v_mul_f32 v38, v30, v38
  v_mul_f32 v39, v30, v39
  v_mul_f32 v40, v30, v40
  v_mul_f32 v41, v30, v41
  v_mul_f32 v42, v30, v42
  v_mul_f32 v43, v30, v43
  v_mul_f32 v44, v30, v44
  v_mul_f32 v45, v30, v45
  v_mfma_f32_32x32x16_bf16 v[176:191], a[44:47], a[40:43], v[176:191]
  ds_read_b64_tr_b16 a[92:93], v14 offset:22528
  ds_read_b64_tr_b16 a[94:95], v14 offset:23040
  v_mul_f32 v46, v30, v46
  v_mul_f32 v47, v30, v47
  v_cvt_pk_bf16_f32 v96, v80, v81
  v_cvt_pk_bf16_f32 v97, v82, v83
  v_cvt_pk_bf16_f32 v98, v84, v85
  v_cvt_pk_bf16_f32 v99, v86, v87
  v_cvt_pk_bf16_f32 v100, v88, v89
  v_cvt_pk_bf16_f32 v101, v90, v91
  v_cvt_pk_bf16_f32 v102, v92, v93
  s_waitcnt vmcnt(4)
  s_barrier
  s_waitcnt lgkmcnt(12)
  v_mfma_f32_32x32x16_bf16 v[160:175], a[56:59], a[48:51], v[160:175]
  ds_read_b128 a[0:3], v9 offset:0
  ds_read_b128 a[4:7], v9 offset:4096
  v_cvt_pk_bf16_f32 v103, v94, v95
  v_cvt_pk_bf16_f32 v104, v32, v33
  v_cvt_pk_bf16_f32 v105, v34, v35
  v_cvt_pk_bf16_f32 v106, v36, v37
  v_cvt_pk_bf16_f32 v107, v38, v39
  v_cvt_pk_bf16_f32 v108, v40, v41
  v_cvt_pk_bf16_f32 v109, v42, v43
  v_cvt_pk_bf16_f32 v110, v44, v45
  v_cvt_pk_bf16_f32 v111, v46, v47
  v_mfma_f32_32x32x16_bf16 v[176:191], a[56:59], a[52:55], v[176:191]
  ds_read_b64_tr_b16 a[8:9], v14 offset:24576
  ds_read_b64_tr_b16 a[10:11], v14 offset:25088
  v_max3_f32 v24, v64, v65, v66
  v_min3_f32 v26, v64, v65, v66
  v_max3_f32 v24, v24, v67, v68
  v_min3_f32 v26, v26, v67, v68
  v_max3_f32 v24, v24, v69, v70
  v_min3_f32 v26, v26, v69, v70
  v_max3_f32 v24, v24, v71, v72
  v_min3_f32 v26, v26, v71, v72
  v_max3_f32 v24, v24, v73, v74
  s_waitcnt lgkmcnt(12)
  v_mfma_f32_32x32x16_bf16 v[160:175], a[68:71], a[60:63], v[160:175]
  ds_read_b128 a[12:15], v10 offset:0
  ds_read_b128 a[16:19], v10 offset:4096
  v_min3_f32 v26, v26, v73, v74
  v_max3_f32 v24, v24, v75, v76
  v_min3_f32 v26, v26, v75, v76
  v_max3_f32 v24, v24, v77, v78
  v_min3_f32 v26, v26, v77, v78
  v_max_f32 v24, v24, v79
  v_min_f32 v26, v26, v79
  v_mov_b32 v25, v24
  v_mov_b32 v27, v26
  v_mfma_f32_32x32x16_bf16 v[176:191], a[68:71], a[64:67], v[176:191]
  ds_read_b64_tr_b16 a[20:21], v14 offset:26624
  ds_read_b64_tr_b16 a[22:23], v14 offset:27136
  s_nop 0
  v_permlane32_swap_b32 v24, v25
  v_permlane32_swap_b32 v26, v27
  v_max_f32 v24, v24, v25
  v_min_f32 v26, v26, v27
  v_mul_f32 v28, s70, v24
  v_mul_f32 v30, s70, v26
  v_fma_f32 v80, v64, s70, -v28
  v_fma_f32 v32, -v64, s70, v30
  s_waitcnt lgkmcnt(12)
  v_mfma_f32_32x32x16_bf16 v[160:175], a[80:83], a[72:75], v[160:175]
  ds_read_b128 a[24:27], v11 offset:0
  ds_read_b128 a[28:31], v11 offset:4096
  v_fma_f32 v81, v65, s70, -v28
  v_fma_f32 v33, -v65, s70, v30
  v_fma_f32 v82, v66, s70, -v28
  v_fma_f32 v34, -v66, s70, v30
  v_fma_f32 v83, v67, s70, -v28
  v_fma_f32 v35, -v67, s70, v30
  v_fma_f32 v84, v68, s70, -v28
  v_fma_f32 v36, -v68, s70, v30
  v_fma_f32 v85, v69, s70, -v28
  v_mfma_f32_32x32x16_bf16 v[176:191], a[80:83], a[76:79], v[176:191]
  ds_read_b64_tr_b16 a[32:33], v14 offset:28672
  ds_read_b64_tr_b16 a[34:35], v14 offset:29184
  v_fma_f32 v37, -v69, s70, v30
  v_fma_f32 v86, v70, s70, -v28
  v_fma_f32 v38, -v70, s70, v30
  v_fma_f32 v87, v71, s70, -v28
  v_fma_f32 v39, -v71, s70, v30
  v_fma_f32 v88, v72, s70, -v28
  v_fma_f32 v40, -v72, s70, v30
  v_fma_f32 v89, v73, s70, -v28
  v_fma_f32 v41, -v73, s70, v30
  s_waitcnt lgkmcnt(12)
  v_mfma_f32_32x32x16_bf16 v[160:175], a[92:95], a[84:87], v[160:175]
  ds_read_b128 a[36:39], v12 offset:0
  ds_read_b128 a[40:43], v12 offset:4096
  v_fma_f32 v90, v74, s70, -v28
  v_fma_f32 v42, -v74, s70, v30
  v_fma_f32 v91, v75, s70, -v28
  v_fma_f32 v43, -v75, s70, v30
  v_fma_f32 v92, v76, s70, -v28
  v_fma_f32 v44, -v76, s70, v30
  v_fma_f32 v93, v77, s70, -v28
  v_fma_f32 v45, -v77, s70, v30
  v_fma_f32 v94, v78, s70, -v28
  v_mfma_f32_32x32x16_bf16 v[176:191], a[92:95], a[88:91], v[176:191]
  ds_read_b64_tr_b16 a[44:45], v14 offset:30720
  ds_read_b64_tr_b16 a[46:47], v14 offset:31232
  v_fma_f32 v46, -v78, s70, v30
  v_fma_f32 v95, v79, s70, -v28
  v_fma_f32 v47, -v79, s70, v30
  v_exp_f32 v80, v80
  v_exp_f32 v81, v81
  v_exp_f32 v82, v82
  s_waitcnt vmcnt(2)
  s_barrier
  s_waitcnt lgkmcnt(12)
  v_mfma_f32_32x32x16_bf16 v[160:175], a[8:11], a[0:3], v[160:175]
  ds_read_b128 a[48:51], v9 offset:16384
  ds_read_b128 a[52:55], v9 offset:20480
  v_exp_f32 v83, v83
  v_exp_f32 v84, v84
  v_exp_f32 v85, v85
  v_exp_f32 v86, v86
  v_exp_f32 v87, v87
  v_mfma_f32_32x32x16_bf16 v[176:191], a[8:11], a[4:7], v[176:191]
  ds_read_b64_tr_b16 a[56:57], v14 offset:32768
  ds_read_b64_tr_b16 a[58:59], v14 offset:33280
  v_exp_f32 v88, v88
  v_exp_f32 v89, v89
  v_exp_f32 v90, v90
  v_exp_f32 v91, v91
  v_exp_f32 v92, v92
  s_waitcnt lgkmcnt(12)
  v_mfma_f32_32x32x16_bf16 v[160:175], a[20:23], a[12:15], v[160:175]
  ds_read_b128 a[60:63], v10 offset:16384
  ds_read_b128 a[64:67], v10 offset:20480
  v_exp_f32 v93, v93
  v_exp_f32 v94, v94
  v_exp_f32 v95, v95
  v_exp_f32 v32, v32
  v_exp_f32 v33, v33
  v_mfma_f32_32x32x16_bf16 v[176:191], a[20:23], a[16:19], v[176:191]
  ds_read_b64_tr_b16 a[68:69], v14 offset:34816
  ds_read_b64_tr_b16 a[70:71], v14 offset:35328
  v_exp_f32 v34, v34
  v_exp_f32 v35, v35
  v_exp_f32 v36, v36
  v_exp_f32 v37, v37
  v_exp_f32 v38, v38
  s_waitcnt lgkmcnt(12)
  v_mfma_f32_32x32x16_bf16 v[160:175], a[32:35], a[24:27], v[160:175]
  ds_read_b128 a[72:75], v11 offset:16384
  ds_read_b128 a[76:79], v11 offset:20480
  v_exp_f32 v39, v39
  v_exp_f32 v40, v40
  v_exp_f32 v41, v41
  v_exp_f32 v42, v42
  v_exp_f32 v43, v43
  v_mfma_f32_32x32x16_bf16 v[176:191], a[32:35], a[28:31], v[176:191]
  ds_read_b64_tr_b16 a[80:81], v14 offset:36864
  ds_read_b64_tr_b16 a[82:83], v14 offset:37376
  v_exp_f32 v44, v44
  v_exp_f32 v45, v45
  v_exp_f32 v46, v46
  v_exp_f32 v47, v47
  s_mov_b32 exec_lo, 0
  v_mov_b32 v92, 0
  v_mov_b32 v44, 0
  v_mov_b32 v93, 0
  v_mov_b32 v45, 0
  v_mov_b32 v94, 0
  v_mov_b32 v46, 0
  v_mov_b32 v95, 0
  v_mov_b32 v47, 0
  s_mov_b32 exec_lo, -1
  s_waitcnt lgkmcnt(12)
  v_mfma_f32_32x32x16_bf16 v[160:175], a[44:47], a[36:39], v[160:175]
  ds_read_b128 a[84:87], v12 offset:16384
  ds_read_b128 a[88:91], v12 offset:20480
  v_add_f32 v24, v80, v81
  v_add_f32 v64, v82, v83
  v_add_f32 v24, v24, v84
  v_add_f32 v64, v64, v85
  v_add_f32 v24, v24, v86
  v_add_f32 v64, v64, v87
  v_add_f32 v24, v24, v88
  v_add_f32 v64, v64, v89
  v_add_f32 v24, v24, v90
  v_mfma_f32_32x32x16_bf16 v[176:191], a[44:47], a[40:43], v[176:191]
  ds_read_b64_tr_b16 a[92:93], v14 offset:38912
  ds_read_b64_tr_b16 a[94:95], v14 offset:39424
  v_add_f32 v64, v64, v91
  v_add_f32 v24, v24, v92
  v_add_f32 v64, v64, v93
  v_add_f32 v24, v24, v94
  v_add_f32 v64, v64, v95
  v_add_f32 v24, v24, v64
  v_add_f32 v26, v32, v33
  v_add_f32 v72, v34, v35
  v_add_f32 v26, v26, v36
  s_waitcnt vmcnt(0)
  s_barrier
  s_waitcnt lgkmcnt(12)
  v_mfma_f32_32x32x16_bf16 v[160:175], a[56:59], a[48:51], v[160:175]
  ds_read_b128 a[0:3], v9 offset:32768
  ds_read_b128 a[4:7], v9 offset:36864
  v_add_f32 v72, v72, v37
  v_add_f32 v26, v26, v38
  v_add_f32 v72, v72, v39
  v_add_f32 v26, v26, v40
  v_add_f32 v72, v72, v41
  v_add_f32 v26, v26, v42
  v_add_f32 v72, v72, v43
  v_add_f32 v26, v26, v44
  v_add_f32 v72, v72, v45
  v_mfma_f32_32x32x16_bf16 v[176:191], a[56:59], a[52:55], v[176:191]
  ds_read_b64_tr_b16 a[8:9], v14 offset:0
  ds_read_b64_tr_b16 a[10:11], v14 offset:512
  v_add_f32 v26, v26, v46
  v_add_f32 v72, v72, v47
  v_add_f32 v26, v26, v72
  v_mov_b32 v25, v24
  v_mov_b32 v27, v26
  s_nop 0
  v_permlane32_swap_b32 v24, v25
  v_permlane32_swap_b32 v26, v27
  v_add_f32 v24, v24, v25
  s_waitcnt lgkmcnt(12)
  v_mfma_f32_32x32x16_bf16 v[160:175], a[68:71], a[60:63], v[160:175]
  ds_read_b128 a[12:15], v10 offset:32768
  ds_read_b128 a[16:19], v10 offset:36864
  v_add_f32 v26, v26, v27
  v_rcp_f32 v28, v24
  v_rcp_f32 v30, v26
  s_nop 0
  v_mul_f32 v80, v28, v80
  v_mul_f32 v81, v28, v81
  v_mul_f32 v82, v28, v82
  v_mfma_f32_32x32x16_bf16 v[176:191], a[68:71], a[64:67], v[176:191]
  ds_read_b64_tr_b16 a[20:21], v14 offset:2048
  ds_read_b64_tr_b16 a[22:23], v14 offset:2560
  v_mul_f32 v83, v28, v83
  v_mul_f32 v84, v28, v84
  v_mul_f32 v85, v28, v85
  v_mul_f32 v86, v28, v86
  v_mul_f32 v87, v28, v87
  v_mul_f32 v88, v28, v88
  v_mul_f32 v89, v28, v89
  v_mul_f32 v90, v28, v90
  v_mul_f32 v91, v28, v91
  s_waitcnt lgkmcnt(12)
  v_mfma_f32_32x32x16_bf16 v[160:175], a[80:83], a[72:75], v[160:175]
  ds_read_b128 a[24:27], v11 offset:32768
  ds_read_b128 a[28:31], v11 offset:36864
  v_mul_f32 v92, v28, v92
  v_mul_f32 v93, v28, v93
  v_mul_f32 v94, v28, v94
  v_mul_f32 v95, v28, v95
  v_mul_f32 v32, v30, v32
  v_mul_f32 v33, v30, v33
  v_mul_f32 v34, v30, v34
  v_mul_f32 v35, v30, v35
  v_mul_f32 v36, v30, v36
  v_mfma_f32_32x32x16_bf16 v[176:191], a[80:83], a[76:79], v[176:191]
  ds_read_b64_tr_b16 a[32:33], v14 offset:4096
  ds_read_b64_tr_b16 a[34:35], v14 offset:4608
  v_mul_f32 v37, v30, v37
  v_mul_f32 v38, v30, v38
  v_mul_f32 v39, v30, v39
  v_mul_f32 v40, v30, v40
  v_mul_f32 v41, v30, v41
  v_mul_f32 v42, v30, v42
  v_mul_f32 v43, v30, v43
  v_mul_f32 v44, v30, v44
  v_mul_f32 v45, v30, v45
  s_waitcnt lgkmcnt(12)
  v_mfma_f32_32x32x16_bf16 v[160:175], a[92:95], a[84:87], v[160:175]
  ds_read_b128 a[36:39], v12 offset:32768
  ds_read_b128 a[40:43], v12 offset:36864
  v_mul_f32 v46, v30, v46
  v_mul_f32 v47, v30, v47
  v_cvt_pk_bf16_f32 v112, v80, v81
  v_cvt_pk_bf16_f32 v113, v82, v83
  v_cvt_pk_bf16_f32 v114, v84, v85
  v_cvt_pk_bf16_f32 v115, v86, v87
  v_cvt_pk_bf16_f32 v116, v88, v89
  v_cvt_pk_bf16_f32 v117, v90, v91
  v_cvt_pk_bf16_f32 v118, v92, v93
  v_mfma_f32_32x32x16_bf16 v[176:191], a[92:95], a[88:91], v[176:191]
  ds_read_b64_tr_b16 a[44:45], v14 offset:6144
  ds_read_b64_tr_b16 a[46:47], v14 offset:6656
  v_cvt_pk_bf16_f32 v119, v94, v95
  v_cvt_pk_bf16_f32 v120, v32, v33
  v_cvt_pk_bf16_f32 v121, v34, v35
  v_cvt_pk_bf16_f32 v122, v36, v37
  v_cvt_pk_bf16_f32 v123, v38, v39
  v_cvt_pk_bf16_f32 v124, v40, v41
  v_cvt_pk_bf16_f32 v125, v42, v43
  v_cvt_pk_bf16_f32 v126, v44, v45
  v_cvt_pk_bf16_f32 v127, v46, v47
  s_waitcnt lgkmcnt(12)
  v_mfma_f32_32x32x16_bf16 v[160:175], a[8:11], a[0:3], v[160:175]
  v_mfma_f32_32x32x16_bf16 v[176:191], a[8:11], a[4:7], v[176:191]
  s_waitcnt lgkmcnt(8)
  v_mfma_f32_32x32x16_bf16 v[160:175], a[20:23], a[12:15], v[160:175]
  v_mfma_f32_32x32x16_bf16 v[176:191], a[20:23], a[16:19], v[176:191]
  s_waitcnt lgkmcnt(4)
  v_mfma_f32_32x32x16_bf16 v[160:175], a[32:35], a[24:27], v[160:175]
  v_mfma_f32_32x32x16_bf16 v[176:191], a[32:35], a[28:31], v[176:191]
  s_waitcnt lgkmcnt(0)
  v_mfma_f32_32x32x16_bf16 v[160:175], a[44:47], a[36:39], v[160:175]
  v_mfma_f32_32x32x16_bf16 v[176:191], a[44:47], a[40:43], v[176:191]
  s_nop 10
  v_and_b32 v16, 31, v0
  s_lshl_b32 s72, s59, 6
  v_add_u32 v16, s72, v16
  v_mul_u32_u24 v16, 72, v16
  v_lshrrev_b32 v17, 5, v0
  v_lshl_add_u32 v16, v17, 3, v16
  s_mul_i32 s72, s60, 18432
  v_add_u32 v16, s72, v16
  s_lshl_b32 s72, s60, 13
  s_lshl_b32 s73, s59, 12
  s_add_u32 s72, s72, s73
  s_add_u32 s72, s72, 36864
  v_add_u32 v17, s72, v1
  s_barrier
  ds_write_b64 v16, v[96:97] offset:0
  v_cvt_pk_bf16_f32 v32, v160, v161
  v_cvt_pk_bf16_f32 v33, v162, v163
  ds_write_b64 v16, v[98:99] offset:16
  v_cvt_pk_bf16_f32 v34, v164, v165
  v_cvt_pk_bf16_f32 v35, v166, v167
  ds_write_b64 v16, v[100:101] offset:32
  v_cvt_pk_bf16_f32 v36, v168, v169
  v_cvt_pk_bf16_f32 v37, v170, v171
  ds_write_b64 v16, v[102:103] offset:48
  v_cvt_pk_bf16_f32 v38, v172, v173
  v_cvt_pk_bf16_f32 v39, v174, v175
  ds_write_b64 v16, v[104:105] offset:9216
  v_cvt_pk_bf16_f32 v40, v176, v177
  v_cvt_pk_bf16_f32 v41, v178, v179
  ds_write_b64 v16, v[106:107] offset:9232
  v_cvt_pk_bf16_f32 v42, v180, v181
  v_cvt_pk_bf16_f32 v43, v182, v183
  ds_write_b64 v16, v[108:109] offset:9248
  v_cvt_pk_bf16_f32 v44, v184, v185
  v_cvt_pk_bf16_f32 v45, v186, v187
  ds_write_b64 v16, v[110:111] offset:9264
  v_cvt_pk_bf16_f32 v46, v188, v189
  v_cvt_pk_bf16_f32 v47, v190, v191
  ds_write_b128 v17, v[128:131] offset:0
  s_mov_b32 exec_lo, 0
  v_mov_b32 v38, 0
  v_mov_b32 v39, 0
  v_mov_b32 v46, 0
  v_mov_b32 v47, 0
  s_mov_b32 exec_lo, -1
  ds_write_b128 v17, v[132:135] offset:1024
  s_nop 0
  v_mfma_f32_32x32x16_bf16 v[48:63], v[208:211], v[32:35], 0
  ds_write_b64 v16, v[112:113] offset:2304
  v_mfma_f32_32x32x16_bf16 v[48:63], v[212:215], v[36:39], v[48:63]
  ds_write_b64 v16, v[114:115] offset:2320
  v_mfma_f32_32x32x16_bf16 v[64:79], v[208:211], v[40:43], 0
  ds_write_b64 v16, v[116:117] offset:2336
  v_mfma_f32_32x32x16_bf16 v[64:79], v[212:215], v[44:47], v[64:79]
  ds_write_b64 v16, v[118:119] offset:2352
  s_nop 10
  ds_write_b64 v16, v[120:121] offset:11520
  v_pk_mul_f32 v[48:49], v[48:49], s[70:71]
  v_pk_mul_f32 v[50:51], v[50:51], s[70:71]
  ds_write_b64 v16, v[122:123] offset:11536
  v_pk_mul_f32 v[52:53], v[52:53], s[70:71]
  v_pk_mul_f32 v[54:55], v[54:55], s[70:71]
  ds_write_b64 v16, v[124:125] offset:11552
  v_pk_mul_f32 v[56:57], v[56:57], s[70:71]
  v_pk_mul_f32 v[58:59], v[58:59], s[70:71]
  ds_write_b64 v16, v[126:127] offset:11568
  v_pk_mul_f32 v[60:61], v[60:61], s[70:71]
  v_pk_mul_f32 v[62:63], v[62:63], s[70:71]
  ds_write_b128 v17, v[144:147] offset:2048
  v_max3_f32 v24, v48, v49, v50
  v_min3_f32 v26, v48, v49, v50
  v_max3_f32 v24, v24, v51, v52
  ds_write_b128 v17, v[148:151] offset:3072
  v_min3_f32 v26, v26, v51, v52
  v_max3_f32 v24, v24, v53, v54
  v_min3_f32 v26, v26, v53, v54
  v_max3_f32 v24, v24, v55, v56
  v_min3_f32 v26, v26, v55, v56
  v_max3_f32 v24, v24, v57, v58
  v_min3_f32 v26, v26, v57, v58
  v_max3_f32 v24, v24, v59, v60
  v_min3_f32 v26, v26, v59, v60
  v_max3_f32 v24, v24, v61, v62
  v_min3_f32 v26, v26, v61, v62
  v_max_f32 v24, v24, v63
  v_min_f32 v26, v26, v63
  v_mov_b32 v25, v24
  v_mov_b32 v27, v26
  s_nop 0
  v_permlane32_swap_b32 v24, v25
  v_permlane32_swap_b32 v26, v27
  v_max_f32 v24, v24, v25
  v_min_f32 v26, v26, v27
  v_pk_add_f32 v[80:81], v[48:49], v[24:25] op_sel_hi:[1,0] neg_lo:[0,1] neg_hi:[0,1]
  v_pk_add_f32 v[32:33], v[48:49], v[26:27] op_sel_hi:[1,0] neg_lo:[1,0] neg_hi:[1,0]
  v_pk_add_f32 v[82:83], v[50:51], v[24:25] op_sel_hi:[1,0] neg_lo:[0,1] neg_hi:[0,1]
  v_pk_add_f32 v[34:35], v[50:51], v[26:27] op_sel_hi:[1,0] neg_lo:[1,0] neg_hi:[1,0]
  v_pk_add_f32 v[84:85], v[52:53], v[24:25] op_sel_hi:[1,0] neg_lo:[0,1] neg_hi:[0,1]
  v_pk_add_f32 v[36:37], v[52:53], v[26:27] op_sel_hi:[1,0] neg_lo:[1,0] neg_hi:[1,0]
  v_pk_add_f32 v[86:87], v[54:55], v[24:25] op_sel_hi:[1,0] neg_lo:[0,1] neg_hi:[0,1]
  v_pk_add_f32 v[38:39], v[54:55], v[26:27] op_sel_hi:[1,0] neg_lo:[1,0] neg_hi:[1,0]
  v_pk_add_f32 v[88:89], v[56:57], v[24:25] op_sel_hi:[1,0] neg_lo:[0,1] neg_hi:[0,1]
  v_pk_add_f32 v[40:41], v[56:57], v[26:27] op_sel_hi:[1,0] neg_lo:[1,0] neg_hi:[1,0]
  v_pk_add_f32 v[90:91], v[58:59], v[24:25] op_sel_hi:[1,0] neg_lo:[0,1] neg_hi:[0,1]
  v_pk_add_f32 v[42:43], v[58:59], v[26:27] op_sel_hi:[1,0] neg_lo:[1,0] neg_hi:[1,0]
  v_pk_add_f32 v[92:93], v[60:61], v[24:25] op_sel_hi:[1,0] neg_lo:[0,1] neg_hi:[0,1]
  v_lshrrev_b32 v16, 5, v0
  v_lshlrev_b32 v16, 2, v16
  v_bfe_u32 v17, v0, 2, 2
  v_add_u32 v16, v16, v17
  v_mul_u32_u24 v16, 72, v16
  v_bfe_u32 v17, v0, 4, 1
  v_lshl_add_u32 v16, v17, 5, v16
  v_and_b32 v17, 3, v0
  v_lshl_add_u32 v16, v17, 3, v16
  s_mul_i32 s72, s55, 9216
  v_add_u32 v16, s72, v16
  s_lshl_b32 s72, s60, 13
  s_add_u32 s72, s72, 36864
  v_add_u32 v17, s72, v1
  s_waitcnt lgkmcnt(0)
  s_barrier
  ds_read_b64_tr_b16 a[0:1], v16 offset:0
  ds_read_b64_tr_b16 a[2:3], v16 offset:576
  ds_read_b128 a[32:35], v17 offset:0
  ds_read_b64_tr_b16 a[4:5], v16 offset:1152
  ds_read_b64_tr_b16 a[6:7], v16 offset:1728
  ds_read_b128 a[36:39], v17 offset:1024
  ds_read_b64_tr_b16 a[8:9], v16 offset:2304
  ds_read_b64_tr_b16 a[10:11], v16 offset:2880
  ds_read_b128 a[40:43], v17 offset:2048
  ds_read_b64_tr_b16 a[12:13], v16 offset:3456
  ds_read_b64_tr_b16 a[14:15], v16 offset:4032
  ds_read_b128 a[44:47], v17 offset:3072
  ds_read_b64_tr_b16 a[16:17], v16 offset:4608
  ds_read_b64_tr_b16 a[18:19], v16 offset:5184
  ds_read_b128 a[48:51], v17 offset:4096
  v_pk_add_f32 v[44:45], v[60:61], v[26:27] op_sel_hi:[1,0] neg_lo:[1,0] neg_hi:[1,0]
  v_pk_add_f32 v[94:95], v[62:63], v[24:25] op_sel_hi:[1,0] neg_lo:[0,1] neg_hi:[0,1]
  v_pk_add_f32 v[46:47], v[62:63], v[26:27] op_sel_hi:[1,0] neg_lo:[1,0] neg_hi:[1,0]
  v_exp_f32 v80, v80
  v_exp_f32 v81, v81
  v_exp_f32 v82, v82
  v_exp_f32 v83, v83
  v_exp_f32 v84, v84
  v_exp_f32 v85, v85
  ds_read_b64_tr_b16 a[20:21], v16 offset:5760
  ds_read_b64_tr_b16 a[22:23], v16 offset:6336
  ds_read_b128 a[52:55], v17 offset:5120
  ds_read_b64_tr_b16 a[24:25], v16 offset:6912
  ds_read_b64_tr_b16 a[26:27], v16 offset:7488
  ds_read_b128 a[56:59], v17 offset:6144
  ds_read_b64_tr_b16 a[28:29], v16 offset:8064
  ds_read_b64_tr_b16 a[30:31], v16 offset:8640
  ds_read_b128 a[60:63], v17 offset:7168
  v_exp_f32 v86, v86
  v_exp_f32 v87, v87
  v_exp_f32 v88, v88
  v_exp_f32 v89, v89
  v_exp_f32 v90, v90
  v_exp_f32 v91, v91
  v_exp_f32 v92, v92
  v_exp_f32 v93, v93
  s_waitcnt lgkmcnt(15)
  v_mfma_f32_32x32x16_bf16 v[96:111], a[0:3], a[32:35], 0
  v_exp_f32 v94, v94
  v_exp_f32 v95, v95
  v_exp_f32 v32, v32
  v_mfma_f32_32x32x16_bf16 v[96:111], a[4:7], a[36:39], v[96:111]
  v_exp_f32 v33, v33
  v_exp_f32 v34, v34
  v_exp_f32 v35, v35
  v_mfma_f32_32x32x16_bf16 v[96:111], a[8:11], a[40:43], v[96:111]
  v_exp_f32 v36, v36
  v_exp_f32 v37, v37
  v_exp_f32 v38, v38
  s_waitcnt lgkmcnt(12)
  v_mfma_f32_32x32x16_bf16 v[96:111], a[12:15], a[44:47], v[96:111]
  v_exp_f32 v39, v39
  v_exp_f32 v40, v40
  v_exp_f32 v41, v41
  s_waitcnt lgkmcnt(9)
  v_mfma_f32_32x32x16_bf16 v[96:111], a[16:19], a[48:51], v[96:111]
  v_exp_f32 v42, v42
  v_exp_f32 v43, v43
  v_exp_f32 v44, v44
  s_waitcnt lgkmcnt(6)
  v_mfma_f32_32x32x16_bf16 v[96:111], a[20:23], a[52:55], v[96:111]
  v_exp_f32 v45, v45
  v_exp_f32 v46, v46
  v_exp_f32 v47, v47
  s_waitcnt lgkmcnt(3)
  v_mfma_f32_32x32x16_bf16 v[96:111], a[24:27], a[56:59], v[96:111]
  s_mov_b32 exec_lo, 0
  v_mov_b32 v92, 0
  v_mov_b32 v44, 0
  v_mov_b32 v93, 0
  v_mov_b32 v45, 0
  v_mov_b32 v94, 0
  v_mov_b32 v46, 0
  v_mov_b32 v95, 0
  v_mov_b32 v47, 0
  s_mov_b32 exec_lo, -1
  s_waitcnt lgkmcnt(0)
  v_mfma_f32_32x32x16_bf16 v[96:111], a[28:31], a[60:63], v[96:111]
  v_pk_add_f32 v[48:49], v[80:81], v[82:83]
  v_pk_add_f32 v[50:51], v[84:85], v[86:87]
  v_pk_add_f32 v[52:53], v[88:89], v[90:91]
  v_pk_add_f32 v[54:55], v[92:93], v[94:95]
  v_pk_add_f32 v[48:49], v[48:49], v[50:51]
  v_pk_add_f32 v[52:53], v[52:53], v[54:55]
  v_pk_add_f32 v[48:49], v[48:49], v[52:53]
  v_add_f32 v24, v48, v49
  v_pk_add_f32 v[56:57], v[32:33], v[34:35]
  v_pk_add_f32 v[58:59], v[36:37], v[38:39]
  v_pk_add_f32 v[60:61], v[40:41], v[42:43]
  v_pk_add_f32 v[62:63], v[44:45], v[46:47]
  v_pk_add_f32 v[56:57], v[56:57], v[58:59]
  v_pk_add_f32 v[60:61], v[60:61], v[62:63]
  v_pk_add_f32 v[56:57], v[56:57], v[60:61]
  v_add_f32 v26, v56, v57
  v_mov_b32 v25, v24
  v_mov_b32 v27, v26
  s_nop 0
  v_permlane32_swap_b32 v24, v25
  v_permlane32_swap_b32 v26, v27
  s_lshl_b32 s72, s92, 4
  s_add_u32 s72, s72, s54
  s_lshl_b32 s72, s72, 13
  s_lshl_b32 s73, s59, 12
  s_add_u32 s72, s72, s73
  s_add_u32 s72, s72, 5242880
  buffer_store_dwordx4 v[96:99], v1, s[40:43], s72 offen offset:0 sc1
  buffer_store_dwordx4 v[100:103], v1, s[40:43], s72 offen offset:1024 sc1
  buffer_store_dwordx4 v[104:107], v1, s[40:43], s72 offen offset:2048 sc1
  buffer_store_dwordx4 v[108:111], v1, s[40:43], s72 offen offset:3072 sc1
  v_add_f32 v24, v24, v25
  v_add_f32 v26, v26, v27
  v_rcp_f32 v28, v24
  v_rcp_f32 v30, v26
  s_nop 0
  v_pk_mul_f32 v[80:81], v[80:81], v[28:29] op_sel_hi:[1,0]
  v_pk_mul_f32 v[82:83], v[82:83], v[28:29] op_sel_hi:[1,0]
  v_pk_mul_f32 v[84:85], v[84:85], v[28:29] op_sel_hi:[1,0]
  v_pk_mul_f32 v[86:87], v[86:87], v[28:29] op_sel_hi:[1,0]
  v_pk_mul_f32 v[88:89], v[88:89], v[28:29] op_sel_hi:[1,0]
  v_pk_mul_f32 v[90:91], v[90:91], v[28:29] op_sel_hi:[1,0]
  v_pk_mul_f32 v[92:93], v[92:93], v[28:29] op_sel_hi:[1,0]
  v_pk_mul_f32 v[94:95], v[94:95], v[28:29] op_sel_hi:[1,0]
  v_pk_mul_f32 v[32:33], v[32:33], v[30:31] op_sel_hi:[1,0]
  v_pk_mul_f32 v[34:35], v[34:35], v[30:31] op_sel_hi:[1,0]
  v_pk_mul_f32 v[36:37], v[36:37], v[30:31] op_sel_hi:[1,0]
  v_pk_mul_f32 v[38:39], v[38:39], v[30:31] op_sel_hi:[1,0]
  v_pk_mul_f32 v[40:41], v[40:41], v[30:31] op_sel_hi:[1,0]
  v_pk_mul_f32 v[42:43], v[42:43], v[30:31] op_sel_hi:[1,0]
  v_pk_mul_f32 v[44:45], v[44:45], v[30:31] op_sel_hi:[1,0]
  v_pk_mul_f32 v[46:47], v[46:47], v[30:31] op_sel_hi:[1,0]
  v_cvt_pk_bf16_f32 v224, v80, v81
  v_cvt_pk_bf16_f32 v225, v82, v83
  v_cvt_pk_bf16_f32 v226, v84, v85
  v_cvt_pk_bf16_f32 v227, v86, v87
  v_cvt_pk_bf16_f32 v228, v88, v89
  v_cvt_pk_bf16_f32 v229, v90, v91
  v_cvt_pk_bf16_f32 v230, v92, v93
  v_cvt_pk_bf16_f32 v231, v94, v95
  v_cvt_pk_bf16_f32 v232, v32, v33
  v_cvt_pk_bf16_f32 v233, v34, v35
  v_cvt_pk_bf16_f32 v234, v36, v37
  v_cvt_pk_bf16_f32 v235, v38, v39
  v_cvt_pk_bf16_f32 v236, v40, v41
  v_cvt_pk_bf16_f32 v237, v42, v43
  v_cvt_pk_bf16_f32 v238, v44, v45
  s_lshr_b32 s82, s57, 1
  s_lshl_b32 s82, s82, 7
  s_add_u32 s82, s82, 8192
  v_and_b32 v19, 15, v0
  v_lshlrev_b32 v19, 2, v19
  buffer_load_dword v20, v19, s[40:43], s82 offen sc1
  v_cvt_pk_bf16_f32 v239, v46, v47
  v_pk_mul_f32 v[64:65], v[64:65], s[70:71]
  v_pk_mul_f32 v[66:67], v[66:67], s[70:71]
  v_pk_mul_f32 v[68:69], v[68:69], s[70:71]
  v_pk_mul_f32 v[70:71], v[70:71], s[70:71]
  v_pk_mul_f32 v[72:73], v[72:73], s[70:71]
  v_pk_mul_f32 v[74:75], v[74:75], s[70:71]
  v_pk_mul_f32 v[76:77], v[76:77], s[70:71]
  v_pk_mul_f32 v[78:79], v[78:79], s[70:71]
  v_max3_f32 v24, v64, v65, v66
  v_min3_f32 v26, v64, v65, v66
  v_max3_f32 v24, v24, v67, v68
  v_min3_f32 v26, v26, v67, v68
  v_max3_f32 v24, v24, v69, v70
  v_min3_f32 v26, v26, v69, v70
  v_max3_f32 v24, v24, v71, v72
  v_min3_f32 v26, v26, v71, v72
  v_max3_f32 v24, v24, v73, v74
  v_min3_f32 v26, v26, v73, v74
  v_max3_f32 v24, v24, v75, v76
  v_min3_f32 v26, v26, v75, v76
  v_max3_f32 v24, v24, v77, v78
  v_min3_f32 v26, v26, v77, v78
  v_max_f32 v24, v24, v79
  v_min_f32 v26, v26, v79
  v_mov_b32 v25, v24
  v_mov_b32 v27, v26
  s_nop 0
  v_permlane32_swap_b32 v24, v25
  v_permlane32_swap_b32 v26, v27
  v_max_f32 v24, v24, v25
  v_min_f32 v26, v26, v27
  v_pk_add_f32 v[80:81], v[64:65], v[24:25] op_sel_hi:[1,0] neg_lo:[0,1] neg_hi:[0,1]
  v_pk_add_f32 v[32:33], v[64:65], v[26:27] op_sel_hi:[1,0] neg_lo:[1,0] neg_hi:[1,0]
  v_pk_add_f32 v[82:83], v[66:67], v[24:25] op_sel_hi:[1,0] neg_lo:[0,1] neg_hi:[0,1]
  v_pk_add_f32 v[34:35], v[66:67], v[26:27] op_sel_hi:[1,0] neg_lo:[1,0] neg_hi:[1,0]
  v_pk_add_f32 v[84:85], v[68:69], v[24:25] op_sel_hi:[1,0] neg_lo:[0,1] neg_hi:[0,1]
  v_pk_add_f32 v[36:37], v[68:69], v[26:27] op_sel_hi:[1,0] neg_lo:[1,0] neg_hi:[1,0]
  v_pk_add_f32 v[86:87], v[70:71], v[24:25] op_sel_hi:[1,0] neg_lo:[0,1] neg_hi:[0,1]
  v_pk_add_f32 v[38:39], v[70:71], v[26:27] op_sel_hi:[1,0] neg_lo:[1,0] neg_hi:[1,0]
  v_pk_add_f32 v[88:89], v[72:73], v[24:25] op_sel_hi:[1,0] neg_lo:[0,1] neg_hi:[0,1]
  v_pk_add_f32 v[40:41], v[72:73], v[26:27] op_sel_hi:[1,0] neg_lo:[1,0] neg_hi:[1,0]
  v_pk_add_f32 v[90:91], v[74:75], v[24:25] op_sel_hi:[1,0] neg_lo:[0,1] neg_hi:[0,1]
  v_pk_add_f32 v[42:43], v[74:75], v[26:27] op_sel_hi:[1,0] neg_lo:[1,0] neg_hi:[1,0]
  v_pk_add_f32 v[92:93], v[76:77], v[24:25] op_sel_hi:[1,0] neg_lo:[0,1] neg_hi:[0,1]
  v_pk_add_f32 v[44:45], v[76:77], v[26:27] op_sel_hi:[1,0] neg_lo:[1,0] neg_hi:[1,0]
  v_pk_add_f32 v[94:95], v[78:79], v[24:25] op_sel_hi:[1,0] neg_lo:[0,1] neg_hi:[0,1]
  v_pk_add_f32 v[46:47], v[78:79], v[26:27] op_sel_hi:[1,0] neg_lo:[1,0] neg_hi:[1,0]
  v_exp_f32 v80, v80
  v_exp_f32 v81, v81
  v_exp_f32 v82, v82
  v_exp_f32 v83, v83
  v_exp_f32 v84, v84
  v_exp_f32 v85, v85
  v_exp_f32 v86, v86
  v_exp_f32 v87, v87
  v_exp_f32 v88, v88
  v_exp_f32 v89, v89
  v_exp_f32 v90, v90
  v_exp_f32 v91, v91
  v_exp_f32 v92, v92
  v_exp_f32 v93, v93
  v_exp_f32 v94, v94
  v_exp_f32 v95, v95
  v_exp_f32 v32, v32
  v_exp_f32 v33, v33
  v_exp_f32 v34, v34
  v_exp_f32 v35, v35
  v_exp_f32 v36, v36
  v_exp_f32 v37, v37
  v_exp_f32 v38, v38
  v_exp_f32 v39, v39
  v_exp_f32 v40, v40
  v_exp_f32 v41, v41
  v_exp_f32 v42, v42
  v_exp_f32 v43, v43
  v_exp_f32 v44, v44
  v_exp_f32 v45, v45
  v_exp_f32 v46, v46
  v_exp_f32 v47, v47
  s_mov_b32 exec_lo, 0
  v_mov_b32 v92, 0
  v_mov_b32 v44, 0
  v_mov_b32 v93, 0
  v_mov_b32 v45, 0
  v_mov_b32 v94, 0
  v_mov_b32 v46, 0
  v_mov_b32 v95, 0
  v_mov_b32 v47, 0
  s_mov_b32 exec_lo, -1
  v_pk_add_f32 v[64:65], v[80:81], v[82:83]
  v_pk_add_f32 v[66:67], v[84:85], v[86:87]
  v_pk_add_f32 v[68:69], v[88:89], v[90:91]
  v_pk_add_f32 v[70:71], v[92:93], v[94:95]
  v_pk_add_f32 v[64:65], v[64:65], v[66:67]
  v_pk_add_f32 v[68:69], v[68:69], v[70:71]
  v_pk_add_f32 v[64:65], v[64:65], v[68:69]
  v_add_f32 v24, v64, v65
  v_pk_add_f32 v[72:73], v[32:33], v[34:35]
  v_pk_add_f32 v[74:75], v[36:37], v[38:39]
  v_pk_add_f32 v[76:77], v[40:41], v[42:43]
  v_pk_add_f32 v[78:79], v[44:45], v[46:47]
  v_pk_add_f32 v[72:73], v[72:73], v[74:75]
  v_pk_add_f32 v[76:77], v[76:77], v[78:79]
  v_pk_add_f32 v[72:73], v[72:73], v[76:77]
  v_add_f32 v26, v72, v73
  v_mov_b32 v25, v24
  v_mov_b32 v27, v26
  s_nop 0
  v_permlane32_swap_b32 v24, v25
  v_permlane32_swap_b32 v26, v27
  v_add_f32 v24, v24, v25
  v_add_f32 v26, v26, v27
  v_rcp_f32 v28, v24
  v_rcp_f32 v30, v26
  s_nop 0
  v_pk_mul_f32 v[80:81], v[80:81], v[28:29] op_sel_hi:[1,0]
  v_pk_mul_f32 v[82:83], v[82:83], v[28:29] op_sel_hi:[1,0]
  v_pk_mul_f32 v[84:85], v[84:85], v[28:29] op_sel_hi:[1,0]
  v_pk_mul_f32 v[86:87], v[86:87], v[28:29] op_sel_hi:[1,0]
  v_pk_mul_f32 v[88:89], v[88:89], v[28:29] op_sel_hi:[1,0]
  v_pk_mul_f32 v[90:91], v[90:91], v[28:29] op_sel_hi:[1,0]
  v_pk_mul_f32 v[92:93], v[92:93], v[28:29] op_sel_hi:[1,0]
  v_pk_mul_f32 v[94:95], v[94:95], v[28:29] op_sel_hi:[1,0]
  v_pk_mul_f32 v[32:33], v[32:33], v[30:31] op_sel_hi:[1,0]
  v_pk_mul_f32 v[34:35], v[34:35], v[30:31] op_sel_hi:[1,0]
  v_pk_mul_f32 v[36:37], v[36:37], v[30:31] op_sel_hi:[1,0]
  v_pk_mul_f32 v[38:39], v[38:39], v[30:31] op_sel_hi:[1,0]
  v_pk_mul_f32 v[40:41], v[40:41], v[30:31] op_sel_hi:[1,0]
  v_pk_mul_f32 v[42:43], v[42:43], v[30:31] op_sel_hi:[1,0]
  v_pk_mul_f32 v[44:45], v[44:45], v[30:31] op_sel_hi:[1,0]
  v_pk_mul_f32 v[46:47], v[46:47], v[30:31] op_sel_hi:[1,0]
  v_cvt_pk_bf16_f32 v240, v80, v81
  v_cvt_pk_bf16_f32 v241, v82, v83
  v_cvt_pk_bf16_f32 v242, v84, v85
  v_cvt_pk_bf16_f32 v243, v86, v87
  v_cvt_pk_bf16_f32 v244, v88, v89
  v_cvt_pk_bf16_f32 v245, v90, v91
  v_cvt_pk_bf16_f32 v246, v92, v93
  v_cvt_pk_bf16_f32 v247, v94, v95
  v_cvt_pk_bf16_f32 v248, v32, v33
  s_waitcnt vmcnt(0)
  v_cmp_ne_u32 vcc, s56, v20
  s_nop 1
  s_cbranch_vccnz L_spin_f1_20
L_back_f1_19:
  s_lshl_b32 s72, s92, 7
  s_lshl_b32 s73, s54, 3
  s_add_u32 s72, s72, s73
  s_lshl_b32 s73, s59, 2
  s_add_u32 s72, s72, s73
  s_add_u32 s72, s72, 12288
  v_mov_b32 v22, s72
  v_mov_b32 v23, s56
  s_mov_b64 exec, 1
  buffer_store_dword v23, v22, s[40:43], 0 offen sc1
  s_mov_b64 exec, -1
  s_lshl_b32 s80, s57, 18
  s_lshl_b32 s72, s55, 16
  s_add_u32 s80, s80, s72
  s_add_u32 s80, s80, 1048576
  s_lshl_b32 s72, s57, 6
  s_lshl_b32 s73, s58, 2
  s_add_u32 s72, s72, s73
  s_lshl_b32 s72, s72, 11
  s_add_u32 s72, s72, 12582912
  s_add_u32 s73, s55, 1
  s_and_b32 s73, s73, 3
  s_lshl_b32 s73, s73, 11
  s_add_u32 s83, s72, s73
  s_add_u32 s73, s55, 2
  s_and_b32 s73, s73, 3
  s_lshl_b32 s73, s73, 11
  s_add_u32 s84, s72, s73
  s_add_u32 s73, s55, 3
  s_and_b32 s73, s73, 3
  s_lshl_b32 s73, s73, 11
  s_add_u32 s85, s72, s73
  s_add_u32 s73, s55, 4
  s_and_b32 s73, s73, 3
  s_lshl_b32 s73, s73, 11
  s_add_u32 s86, s72, s73
  s_add_u32 s65, s80, 0
  buffer_load_dwordx4 a[0:3], v1, s[40:43], s65 offen offset:0 sc1
  buffer_load_dwordx4 a[4:7], v1, s[40:43], s65 offen offset:1024 sc1
  buffer_load_dwordx4 v[160:163], v1, s[40:43], s83 offen offset:0 sc1
  buffer_load_dwordx4 v[164:167], v1, s[40:43], s83 offen offset:1024 sc1
  buffer_load_dwordx4 v[168:171], v1, s[40:43], s84 offen offset:0 sc1
  buffer_load_dwordx4 v[172:175], v1, s[40:43], s84 offen offset:1024 sc1
  s_add_u32 s65, s80, 0
  buffer_load_dwordx4 a[8:11], v1, s[40:43], s65 offen offset:2048 sc1
  buffer_load_dwordx4 a[12:15], v1, s[40:43], s65 offen offset:3072 sc1
  v_cvt_pk_bf16_f32 v249, v34, v35
  v_cvt_pk_bf16_f32 v250, v36, v37
  v_cvt_pk_bf16_f32 v251, v38, v39
  v_cvt_pk_bf16_f32 v252, v40, v41
  v_cvt_pk_bf16_f32 v253, v42, v43
  v_cvt_pk_bf16_f32 v254, v44, v45
  v_cvt_pk_bf16_f32 v255, v46, v47
  buffer_load_dwordx4 v[176:179], v1, s[40:43], s85 offen offset:0 sc1
  buffer_load_dwordx4 v[180:183], v1, s[40:43], s85 offen offset:1024 sc1
  buffer_load_dwordx4 v[184:187], v1, s[40:43], s86 offen offset:0 sc1
  buffer_load_dwordx4 v[188:191], v1, s[40:43], s86 offen offset:1024 sc1
  s_add_u32 s65, s80, 4096
  buffer_load_dwordx4 a[16:19], v1, s[40:43], s65 offen offset:0 sc1
  buffer_load_dwordx4 a[20:23], v1, s[40:43], s65 offen offset:1024 sc1
  buffer_load_dwordx4 a[24:27], v1, s[40:43], s65 offen offset:2048 sc1
  buffer_load_dwordx4 a[28:31], v1, s[40:43], s65 offen offset:3072 sc1
  s_waitcnt lgkmcnt(0)
  s_barrier
  s_waitcnt vmcnt(12)
  v_mfma_f32_32x32x16_bf16 v[32:47], a[0:3], v[160:163], 0
  v_mfma_f32_32x32x16_bf16 v[32:47], a[4:7], v[164:167], v[32:47]
  s_nop 10
  s_waitcnt vmcnt(10)
  v_mfma_f32_32x32x16_bf16 v[48:63], a[0:3], v[168:171], 0
  v_exp_f32 v32, v32
  v_exp_f32 v33, v33
  v_exp_f32 v34, v34
  v_exp_f32 v35, v35
  v_cvt_pk_bf16_f32 v64, v32, v33
  v_mfma_f32_32x32x16_bf16 v[48:63], a[4:7], v[172:175], v[48:63]
  s_add_u32 s65, s80, 8192
  buffer_load_dwordx4 a[32:35], v1, s[40:43], s65 offen offset:0 sc1
  buffer_load_dwordx4 a[36:39], v1, s[40:43], s65 offen offset:1024 sc1
  buffer_load_dwordx4 a[40:43], v1, s[40:43], s65 offen offset:2048 sc1
  buffer_load_dwordx4 a[44:47], v1, s[40:43], s65 offen offset:3072 sc1
  v_exp_f32 v36, v36
  v_exp_f32 v37, v37
  v_cvt_pk_bf16_f32 v65, v34, v35
  v_exp_f32 v38, v38
  v_exp_f32 v39, v39
  v_cvt_pk_bf16_f32 v66, v36, v37
  v_exp_f32 v40, v40
  v_exp_f32 v41, v41
  v_cvt_pk_bf16_f32 v67, v38, v39
  v_exp_f32 v42, v42
  v_exp_f32 v43, v43
  v_cvt_pk_bf16_f32 v68, v40, v41
  v_exp_f32 v44, v44
  v_exp_f32 v45, v45
  v_cvt_pk_bf16_f32 v69, v42, v43
  v_exp_f32 v46, v46
  v_exp_f32 v47, v47
  v_cvt_pk_bf16_f32 v70, v44, v45
  v_cvt_pk_bf16_f32 v71, v46, v47
  s_waitcnt vmcnt(10)
  v_mfma_f32_32x32x16_bf16 v[32:47], a[0:3], v[176:179], 0
  v_exp_f32 v48, v48
  v_exp_f32 v49, v49
  v_exp_f32 v50, v50
  v_exp_f32 v51, v51
  v_cvt_pk_bf16_f32 v72, v48, v49
  v_mfma_f32_32x32x16_bf16 v[32:47], a[4:7], v[180:183], v[32:47]
  s_add_u32 s65, s80, 12288
  buffer_load_dwordx4 a[48:51], v1, s[40:43], s65 offen offset:0 sc1
  buffer_load_dwordx4 a[52:55], v1, s[40:43], s65 offen offset:1024 sc1
  buffer_load_dwordx4 a[56:59], v1, s[40:43], s65 offen offset:2048 sc1
  buffer_load_dwordx4 a[60:63], v1, s[40:43], s65 offen offset:3072 sc1
  v_exp_f32 v52, v52
  v_exp_f32 v53, v53
  v_cvt_pk_bf16_f32 v73, v50, v51
  v_exp_f32 v54, v54
  v_exp_f32 v55, v55
  v_cvt_pk_bf16_f32 v74, v52, v53
  v_mfma_f32_32x32x16_bf16 v[96:111], a[8:11], v[64:67], 0
  v_exp_f32 v56, v56
  v_exp_f32 v57, v57
  v_cvt_pk_bf16_f32 v75, v54, v55
  v_exp_f32 v58, v58
  v_exp_f32 v59, v59
  v_cvt_pk_bf16_f32 v76, v56, v57
  v_mfma_f32_32x32x16_bf16 v[96:111], a[12:15], v[68:71], v[96:111]
  v_exp_f32 v60, v60
  v_exp_f32 v61, v61
  v_cvt_pk_bf16_f32 v77, v58, v59
  v_exp_f32 v62, v62
  v_exp_f32 v63, v63
  v_cvt_pk_bf16_f32 v78, v60, v61
  v_cvt_pk_bf16_f32 v79, v62, v63
  s_waitcnt vmcnt(12)
  v_mfma_f32_32x32x16_bf16 v[48:63], a[0:3], v[184:187], 0
  v_exp_f32 v32, v32
  v_exp_f32 v33, v33
  v_exp_f32 v34, v34
  v_exp_f32 v35, v35
  v_cvt_pk_bf16_f32 v64, v32, v33
  v_mfma_f32_32x32x16_bf16 v[48:63], a[4:7], v[188:191], v[48:63]
  v_exp_f32 v36, v36
  v_exp_f32 v37, v37
  v_cvt_pk_bf16_f32 v65, v34, v35
  v_exp_f32 v38, v38
  v_exp_f32 v39, v39
  v_cvt_pk_bf16_f32 v66, v36, v37
  v_mfma_f32_32x32x16_bf16 v[112:127], a[8:11], v[72:75], 0
  v_exp_f32 v40, v40
  v_exp_f32 v41, v41
  v_cvt_pk_bf16_f32 v67, v38, v39
  v_exp_f32 v42, v42
  v_exp_f32 v43, v43
  v_cvt_pk_bf16_f32 v68, v40, v41
  v_mfma_f32_32x32x16_bf16 v[112:127], a[12:15], v[76:79], v[112:127]
  v_exp_f32 v44, v44
  v_exp_f32 v45, v45
  v_cvt_pk_bf16_f32 v69, v42, v43
  v_exp_f32 v46, v46
  v_exp_f32 v47, v47
  v_cvt_pk_bf16_f32 v70, v44, v45
  v_cvt_pk_bf16_f32 v71, v46, v47
  s_waitcnt vmcnt(8)
  v_mfma_f32_32x32x16_bf16 v[32:47], a[16:19], v[160:163], 0
  v_exp_f32 v48, v48
  v_exp_f32 v49, v49
  v_exp_f32 v50, v50
  v_exp_f32 v51, v51
  v_cvt_pk_bf16_f32 v72, v48, v49
  v_mfma_f32_32x32x16_bf16 v[32:47], a[20:23], v[164:167], v[32:47]
  v_exp_f32 v52, v52
  v_exp_f32 v53, v53
  v_cvt_pk_bf16_f32 v73, v50, v51
  v_exp_f32 v54, v54
  v_exp_f32 v55, v55
  v_cvt_pk_bf16_f32 v74, v52, v53
  v_mfma_f32_32x32x16_bf16 v[128:143], a[8:11], v[64:67], 0
  v_exp_f32 v56, v56
  v_exp_f32 v57, v57
  v_cvt_pk_bf16_f32 v75, v54, v55
  v_exp_f32 v58, v58
  v_exp_f32 v59, v59
  v_cvt_pk_bf16_f32 v76, v56, v57
  v_mfma_f32_32x32x16_bf16 v[128:143], a[12:15], v[68:71], v[128:143]
  v_exp_f32 v60, v60
  v_exp_f32 v61, v61
  v_cvt_pk_bf16_f32 v77, v58, v59
  v_exp_f32 v62, v62
  v_exp_f32 v63, v63
  v_cvt_pk_bf16_f32 v78, v60, v61
  v_cvt_pk_bf16_f32 v79, v62, v63
  v_mfma_f32_32x32x16_bf16 v[48:63], a[16:19], v[168:171], 0
  v_exp_f32 v32, v32
  v_exp_f32 v33, v33
  v_exp_f32 v34, v34
  v_exp_f32 v35, v35
  v_cvt_pk_bf16_f32 v64, v32, v33
  v_mfma_f32_32x32x16_bf16 v[48:63], a[20:23], v[172:175], v[48:63]
  v_exp_f32 v36, v36
  v_exp_f32 v37, v37
  v_cvt_pk_bf16_f32 v65, v34, v35
  v_exp_f32 v38, v38
  v_exp_f32 v39, v39
  v_cvt_pk_bf16_f32 v66, v36, v37
  v_mfma_f32_32x32x16_bf16 v[144:159], a[8:11], v[72:75], 0
  v_exp_f32 v40, v40
  v_exp_f32 v41, v41
  v_cvt_pk_bf16_f32 v67, v38, v39
  v_exp_f32 v42, v42
  v_exp_f32 v43, v43
  v_cvt_pk_bf16_f32 v68, v40, v41
  v_mfma_f32_32x32x16_bf16 v[144:159], a[12:15], v[76:79], v[144:159]
  v_exp_f32 v44, v44
  v_exp_f32 v45, v45
  v_cvt_pk_bf16_f32 v69, v42, v43
  v_exp_f32 v46, v46
  v_exp_f32 v47, v47
  v_cvt_pk_bf16_f32 v70, v44, v45
  v_cvt_pk_bf16_f32 v71, v46, v47
  v_mfma_f32_32x32x16_bf16 v[32:47], a[16:19], v[176:179], 0
  v_exp_f32 v48, v48
  v_exp_f32 v49, v49
  v_exp_f32 v50, v50
  v_exp_f32 v51, v51
  v_cvt_pk_bf16_f32 v72, v48, v49
  v_mfma_f32_32x32x16_bf16 v[32:47], a[20:23], v[180:183], v[32:47]
  s_add_u32 s65, s80, 16384
  buffer_load_dwordx4 a[0:3], v1, s[40:43], s65 offen offset:0 sc1
  buffer_load_dwordx4 a[4:7], v1, s[40:43], s65 offen offset:1024 sc1
  buffer_load_dwordx4 a[8:11], v1, s[40:43], s65 offen offset:2048 sc1
  buffer_load_dwordx4 a[12:15], v1, s[40:43], s65 offen offset:3072 sc1
  v_exp_f32 v52, v52
  v_exp_f32 v53, v53
  v_cvt_pk_bf16_f32 v73, v50, v51
  v_exp_f32 v54, v54
  v_exp_f32 v55, v55
  v_cvt_pk_bf16_f32 v74, v52, v53
  v_mfma_f32_32x32x16_bf16 v[96:111], a[24:27], v[64:67], v[96:111]
  v_exp_f32 v56, v56
  v_exp_f32 v57, v57
  v_cvt_pk_bf16_f32 v75, v54, v55
  v_exp_f32 v58, v58
  v_exp_f32 v59, v59
  v_cvt_pk_bf16_f32 v76, v56, v57
  v_mfma_f32_32x32x16_bf16 v[96:111], a[28:31], v[68:71], v[96:111]
  v_exp_f32 v60, v60
  v_exp_f32 v61, v61
  v_cvt_pk_bf16_f32 v77, v58, v59
  v_exp_f32 v62, v62
  v_exp_f32 v63, v63
  v_cvt_pk_bf16_f32 v78, v60, v61
  v_cvt_pk_bf16_f32 v79, v62, v63
  v_mfma_f32_32x32x16_bf16 v[48:63], a[16:19], v[184:187], 0
  v_exp_f32 v32, v32
  v_exp_f32 v33, v33
  v_exp_f32 v34, v34
  v_exp_f32 v35, v35
  v_cvt_pk_bf16_f32 v64, v32, v33
  v_mfma_f32_32x32x16_bf16 v[48:63], a[20:23], v[188:191], v[48:63]
  v_exp_f32 v36, v36
  v_exp_f32 v37, v37
  v_cvt_pk_bf16_f32 v65, v34, v35
  v_exp_f32 v38, v38
  v_exp_f32 v39, v39
  v_cvt_pk_bf16_f32 v66, v36, v37
  v_mfma_f32_32x32x16_bf16 v[112:127], a[24:27], v[72:75], v[112:127]
  v_exp_f32 v40, v40
  v_exp_f32 v41, v41
  v_cvt_pk_bf16_f32 v67, v38, v39
  v_exp_f32 v42, v42
  v_exp_f32 v43, v43
  v_cvt_pk_bf16_f32 v68, v40, v41
  v_mfma_f32_32x32x16_bf16 v[112:127], a[28:31], v[76:79], v[112:127]
  v_exp_f32 v44, v44
  v_exp_f32 v45, v45
  v_cvt_pk_bf16_f32 v69, v42, v43
  v_exp_f32 v46, v46
  v_exp_f32 v47, v47
  v_cvt_pk_bf16_f32 v70, v44, v45
  v_cvt_pk_bf16_f32 v71, v46, v47
  s_waitcnt vmcnt(8)
  v_mfma_f32_32x32x16_bf16 v[32:47], a[32:35], v[160:163], 0
  v_exp_f32 v48, v48
  v_exp_f32 v49, v49
  v_exp_f32 v50, v50
  v_exp_f32 v51, v51
  v_cvt_pk_bf16_f32 v72, v48, v49
  v_mfma_f32_32x32x16_bf16 v[32:47], a[36:39], v[164:167], v[32:47]
  v_exp_f32 v52, v52
  v_exp_f32 v53, v53
  v_cvt_pk_bf16_f32 v73, v50, v51
  v_exp_f32 v54, v54
  v_exp_f32 v55, v55
  v_cvt_pk_bf16_f32 v74, v52, v53
  v_mfma_f32_32x32x16_bf16 v[128:143], a[24:27], v[64:67], v[128:143]
  v_exp_f32 v56, v56
  v_exp_f32 v57, v57
  v_cvt_pk_bf16_f32 v75, v54, v55
  v_exp_f32 v58, v58
  v_exp_f32 v59, v59
  v_cvt_pk_bf16_f32 v76, v56, v57
  v_mfma_f32_32x32x16_bf16 v[128:143], a[28:31], v[68:71], v[128:143]
  v_exp_f32 v60, v60
  v_exp_f32 v61, v61
  v_cvt_pk_bf16_f32 v77, v58, v59
  v_exp_f32 v62, v62
  v_exp_f32 v63, v63
  v_cvt_pk_bf16_f32 v78, v60, v61
  v_cvt_pk_bf16_f32 v79, v62, v63
  v_mfma_f32_32x32x16_bf16 v[48:63], a[32:35], v[168:171], 0
  v_exp_f32 v32, v32
  v_exp_f32 v33, v33
  v_exp_f32 v34, v34
  v_exp_f32 v35, v35
  v_cvt_pk_bf16_f32 v64, v32, v33
  v_mfma_f32_32x32x16_bf16 v[48:63], a[36:39], v[172:175], v[48:63]
  v_exp_f32 v36, v36
  v_exp_f32 v37, v37
  v_cvt_pk_bf16_f32 v65, v34, v35
  v_exp_f32 v38, v38
  v_exp_f32 v39, v39
  v_cvt_pk_bf16_f32 v66, v36, v37
  v_mfma_f32_32x32x16_bf16 v[144:159], a[24:27], v[72:75], v[144:159]
  v_exp_f32 v40, v40
  v_exp_f32 v41, v41
  v_cvt_pk_bf16_f32 v67, v38, v39
  v_exp_f32 v42, v42
  v_exp_f32 v43, v43
  v_cvt_pk_bf16_f32 v68, v40, v41
  v_mfma_f32_32x32x16_bf16 v[144:159], a[28:31], v[76:79], v[144:159]
  v_exp_f32 v44, v44
  v_exp_f32 v45, v45
  v_cvt_pk_bf16_f32 v69, v42, v43
  v_exp_f32 v46, v46
  v_exp_f32 v47, v47
  v_cvt_pk_bf16_f32 v70, v44, v45
  v_cvt_pk_bf16_f32 v71, v46, v47
  v_mfma_f32_32x32x16_bf16 v[32:47], a[32:35], v[176:179], 0
  v_exp_f32 v48, v48
  v_exp_f32 v49, v49
  v_exp_f32 v50, v50
  v_exp_f32 v51, v51
  v_cvt_pk_bf16_f32 v72, v48, v49
  v_mfma_f32_32x32x16_bf16 v[32:47], a[36:39], v[180:183], v[32:47]
  s_add_u32 s65, s80, 20480
  buffer_load_dwordx4 a[16:19], v1, s[40:43], s65 offen offset:0 sc1
  buffer_load_dwordx4 a[20:23], v1, s[40:43], s65 offen offset:1024 sc1
  buffer_load_dwordx4 a[24:27], v1, s[40:43], s65 offen offset:2048 sc1
  buffer_load_dwordx4 a[28:31], v1, s[40:43], s65 offen offset:3072 sc1
  v_exp_f32 v52, v52
  v_exp_f32 v53, v53
  v_cvt_pk_bf16_f32 v73, v50, v51
  v_exp_f32 v54, v54
  v_exp_f32 v55, v55
  v_cvt_pk_bf16_f32 v74, v52, v53
  v_mfma_f32_32x32x16_bf16 v[96:111], a[40:43], v[64:67], v[96:111]
  v_exp_f32 v56, v56
  v_exp_f32 v57, v57
  v_cvt_pk_bf16_f32 v75, v54, v55
  v_exp_f32 v58, v58
  v_exp_f32 v59, v59
  v_cvt_pk_bf16_f32 v76, v56, v57
  v_mfma_f32_32x32x16_bf16 v[96:111], a[44:47], v[68:71], v[96:111]
  v_exp_f32 v60, v60
  v_exp_f32 v61, v61
  v_cvt_pk_bf16_f32 v77, v58, v59
  v_exp_f32 v62, v62
  v_exp_f32 v63, v63
  v_cvt_pk_bf16_f32 v78, v60, v61
  v_cvt_pk_bf16_f32 v79, v62, v63
  v_mfma_f32_32x32x16_bf16 v[48:63], a[32:35], v[184:187], 0
  v_exp_f32 v32, v32
  v_exp_f32 v33, v33
  v_exp_f32 v34, v34
  v_exp_f32 v35, v35
  v_cvt_pk_bf16_f32 v64, v32, v33
  v_mfma_f32_32x32x16_bf16 v[48:63], a[36:39], v[188:191], v[48:63]
  v_exp_f32 v36, v36
  v_exp_f32 v37, v37
  v_cvt_pk_bf16_f32 v65, v34, v35
  v_exp_f32 v38, v38
  v_exp_f32 v39, v39
  v_cvt_pk_bf16_f32 v66, v36, v37
  v_mfma_f32_32x32x16_bf16 v[112:127], a[40:43], v[72:75], v[112:127]
  v_exp_f32 v40, v40
  v_exp_f32 v41, v41
  v_cvt_pk_bf16_f32 v67, v38, v39
  v_exp_f32 v42, v42
  v_exp_f32 v43, v43
  v_cvt_pk_bf16_f32 v68, v40, v41
  v_mfma_f32_32x32x16_bf16 v[112:127], a[44:47], v[76:79], v[112:127]
  v_exp_f32 v44, v44
  v_exp_f32 v45, v45
  v_cvt_pk_bf16_f32 v69, v42, v43
  v_exp_f32 v46, v46
  v_exp_f32 v47, v47
  v_cvt_pk_bf16_f32 v70, v44, v45
  v_cvt_pk_bf16_f32 v71, v46, v47
  s_waitcnt vmcnt(8)
  v_mfma_f32_32x32x16_bf16 v[32:47], a[48:51], v[160:163], 0
  v_exp_f32 v48, v48
  v_exp_f32 v49, v49
  v_exp_f32 v50, v50
  v_exp_f32 v51, v51
  v_cvt_pk_bf16_f32 v72, v48, v49
  v_mfma_f32_32x32x16_bf16 v[32:47], a[52:55], v[164:167], v[32:47]
  v_exp_f32 v52, v52
  v_exp_f32 v53, v53
  v_cvt_pk_bf16_f32 v73, v50, v51
  v_exp_f32 v54, v54
  v_exp_f32 v55, v55
  v_cvt_pk_bf16_f32 v74, v52, v53
  v_mfma_f32_32x32x16_bf16 v[128:143], a[40:43], v[64:67], v[128:143]
  v_exp_f32 v56, v56
  v_exp_f32 v57, v57
  v_cvt_pk_bf16_f32 v75, v54, v55
  v_exp_f32 v58, v58
  v_exp_f32 v59, v59
  v_cvt_pk_bf16_f32 v76, v56, v57
  v_mfma_f32_32x32x16_bf16 v[128:143], a[44:47], v[68:71], v[128:143]
  v_exp_f32 v60, v60
  v_exp_f32 v61, v61
  v_cvt_pk_bf16_f32 v77, v58, v59
  v_exp_f32 v62, v62
  v_exp_f32 v63, v63
  v_cvt_pk_bf16_f32 v78, v60, v61
  v_cvt_pk_bf16_f32 v79, v62, v63
  v_mfma_f32_32x32x16_bf16 v[48:63], a[48:51], v[168:171], 0
  v_exp_f32 v32, v32
  v_exp_f32 v33, v33
  v_exp_f32 v34, v34
  v_exp_f32 v35, v35
  v_cvt_pk_bf16_f32 v64, v32, v33
  v_mfma_f32_32x32x16_bf16 v[48:63], a[52:55], v[172:175], v[48:63]
  v_exp_f32 v36, v36
  v_exp_f32 v37, v37
  v_cvt_pk_bf16_f32 v65, v34, v35
  v_exp_f32 v38, v38
  v_exp_f32 v39, v39
  v_cvt_pk_bf16_f32 v66, v36, v37
  v_mfma_f32_32x32x16_bf16 v[144:159], a[40:43], v[72:75], v[144:159]
  v_exp_f32 v40, v40
  v_exp_f32 v41, v41
  v_cvt_pk_bf16_f32 v67, v38, v39
  v_exp_f32 v42, v42
  v_exp_f32 v43, v43
  v_cvt_pk_bf16_f32 v68, v40, v41
  v_mfma_f32_32x32x16_bf16 v[144:159], a[44:47], v[76:79], v[144:159]
  v_exp_f32 v44, v44
  v_exp_f32 v45, v45
  v_cvt_pk_bf16_f32 v69, v42, v43
  v_exp_f32 v46, v46
  v_exp_f32 v47, v47
  v_cvt_pk_bf16_f32 v70, v44, v45
  v_cvt_pk_bf16_f32 v71, v46, v47
  v_mfma_f32_32x32x16_bf16 v[32:47], a[48:51], v[176:179], 0
  v_exp_f32 v48, v48
  v_exp_f32 v49, v49
  v_exp_f32 v50, v50
  v_exp_f32 v51, v51
  v_cvt_pk_bf16_f32 v72, v48, v49
  v_mfma_f32_32x32x16_bf16 v[32:47], a[52:55], v[180:183], v[32:47]
  s_add_u32 s65, s80, 24576
  buffer_load_dwordx4 a[32:35], v1, s[40:43], s65 offen offset:0 sc1
  buffer_load_dwordx4 a[36:39], v1, s[40:43], s65 offen offset:1024 sc1
  buffer_load_dwordx4 a[40:43], v1, s[40:43], s65 offen offset:2048 sc1
  buffer_load_dwordx4 a[44:47], v1, s[40:43], s65 offen offset:3072 sc1
  v_exp_f32 v52, v52
  v_exp_f32 v53, v53
  v_cvt_pk_bf16_f32 v73, v50, v51
  v_exp_f32 v54, v54
  v_exp_f32 v55, v55
  v_cvt_pk_bf16_f32 v74, v52, v53
  v_mfma_f32_32x32x16_bf16 v[96:111], a[56:59], v[64:67], v[96:111]
  v_exp_f32 v56, v56
  v_exp_f32 v57, v57
  v_cvt_pk_bf16_f32 v75, v54, v55
  v_exp_f32 v58, v58
  v_exp_f32 v59, v59
  v_cvt_pk_bf16_f32 v76, v56, v57
  v_mfma_f32_32x32x16_bf16 v[96:111], a[60:63], v[68:71], v[96:111]
  v_exp_f32 v60, v60
  v_exp_f32 v61, v61
  v_cvt_pk_bf16_f32 v77, v58, v59
  v_exp_f32 v62, v62
  v_exp_f32 v63, v63
  v_cvt_pk_bf16_f32 v78, v60, v61
  v_cvt_pk_bf16_f32 v79, v62, v63
  v_mfma_f32_32x32x16_bf16 v[48:63], a[48:51], v[184:187], 0
  v_exp_f32 v32, v32
  v_exp_f32 v33, v33
  v_exp_f32 v34, v34
  v_exp_f32 v35, v35
  v_cvt_pk_bf16_f32 v64, v32, v33
  v_mfma_f32_32x32x16_bf16 v[48:63], a[52:55], v[188:191], v[48:63]
  v_exp_f32 v36, v36
  v_exp_f32 v37, v37
  v_cvt_pk_bf16_f32 v65, v34, v35
  v_exp_f32 v38, v38
  v_exp_f32 v39, v39
  v_cvt_pk_bf16_f32 v66, v36, v37
  v_mfma_f32_32x32x16_bf16 v[112:127], a[56:59], v[72:75], v[112:127]
  v_exp_f32 v40, v40
  v_exp_f32 v41, v41
  v_cvt_pk_bf16_f32 v67, v38, v39
  v_exp_f32 v42, v42
  v_exp_f32 v43, v43
  v_cvt_pk_bf16_f32 v68, v40, v41
  v_mfma_f32_32x32x16_bf16 v[112:127], a[60:63], v[76:79], v[112:127]
  v_exp_f32 v44, v44
  v_exp_f32 v45, v45
  v_cvt_pk_bf16_f32 v69, v42, v43
  v_exp_f32 v46, v46
  v_exp_f32 v47, v47
  v_cvt_pk_bf16_f32 v70, v44, v45
  v_cvt_pk_bf16_f32 v71, v46, v47
  s_waitcnt vmcnt(8)
  v_mfma_f32_32x32x16_bf16 v[32:47], a[0:3], v[160:163], 0
  v_exp_f32 v48, v48
  v_exp_f32 v49, v49
  v_exp_f32 v50, v50
  v_exp_f32 v51, v51
  v_cvt_pk_bf16_f32 v72, v48, v49
  v_mfma_f32_32x32x16_bf16 v[32:47], a[4:7], v[164:167], v[32:47]
  v_exp_f32 v52, v52
  v_exp_f32 v53, v53
  v_cvt_pk_bf16_f32 v73, v50, v51
  v_exp_f32 v54, v54
  v_exp_f32 v55, v55
  v_cvt_pk_bf16_f32 v74, v52, v53
  v_mfma_f32_32x32x16_bf16 v[128:143], a[56:59], v[64:67], v[128:143]
  v_exp_f32 v56, v56
  v_exp_f32 v57, v57
  v_cvt_pk_bf16_f32 v75, v54, v55
  v_exp_f32 v58, v58
  v_exp_f32 v59, v59
  v_cvt_pk_bf16_f32 v76, v56, v57
  v_mfma_f32_32x32x16_bf16 v[128:143], a[60:63], v[68:71], v[128:143]
  v_exp_f32 v60, v60
  v_exp_f32 v61, v61
  v_cvt_pk_bf16_f32 v77, v58, v59
  v_exp_f32 v62, v62
  v_exp_f32 v63, v63
  v_cvt_pk_bf16_f32 v78, v60, v61
  v_cvt_pk_bf16_f32 v79, v62, v63
  v_mfma_f32_32x32x16_bf16 v[48:63], a[0:3], v[168:171], 0
  v_exp_f32 v32, v32
  v_exp_f32 v33, v33
  v_exp_f32 v34, v34
  v_exp_f32 v35, v35
  v_cvt_pk_bf16_f32 v64, v32, v33
  v_mfma_f32_32x32x16_bf16 v[48:63], a[4:7], v[172:175], v[48:63]
  v_exp_f32 v36, v36
  v_exp_f32 v37, v37
  v_cvt_pk_bf16_f32 v65, v34, v35
  v_exp_f32 v38, v38
  v_exp_f32 v39, v39
  v_cvt_pk_bf16_f32 v66, v36, v37
  v_mfma_f32_32x32x16_bf16 v[144:159], a[56:59], v[72:75], v[144:159]
  v_exp_f32 v40, v40
  v_exp_f32 v41, v41
  v_cvt_pk_bf16_f32 v67, v38, v39
  v_exp_f32 v42, v42
  v_exp_f32 v43, v43
  v_cvt_pk_bf16_f32 v68, v40, v41
  v_mfma_f32_32x32x16_bf16 v[144:159], a[60:63], v[76:79], v[144:159]
  v_exp_f32 v44, v44
  v_exp_f32 v45, v45
  v_cvt_pk_bf16_f32 v69, v42, v43
  v_exp_f32 v46, v46
  v_exp_f32 v47, v47
  v_cvt_pk_bf16_f32 v70, v44, v45
  v_cvt_pk_bf16_f32 v71, v46, v47
  v_mfma_f32_32x32x16_bf16 v[32:47], a[0:3], v[176:179], 0
  v_exp_f32 v48, v48
  v_exp_f32 v49, v49
  v_exp_f32 v50, v50
  v_exp_f32 v51, v51
  v_cvt_pk_bf16_f32 v72, v48, v49
  v_mfma_f32_32x32x16_bf16 v[32:47], a[4:7], v[180:183], v[32:47]
  s_add_u32 s65, s80, 28672
  buffer_load_dwordx4 a[48:51], v1, s[40:43], s65 offen offset:0 sc1
  buffer_load_dwordx4 a[52:55], v1, s[40:43], s65 offen offset:1024 sc1
  buffer_load_dwordx4 a[56:59], v1, s[40:43], s65 offen offset:2048 sc1
  buffer_load_dwordx4 a[60:63], v1, s[40:43], s65 offen offset:3072 sc1
  v_exp_f32 v52, v52
  v_exp_f32 v53, v53
  v_cvt_pk_bf16_f32 v73, v50, v51
  v_exp_f32 v54, v54
  v_exp_f32 v55, v55
  v_cvt_pk_bf16_f32 v74, v52, v53
  v_mfma_f32_32x32x16_bf16 v[96:111], a[8:11], v[64:67], v[96:111]
  v_exp_f32 v56, v56
  v_exp_f32 v57, v57
  v_cvt_pk_bf16_f32 v75, v54, v55
  v_exp_f32 v58, v58
  v_exp_f32 v59, v59
  v_cvt_pk_bf16_f32 v76, v56, v57
  v_mfma_f32_32x32x16_bf16 v[96:111], a[12:15], v[68:71], v[96:111]
  v_exp_f32 v60, v60
  v_exp_f32 v61, v61
  v_cvt_pk_bf16_f32 v77, v58, v59
  v_exp_f32 v62, v62
  v_exp_f32 v63, v63
  v_cvt_pk_bf16_f32 v78, v60, v61
  v_cvt_pk_bf16_f32 v79, v62, v63
  v_mfma_f32_32x32x16_bf16 v[48:63], a[0:3], v[184:187], 0
  v_exp_f32 v32, v32
  v_exp_f32 v33, v33
  v_exp_f32 v34, v34
  v_exp_f32 v35, v35
  v_cvt_pk_bf16_f32 v64, v32, v33
  v_mfma_f32_32x32x16_bf16 v[48:63], a[4:7], v[188:191], v[48:63]
  v_exp_f32 v36, v36
  v_exp_f32 v37, v37
  v_cvt_pk_bf16_f32 v65, v34, v35
  v_exp_f32 v38, v38
  v_exp_f32 v39, v39
  v_cvt_pk_bf16_f32 v66, v36, v37
  v_mfma_f32_32x32x16_bf16 v[112:127], a[8:11], v[72:75], v[112:127]
  v_exp_f32 v40, v40
  v_exp_f32 v41, v41
  v_cvt_pk_bf16_f32 v67, v38, v39
  v_exp_f32 v42, v42
  v_exp_f32 v43, v43
  v_cvt_pk_bf16_f32 v68, v40, v41
  v_mfma_f32_32x32x16_bf16 v[112:127], a[12:15], v[76:79], v[112:127]
  v_exp_f32 v44, v44
  v_exp_f32 v45, v45
  v_cvt_pk_bf16_f32 v69, v42, v43
  v_exp_f32 v46, v46
  v_exp_f32 v47, v47
  v_cvt_pk_bf16_f32 v70, v44, v45
  v_cvt_pk_bf16_f32 v71, v46, v47
  s_waitcnt vmcnt(8)
  v_mfma_f32_32x32x16_bf16 v[32:47], a[16:19], v[160:163], 0
  v_exp_f32 v48, v48
  v_exp_f32 v49, v49
  v_exp_f32 v50, v50
  v_exp_f32 v51, v51
  v_cvt_pk_bf16_f32 v72, v48, v49
  v_mfma_f32_32x32x16_bf16 v[32:47], a[20:23], v[164:167], v[32:47]
  v_exp_f32 v52, v52
  v_exp_f32 v53, v53
  v_cvt_pk_bf16_f32 v73, v50, v51
  v_exp_f32 v54, v54
  v_exp_f32 v55, v55
  v_cvt_pk_bf16_f32 v74, v52, v53
  v_mfma_f32_32x32x16_bf16 v[128:143], a[8:11], v[64:67], v[128:143]
  v_exp_f32 v56, v56
  v_exp_f32 v57, v57
  v_cvt_pk_bf16_f32 v75, v54, v55
  v_exp_f32 v58, v58
  v_exp_f32 v59, v59
  v_cvt_pk_bf16_f32 v76, v56, v57
  v_mfma_f32_32x32x16_bf16 v[128:143], a[12:15], v[68:71], v[128:143]
  v_exp_f32 v60, v60
  v_exp_f32 v61, v61
  v_cvt_pk_bf16_f32 v77, v58, v59
  v_exp_f32 v62, v62
  v_exp_f32 v63, v63
  v_cvt_pk_bf16_f32 v78, v60, v61
  v_cvt_pk_bf16_f32 v79, v62, v63
  v_mfma_f32_32x32x16_bf16 v[48:63], a[16:19], v[168:171], 0
  v_exp_f32 v32, v32
  v_exp_f32 v33, v33
  v_exp_f32 v34, v34
  v_exp_f32 v35, v35
  v_cvt_pk_bf16_f32 v64, v32, v33
  v_mfma_f32_32x32x16_bf16 v[48:63], a[20:23], v[172:175], v[48:63]
  v_exp_f32 v36, v36
  v_exp_f32 v37, v37
  v_cvt_pk_bf16_f32 v65, v34, v35
  v_exp_f32 v38, v38
  v_exp_f32 v39, v39
  v_cvt_pk_bf16_f32 v66, v36, v37
  v_mfma_f32_32x32x16_bf16 v[144:159], a[8:11], v[72:75], v[144:159]
  v_exp_f32 v40, v40
  v_exp_f32 v41, v41
  v_cvt_pk_bf16_f32 v67, v38, v39
  v_exp_f32 v42, v42
  v_exp_f32 v43, v43
  v_cvt_pk_bf16_f32 v68, v40, v41
  v_mfma_f32_32x32x16_bf16 v[144:159], a[12:15], v[76:79], v[144:159]
  v_exp_f32 v44, v44
  v_exp_f32 v45, v45
  v_cvt_pk_bf16_f32 v69, v42, v43
  v_exp_f32 v46, v46
  v_exp_f32 v47, v47
  v_cvt_pk_bf16_f32 v70, v44, v45
  v_cvt_pk_bf16_f32 v71, v46, v47
  v_mfma_f32_32x32x16_bf16 v[32:47], a[16:19], v[176:179], 0
  v_exp_f32 v48, v48
  v_exp_f32 v49, v49
  v_exp_f32 v50, v50
  v_exp_f32 v51, v51
  v_cvt_pk_bf16_f32 v72, v48, v49
  v_mfma_f32_32x32x16_bf16 v[32:47], a[20:23], v[180:183], v[32:47]
  s_add_u32 s65, s80, 32768
  buffer_load_dwordx4 a[0:3], v1, s[40:43], s65 offen offset:0 sc1
  buffer_load_dwordx4 a[4:7], v1, s[40:43], s65 offen offset:1024 sc1
  buffer_load_dwordx4 a[8:11], v1, s[40:43], s65 offen offset:2048 sc1
  buffer_load_dwordx4 a[12:15], v1, s[40:43], s65 offen offset:3072 sc1
  v_exp_f32 v52, v52
  v_exp_f32 v53, v53
  v_cvt_pk_bf16_f32 v73, v50, v51
  v_exp_f32 v54, v54
  v_exp_f32 v55, v55
  v_cvt_pk_bf16_f32 v74, v52, v53
  v_mfma_f32_32x32x16_bf16 v[96:111], a[24:27], v[64:67], v[96:111]
  v_exp_f32 v56, v56
  v_exp_f32 v57, v57
  v_cvt_pk_bf16_f32 v75, v54, v55
  v_exp_f32 v58, v58
  v_exp_f32 v59, v59
  v_cvt_pk_bf16_f32 v76, v56, v57
  v_mfma_f32_32x32x16_bf16 v[96:111], a[28:31], v[68:71], v[96:111]
  v_exp_f32 v60, v60
  v_exp_f32 v61, v61
  v_cvt_pk_bf16_f32 v77, v58, v59
  v_exp_f32 v62, v62
  v_exp_f32 v63, v63
  v_cvt_pk_bf16_f32 v78, v60, v61
  v_cvt_pk_bf16_f32 v79, v62, v63
  v_mfma_f32_32x32x16_bf16 v[48:63], a[16:19], v[184:187], 0
  v_exp_f32 v32, v32
  v_exp_f32 v33, v33
  v_exp_f32 v34, v34
  v_exp_f32 v35, v35
  v_cvt_pk_bf16_f32 v64, v32, v33
  v_mfma_f32_32x32x16_bf16 v[48:63], a[20:23], v[188:191], v[48:63]
  v_exp_f32 v36, v36
  v_exp_f32 v37, v37
  v_cvt_pk_bf16_f32 v65, v34, v35
  v_exp_f32 v38, v38
  v_exp_f32 v39, v39
  v_cvt_pk_bf16_f32 v66, v36, v37
  v_mfma_f32_32x32x16_bf16 v[112:127], a[24:27], v[72:75], v[112:127]
  v_exp_f32 v40, v40
  v_exp_f32 v41, v41
  v_cvt_pk_bf16_f32 v67, v38, v39
  v_exp_f32 v42, v42
  v_exp_f32 v43, v43
  v_cvt_pk_bf16_f32 v68, v40, v41
  v_mfma_f32_32x32x16_bf16 v[112:127], a[28:31], v[76:79], v[112:127]
  v_exp_f32 v44, v44
  v_exp_f32 v45, v45
  v_cvt_pk_bf16_f32 v69, v42, v43
  v_exp_f32 v46, v46
  v_exp_f32 v47, v47
  v_cvt_pk_bf16_f32 v70, v44, v45
  v_cvt_pk_bf16_f32 v71, v46, v47
  s_waitcnt vmcnt(8)
  v_mfma_f32_32x32x16_bf16 v[32:47], a[32:35], v[160:163], 0
  v_exp_f32 v48, v48
  v_exp_f32 v49, v49
  v_exp_f32 v50, v50
  v_exp_f32 v51, v51
  v_cvt_pk_bf16_f32 v72, v48, v49
  v_mfma_f32_32x32x16_bf16 v[32:47], a[36:39], v[164:167], v[32:47]
  v_exp_f32 v52, v52
  v_exp_f32 v53, v53
  v_cvt_pk_bf16_f32 v73, v50, v51
  v_exp_f32 v54, v54
  v_exp_f32 v55, v55
  v_cvt_pk_bf16_f32 v74, v52, v53
  v_mfma_f32_32x32x16_bf16 v[128:143], a[24:27], v[64:67], v[128:143]
  v_exp_f32 v56, v56
  v_exp_f32 v57, v57
  v_cvt_pk_bf16_f32 v75, v54, v55
  v_exp_f32 v58, v58
  v_exp_f32 v59, v59
  v_cvt_pk_bf16_f32 v76, v56, v57
  v_mfma_f32_32x32x16_bf16 v[128:143], a[28:31], v[68:71], v[128:143]
  v_exp_f32 v60, v60
  v_exp_f32 v61, v61
  v_cvt_pk_bf16_f32 v77, v58, v59
  v_exp_f32 v62, v62
  v_exp_f32 v63, v63
  v_cvt_pk_bf16_f32 v78, v60, v61
  v_cvt_pk_bf16_f32 v79, v62, v63
  v_mfma_f32_32x32x16_bf16 v[48:63], a[32:35], v[168:171], 0
  v_exp_f32 v32, v32
  v_exp_f32 v33, v33
  v_exp_f32 v34, v34
  v_exp_f32 v35, v35
  v_cvt_pk_bf16_f32 v64, v32, v33
  v_mfma_f32_32x32x16_bf16 v[48:63], a[36:39], v[172:175], v[48:63]
  v_exp_f32 v36, v36
  v_exp_f32 v37, v37
  v_cvt_pk_bf16_f32 v65, v34, v35
  v_exp_f32 v38, v38
  v_exp_f32 v39, v39
  v_cvt_pk_bf16_f32 v66, v36, v37
  v_mfma_f32_32x32x16_bf16 v[144:159], a[24:27], v[72:75], v[144:159]
  v_exp_f32 v40, v40
  v_exp_f32 v41, v41
  v_cvt_pk_bf16_f32 v67, v38, v39
  v_exp_f32 v42, v42
  v_exp_f32 v43, v43
  v_cvt_pk_bf16_f32 v68, v40, v41
  v_mfma_f32_32x32x16_bf16 v[144:159], a[28:31], v[76:79], v[144:159]
  v_exp_f32 v44, v44
  v_exp_f32 v45, v45
  v_cvt_pk_bf16_f32 v69, v42, v43
  v_exp_f32 v46, v46
  v_exp_f32 v47, v47
  v_cvt_pk_bf16_f32 v70, v44, v45
  v_cvt_pk_bf16_f32 v71, v46, v47
  v_mfma_f32_32x32x16_bf16 v[32:47], a[32:35], v[176:179], 0
  v_exp_f32 v48, v48
  v_exp_f32 v49, v49
  v_exp_f32 v50, v50
  v_exp_f32 v51, v51
  v_cvt_pk_bf16_f32 v72, v48, v49
  v_mfma_f32_32x32x16_bf16 v[32:47], a[36:39], v[180:183], v[32:47]
  s_add_u32 s65, s80, 36864
  buffer_load_dwordx4 a[16:19], v1, s[40:43], s65 offen offset:0 sc1
  buffer_load_dwordx4 a[20:23], v1, s[40:43], s65 offen offset:1024 sc1
  buffer_load_dwordx4 a[24:27], v1, s[40:43], s65 offen offset:2048 sc1
  buffer_load_dwordx4 a[28:31], v1, s[40:43], s65 offen offset:3072 sc1
  v_exp_f32 v52, v52
  v_exp_f32 v53, v53
  v_cvt_pk_bf16_f32 v73, v50, v51
  v_exp_f32 v54, v54
  v_exp_f32 v55, v55
  v_cvt_pk_bf16_f32 v74, v52, v53
  v_mfma_f32_32x32x16_bf16 v[96:111], a[40:43], v[64:67], v[96:111]
  v_exp_f32 v56, v56
  v_exp_f32 v57, v57
  v_cvt_pk_bf16_f32 v75, v54, v55
  v_exp_f32 v58, v58
  v_exp_f32 v59, v59
  v_cvt_pk_bf16_f32 v76, v56, v57
  v_mfma_f32_32x32x16_bf16 v[96:111], a[44:47], v[68:71], v[96:111]
  v_exp_f32 v60, v60
  v_exp_f32 v61, v61
  v_cvt_pk_bf16_f32 v77, v58, v59
  v_exp_f32 v62, v62
  v_exp_f32 v63, v63
  v_cvt_pk_bf16_f32 v78, v60, v61
  v_cvt_pk_bf16_f32 v79, v62, v63
  v_mfma_f32_32x32x16_bf16 v[48:63], a[32:35], v[184:187], 0
  v_exp_f32 v32, v32
  v_exp_f32 v33, v33
  v_exp_f32 v34, v34
  v_exp_f32 v35, v35
  v_cvt_pk_bf16_f32 v64, v32, v33
  v_mfma_f32_32x32x16_bf16 v[48:63], a[36:39], v[188:191], v[48:63]
  v_exp_f32 v36, v36
  v_exp_f32 v37, v37
  v_cvt_pk_bf16_f32 v65, v34, v35
  v_exp_f32 v38, v38
  v_exp_f32 v39, v39
  v_cvt_pk_bf16_f32 v66, v36, v37
  v_mfma_f32_32x32x16_bf16 v[112:127], a[40:43], v[72:75], v[112:127]
  v_exp_f32 v40, v40
  v_exp_f32 v41, v41
  v_cvt_pk_bf16_f32 v67, v38, v39
  v_exp_f32 v42, v42
  v_exp_f32 v43, v43
  v_cvt_pk_bf16_f32 v68, v40, v41
  v_mfma_f32_32x32x16_bf16 v[112:127], a[44:47], v[76:79], v[112:127]
  v_exp_f32 v44, v44
  v_exp_f32 v45, v45
  v_cvt_pk_bf16_f32 v69, v42, v43
  v_exp_f32 v46, v46
  v_exp_f32 v47, v47
  v_cvt_pk_bf16_f32 v70, v44, v45
  v_cvt_pk_bf16_f32 v71, v46, v47
  s_waitcnt vmcnt(8)
  v_mfma_f32_32x32x16_bf16 v[32:47], a[48:51], v[160:163], 0
  v_lshrrev_b32 v80, 3, v0
  v_lshlrev_b32 v80, 7, v80
  v_and_b32 v81, 7, v0
  v_lshl_add_u32 v80, v81, 3, v80
  s_mov_b32 s89, 4096
  buffer_load_dwordx2 v[82:83], v80, s[40:43], s89 offen sc1
  v_exp_f32 v48, v48
  v_exp_f32 v49, v49
  v_exp_f32 v50, v50
  v_exp_f32 v51, v51
  v_cvt_pk_bf16_f32 v72, v48, v49
  v_mfma_f32_32x32x16_bf16 v[32:47], a[52:55], v[164:167], v[32:47]
  v_exp_f32 v52, v52
  v_exp_f32 v53, v53
  v_cvt_pk_bf16_f32 v73, v50, v51
  v_exp_f32 v54, v54
  v_exp_f32 v55, v55
  v_cvt_pk_bf16_f32 v74, v52, v53
  v_mfma_f32_32x32x16_bf16 v[128:143], a[40:43], v[64:67], v[128:143]
  v_exp_f32 v56, v56
  v_exp_f32 v57, v57
  v_cvt_pk_bf16_f32 v75, v54, v55
  v_exp_f32 v58, v58
  v_exp_f32 v59, v59
  v_cvt_pk_bf16_f32 v76, v56, v57
  v_mfma_f32_32x32x16_bf16 v[128:143], a[44:47], v[68:71], v[128:143]
  v_exp_f32 v60, v60
  v_exp_f32 v61, v61
  v_cvt_pk_bf16_f32 v77, v58, v59
  v_exp_f32 v62, v62
  v_exp_f32 v63, v63
  v_cvt_pk_bf16_f32 v78, v60, v61
  v_cvt_pk_bf16_f32 v79, v62, v63
  v_mfma_f32_32x32x16_bf16 v[48:63], a[48:51], v[168:171], 0
  v_exp_f32 v32, v32
  v_exp_f32 v33, v33
  v_exp_f32 v34, v34
  v_exp_f32 v35, v35
  v_cvt_pk_bf16_f32 v64, v32, v33
  v_mfma_f32_32x32x16_bf16 v[48:63], a[52:55], v[172:175], v[48:63]
  v_exp_f32 v36, v36
  v_exp_f32 v37, v37
  v_cvt_pk_bf16_f32 v65, v34, v35
  v_exp_f32 v38, v38
  v_exp_f32 v39, v39
  v_cvt_pk_bf16_f32 v66, v36, v37
  v_mfma_f32_32x32x16_bf16 v[144:159], a[40:43], v[72:75], v[144:159]
  v_exp_f32 v40, v40
  v_exp_f32 v41, v41
  v_cvt_pk_bf16_f32 v67, v38, v39
  v_exp_f32 v42, v42
  v_exp_f32 v43, v43
  v_cvt_pk_bf16_f32 v68, v40, v41
  v_mfma_f32_32x32x16_bf16 v[144:159], a[44:47], v[76:79], v[144:159]
  v_exp_f32 v44, v44
  v_exp_f32 v45, v45
  v_cvt_pk_bf16_f32 v69, v42, v43
  v_exp_f32 v46, v46
  v_exp_f32 v47, v47
  v_cvt_pk_bf16_f32 v70, v44, v45
  v_cvt_pk_bf16_f32 v71, v46, v47
  v_mfma_f32_32x32x16_bf16 v[32:47], a[48:51], v[176:179], 0
  v_exp_f32 v48, v48
  v_exp_f32 v49, v49
  v_exp_f32 v50, v50
  v_exp_f32 v51, v51
  v_cvt_pk_bf16_f32 v72, v48, v49
  v_mfma_f32_32x32x16_bf16 v[32:47], a[52:55], v[180:183], v[32:47]
  s_add_u32 s65, s80, 40960
  buffer_load_dwordx4 a[32:35], v1, s[40:43], s65 offen offset:0 sc1
  buffer_load_dwordx4 a[36:39], v1, s[40:43], s65 offen offset:1024 sc1
  buffer_load_dwordx4 a[40:43], v1, s[40:43], s65 offen offset:2048 sc1
  buffer_load_dwordx4 a[44:47], v1, s[40:43], s65 offen offset:3072 sc1
  v_exp_f32 v52, v52
  v_exp_f32 v53, v53
  v_cvt_pk_bf16_f32 v73, v50, v51
  v_exp_f32 v54, v54
  v_exp_f32 v55, v55
  v_cvt_pk_bf16_f32 v74, v52, v53
  v_mfma_f32_32x32x16_bf16 v[96:111], a[56:59], v[64:67], v[96:111]
  v_exp_f32 v56, v56
  v_exp_f32 v57, v57
  v_cvt_pk_bf16_f32 v75, v54, v55
  v_exp_f32 v58, v58
  v_exp_f32 v59, v59
  v_cvt_pk_bf16_f32 v76, v56, v57
  v_mfma_f32_32x32x16_bf16 v[96:111], a[60:63], v[68:71], v[96:111]
  v_exp_f32 v60, v60
  v_exp_f32 v61, v61
  v_cvt_pk_bf16_f32 v77, v58, v59
  v_exp_f32 v62, v62
  v_exp_f32 v63, v63
  v_cvt_pk_bf16_f32 v78, v60, v61
  v_cvt_pk_bf16_f32 v79, v62, v63
  v_mfma_f32_32x32x16_bf16 v[48:63], a[48:51], v[184:187], 0
  v_exp_f32 v32, v32
  v_exp_f32 v33, v33
  v_exp_f32 v34, v34
  v_exp_f32 v35, v35
  v_cvt_pk_bf16_f32 v64, v32, v33
  v_mfma_f32_32x32x16_bf16 v[48:63], a[52:55], v[188:191], v[48:63]
  v_exp_f32 v36, v36
  v_exp_f32 v37, v37
  v_cvt_pk_bf16_f32 v65, v34, v35
  v_exp_f32 v38, v38
  v_exp_f32 v39, v39
  v_cvt_pk_bf16_f32 v66, v36, v37
  v_mfma_f32_32x32x16_bf16 v[112:127], a[56:59], v[72:75], v[112:127]
  v_exp_f32 v40, v40
  v_exp_f32 v41, v41
  v_cvt_pk_bf16_f32 v67, v38, v39
  v_exp_f32 v42, v42
  v_exp_f32 v43, v43
  v_cvt_pk_bf16_f32 v68, v40, v41
  v_mfma_f32_32x32x16_bf16 v[112:127], a[60:63], v[76:79], v[112:127]
  v_exp_f32 v44, v44
  v_exp_f32 v45, v45
  v_cvt_pk_bf16_f32 v69, v42, v43
  v_exp_f32 v46, v46
  v_exp_f32 v47, v47
  v_cvt_pk_bf16_f32 v70, v44, v45
  v_cvt_pk_bf16_f32 v71, v46, v47
  s_waitcnt vmcnt(9)
  v_mfma_f32_32x32x16_bf16 v[32:47], a[0:3], v[160:163], 0
  v_exp_f32 v48, v48
  v_exp_f32 v49, v49
  v_exp_f32 v50, v50
  v_exp_f32 v51, v51
  v_cvt_pk_bf16_f32 v72, v48, v49
  v_mfma_f32_32x32x16_bf16 v[32:47], a[4:7], v[164:167], v[32:47]
  v_exp_f32 v52, v52
  v_exp_f32 v53, v53
  v_cvt_pk_bf16_f32 v73, v50, v51
  v_exp_f32 v54, v54
  v_exp_f32 v55, v55
  v_cvt_pk_bf16_f32 v74, v52, v53
  v_mfma_f32_32x32x16_bf16 v[128:143], a[56:59], v[64:67], v[128:143]
  v_exp_f32 v56, v56
  v_exp_f32 v57, v57
  v_cvt_pk_bf16_f32 v75, v54, v55
  v_exp_f32 v58, v58
  v_exp_f32 v59, v59
  v_cvt_pk_bf16_f32 v76, v56, v57
  v_mfma_f32_32x32x16_bf16 v[128:143], a[60:63], v[68:71], v[128:143]
  v_exp_f32 v60, v60
  v_exp_f32 v61, v61
  v_cvt_pk_bf16_f32 v77, v58, v59
  v_exp_f32 v62, v62
  v_exp_f32 v63, v63
  v_cvt_pk_bf16_f32 v78, v60, v61
  v_cvt_pk_bf16_f32 v79, v62, v63
  v_mfma_f32_32x32x16_bf16 v[48:63], a[0:3], v[168:171], 0
  v_exp_f32 v32, v32
  v_exp_f32 v33, v33
  v_exp_f32 v34, v34
  v_exp_f32 v35, v35
  v_cvt_pk_bf16_f32 v64, v32, v33
  v_mfma_f32_32x32x16_bf16 v[48:63], a[4:7], v[172:175], v[48:63]
  v_exp_f32 v36, v36
  v_exp_f32 v37, v37
  v_cvt_pk_bf16_f32 v65, v34, v35
  v_exp_f32 v38, v38
  v_exp_f32 v39, v39
  v_cvt_pk_bf16_f32 v66, v36, v37
  v_mfma_f32_32x32x16_bf16 v[144:159], a[56:59], v[72:75], v[144:159]
  v_exp_f32 v40, v40
  v_exp_f32 v41, v41
  v_cvt_pk_bf16_f32 v67, v38, v39
  v_exp_f32 v42, v42
  v_exp_f32 v43, v43
  v_cvt_pk_bf16_f32 v68, v40, v41
  v_mfma_f32_32x32x16_bf16 v[144:159], a[60:63], v[76:79], v[144:159]
  v_exp_f32 v44, v44
  v_exp_f32 v45, v45
  v_cvt_pk_bf16_f32 v69, v42, v43
  v_exp_f32 v46, v46
  v_exp_f32 v47, v47
  v_cvt_pk_bf16_f32 v70, v44, v45
  v_cvt_pk_bf16_f32 v71, v46, v47
  v_mfma_f32_32x32x16_bf16 v[32:47], a[0:3], v[176:179], 0
  s_waitcnt vmcnt(4)
  v_xor_b32 v82, s56, v82
  v_xor_b32 v83, s56, v83
  v_or_b32 v82, v82, v83
  v_cmp_ne_u32 vcc, 0, v82
  s_nop 1
  s_cbranch_vccnz L_spin_f0_22
L_back_f0_21:
  s_bfe_u32 s87, s2, 0x20003
  s_lshl_b32 s87, s87, 2
  s_add_u32 s87, s87, s55
  s_lshl_b32 s87, s87, 15
  s_add_u32 s87, s87, 11534336
  v_exp_f32 v48, v48
  v_exp_f32 v49, v49
  v_exp_f32 v50, v50
  v_exp_f32 v51, v51
  v_cvt_pk_bf16_f32 v72, v48, v49
  v_mfma_f32_32x32x16_bf16 v[32:47], a[4:7], v[180:183], v[32:47]
  s_add_u32 s65, s80, 45056
  buffer_load_dwordx4 a[48:51], v1, s[40:43], s65 offen offset:0 sc1
  buffer_load_dwordx4 a[52:55], v1, s[40:43], s65 offen offset:1024 sc1
  buffer_load_dwordx4 a[56:59], v1, s[40:43], s65 offen offset:2048 sc1
  buffer_load_dwordx4 a[60:63], v1, s[40:43], s65 offen offset:3072 sc1
  v_exp_f32 v52, v52
  v_exp_f32 v53, v53
  v_cvt_pk_bf16_f32 v73, v50, v51
  v_exp_f32 v54, v54
  v_exp_f32 v55, v55
  v_cvt_pk_bf16_f32 v74, v52, v53
  v_mfma_f32_32x32x16_bf16 v[96:111], a[8:11], v[64:67], v[96:111]
  v_exp_f32 v56, v56
  v_exp_f32 v57, v57
  v_cvt_pk_bf16_f32 v75, v54, v55
  v_exp_f32 v58, v58
  v_exp_f32 v59, v59
  v_cvt_pk_bf16_f32 v76, v56, v57
  v_mfma_f32_32x32x16_bf16 v[96:111], a[12:15], v[68:71], v[96:111]
  v_exp_f32 v60, v60
  v_exp_f32 v61, v61
  v_cvt_pk_bf16_f32 v77, v58, v59
  v_exp_f32 v62, v62
  v_exp_f32 v63, v63
  v_cvt_pk_bf16_f32 v78, v60, v61
  v_cvt_pk_bf16_f32 v79, v62, v63
  v_mfma_f32_32x32x16_bf16 v[48:63], a[0:3], v[184:187], 0
  s_add_u32 s88, s87, 0
  buffer_load_dwordx4 a[128:131], v1, s[40:43], s88 offen offset:0 sc1
  buffer_load_dwordx4 a[132:135], v1, s[40:43], s88 offen offset:1024 sc1
  buffer_load_dwordx4 a[136:139], v1, s[40:43], s88 offen offset:2048 sc1
  buffer_load_dwordx4 a[140:143], v1, s[40:43], s88 offen offset:3072 sc1
  v_exp_f32 v32, v32
  v_exp_f32 v33, v33
  v_exp_f32 v34, v34
  v_exp_f32 v35, v35
  v_cvt_pk_bf16_f32 v64, v32, v33
  v_mfma_f32_32x32x16_bf16 v[48:63], a[4:7], v[188:191], v[48:63]
  v_exp_f32 v36, v36
  v_exp_f32 v37, v37
  v_cvt_pk_bf16_f32 v65, v34, v35
  v_exp_f32 v38, v38
  v_exp_f32 v39, v39
  v_cvt_pk_bf16_f32 v66, v36, v37
  v_mfma_f32_32x32x16_bf16 v[112:127], a[8:11], v[72:75], v[112:127]
  v_exp_f32 v40, v40
  v_exp_f32 v41, v41
  v_cvt_pk_bf16_f32 v67, v38, v39
  v_exp_f32 v42, v42
  v_exp_f32 v43, v43
  v_cvt_pk_bf16_f32 v68, v40, v41
  v_mfma_f32_32x32x16_bf16 v[112:127], a[12:15], v[76:79], v[112:127]
  v_exp_f32 v44, v44
  v_exp_f32 v45, v45
  v_cvt_pk_bf16_f32 v69, v42, v43
  v_exp_f32 v46, v46
  v_exp_f32 v47, v47
  v_cvt_pk_bf16_f32 v70, v44, v45
  v_cvt_pk_bf16_f32 v71, v46, v47
  v_mfma_f32_32x32x16_bf16 v[32:47], a[16:19], v[160:163], 0
  s_add_u32 s88, s87, 4096
  buffer_load_dwordx4 a[144:147], v1, s[40:43], s88 offen offset:0 sc1
  buffer_load_dwordx4 a[148:151], v1, s[40:43], s88 offen offset:1024 sc1
  buffer_load_dwordx4 a[152:155], v1, s[40:43], s88 offen offset:2048 sc1
  buffer_load_dwordx4 a[156:159], v1, s[40:43], s88 offen offset:3072 sc1
  v_exp_f32 v48, v48
  v_exp_f32 v49, v49
  v_exp_f32 v50, v50
  v_exp_f32 v51, v51
  v_cvt_pk_bf16_f32 v72, v48, v49
  v_mfma_f32_32x32x16_bf16 v[32:47], a[20:23], v[164:167], v[32:47]
  v_exp_f32 v52, v52
  v_exp_f32 v53, v53
  v_cvt_pk_bf16_f32 v73, v50, v51
  v_exp_f32 v54, v54
  v_exp_f32 v55, v55
  v_cvt_pk_bf16_f32 v74, v52, v53
  v_mfma_f32_32x32x16_bf16 v[128:143], a[8:11], v[64:67], v[128:143]
  v_exp_f32 v56, v56
  v_exp_f32 v57, v57
  v_cvt_pk_bf16_f32 v75, v54, v55
  v_exp_f32 v58, v58
  v_exp_f32 v59, v59
  v_cvt_pk_bf16_f32 v76, v56, v57
  v_mfma_f32_32x32x16_bf16 v[128:143], a[12:15], v[68:71], v[128:143]
  v_exp_f32 v60, v60
  v_exp_f32 v61, v61
  v_cvt_pk_bf16_f32 v77, v58, v59
  v_exp_f32 v62, v62
  v_exp_f32 v63, v63
  v_cvt_pk_bf16_f32 v78, v60, v61
  v_cvt_pk_bf16_f32 v79, v62, v63
  v_mfma_f32_32x32x16_bf16 v[48:63], a[16:19], v[168:171], 0
  s_lshl_b32 s91, s92, 7
  s_add_u32 s91, s91, 16384
  v_and_b32 v24, 15, v0
  v_lshlrev_b32 v24, 2, v24
  buffer_load_dword v25, v24, s[40:43], s91 offen sc1
  v_exp_f32 v32, v32
  v_exp_f32 v33, v33
  v_exp_f32 v34, v34
  v_exp_f32 v35, v35
  v_cvt_pk_bf16_f32 v64, v32, v33
  v_mfma_f32_32x32x16_bf16 v[48:63], a[20:23], v[172:175], v[48:63]
  v_exp_f32 v36, v36
  v_exp_f32 v37, v37
  v_cvt_pk_bf16_f32 v65, v34, v35
  v_exp_f32 v38, v38
  v_exp_f32 v39, v39
  v_cvt_pk_bf16_f32 v66, v36, v37
  v_mfma_f32_32x32x16_bf16 v[144:159], a[8:11], v[72:75], v[144:159]
  v_exp_f32 v40, v40
  v_exp_f32 v41, v41
  v_cvt_pk_bf16_f32 v67, v38, v39
  v_exp_f32 v42, v42
  v_exp_f32 v43, v43
  v_cvt_pk_bf16_f32 v68, v40, v41
  v_mfma_f32_32x32x16_bf16 v[144:159], a[12:15], v[76:79], v[144:159]
  v_exp_f32 v44, v44
  v_exp_f32 v45, v45
  v_cvt_pk_bf16_f32 v69, v42, v43
  v_exp_f32 v46, v46
  v_exp_f32 v47, v47
  v_cvt_pk_bf16_f32 v70, v44, v45
  v_cvt_pk_bf16_f32 v71, v46, v47
  v_mfma_f32_32x32x16_bf16 v[32:47], a[16:19], v[176:179], 0
  v_exp_f32 v48, v48
  v_exp_f32 v49, v49
  v_exp_f32 v50, v50
  v_exp_f32 v51, v51
  v_cvt_pk_bf16_f32 v72, v48, v49
  v_mfma_f32_32x32x16_bf16 v[32:47], a[20:23], v[180:183], v[32:47]
  s_add_u32 s65, s80, 49152
  buffer_load_dwordx4 a[0:3], v1, s[40:43], s65 offen offset:0 sc1
  buffer_load_dwordx4 a[4:7], v1, s[40:43], s65 offen offset:1024 sc1
  buffer_load_dwordx4 a[8:11], v1, s[40:43], s65 offen offset:2048 sc1
  buffer_load_dwordx4 a[12:15], v1, s[40:43], s65 offen offset:3072 sc1
  v_exp_f32 v52, v52
  v_exp_f32 v53, v53
  v_cvt_pk_bf16_f32 v73, v50, v51
  v_exp_f32 v54, v54
  v_exp_f32 v55, v55
  v_cvt_pk_bf16_f32 v74, v52, v53
  v_mfma_f32_32x32x16_bf16 v[96:111], a[24:27], v[64:67], v[96:111]
  v_exp_f32 v56, v56
  v_exp_f32 v57, v57
  v_cvt_pk_bf16_f32 v75, v54, v55
  v_exp_f32 v58, v58
  v_exp_f32 v59, v59
  v_cvt_pk_bf16_f32 v76, v56, v57
  v_mfma_f32_32x32x16_bf16 v[96:111], a[28:31], v[68:71], v[96:111]
  v_exp_f32 v60, v60
  v_exp_f32 v61, v61
  v_cvt_pk_bf16_f32 v77, v58, v59
  v_exp_f32 v62, v62
  v_exp_f32 v63, v63
  v_cvt_pk_bf16_f32 v78, v60, v61
  v_cvt_pk_bf16_f32 v79, v62, v63
  v_mfma_f32_32x32x16_bf16 v[48:63], a[16:19], v[184:187], 0
  s_add_u32 s88, s87, 8192
  buffer_load_dwordx4 a[160:163], v1, s[40:43], s88 offen offset:0 sc1
  buffer_load_dwordx4 a[164:167], v1, s[40:43], s88 offen offset:1024 sc1
  buffer_load_dwordx4 a[168:171], v1, s[40:43], s88 offen offset:2048 sc1
  buffer_load_dwordx4 a[172:175], v1, s[40:43], s88 offen offset:3072 sc1
  v_exp_f32 v32, v32
  v_exp_f32 v33, v33
  v_exp_f32 v34, v34
  v_exp_f32 v35, v35
  v_cvt_pk_bf16_f32 v64, v32, v33
  v_mfma_f32_32x32x16_bf16 v[48:63], a[20:23], v[188:191], v[48:63]
  v_exp_f32 v36, v36
  v_exp_f32 v37, v37
  v_cvt_pk_bf16_f32 v65, v34, v35
  v_exp_f32 v38, v38
  v_exp_f32 v39, v39
  v_cvt_pk_bf16_f32 v66, v36, v37
  v_mfma_f32_32x32x16_bf16 v[112:127], a[24:27], v[72:75], v[112:127]
  v_exp_f32 v40, v40
  v_exp_f32 v41, v41
  v_cvt_pk_bf16_f32 v67, v38, v39
  v_exp_f32 v42, v42
  v_exp_f32 v43, v43
  v_cvt_pk_bf16_f32 v68, v40, v41
  v_mfma_f32_32x32x16_bf16 v[112:127], a[28:31], v[76:79], v[112:127]
  v_exp_f32 v44, v44
  v_exp_f32 v45, v45
  v_cvt_pk_bf16_f32 v69, v42, v43
  v_exp_f32 v46, v46
  v_exp_f32 v47, v47
  v_cvt_pk_bf16_f32 v70, v44, v45
  v_cvt_pk_bf16_f32 v71, v46, v47
  s_waitcnt vmcnt(21)
  v_mfma_f32_32x32x16_bf16 v[32:47], a[32:35], v[160:163], 0
  s_add_u32 s88, s87, 12288
  buffer_load_dwordx4 a[176:179], v1, s[40:43], s88 offen offset:0 sc1
  buffer_load_dwordx4 a[180:183], v1, s[40:43], s88 offen offset:1024 sc1
  buffer_load_dwordx4 a[184:187], v1, s[40:43], s88 offen offset:2048 sc1
  buffer_load_dwordx4 a[188:191], v1, s[40:43], s88 offen offset:3072 sc1
  v_exp_f32 v48, v48
  v_exp_f32 v49, v49
  v_exp_f32 v50, v50
  v_exp_f32 v51, v51
  v_cvt_pk_bf16_f32 v72, v48, v49
  v_mfma_f32_32x32x16_bf16 v[32:47], a[36:39], v[164:167], v[32:47]
  v_exp_f32 v52, v52
  v_exp_f32 v53, v53
  v_cvt_pk_bf16_f32 v73, v50, v51
  v_exp_f32 v54, v54
  v_exp_f32 v55, v55
  v_cvt_pk_bf16_f32 v74, v52, v53
  v_mfma_f32_32x32x16_bf16 v[128:143], a[24:27], v[64:67], v[128:143]
  v_exp_f32 v56, v56
  v_exp_f32 v57, v57
  v_cvt_pk_bf16_f32 v75, v54, v55
  v_exp_f32 v58, v58
  v_exp_f32 v59, v59
  v_cvt_pk_bf16_f32 v76, v56, v57
  v_mfma_f32_32x32x16_bf16 v[128:143], a[28:31], v[68:71], v[128:143]
  v_exp_f32 v60, v60
  v_exp_f32 v61, v61
  v_cvt_pk_bf16_f32 v77, v58, v59
  v_exp_f32 v62, v62
  v_exp_f32 v63, v63
  v_cvt_pk_bf16_f32 v78, v60, v61
  v_cvt_pk_bf16_f32 v79, v62, v63
  v_mfma_f32_32x32x16_bf16 v[48:63], a[32:35], v[168:171], 0
  s_add_u32 s88, s87, 16384
  buffer_load_dwordx4 a[192:195], v1, s[40:43], s88 offen offset:0 sc1
  buffer_load_dwordx4 a[196:199], v1, s[40:43], s88 offen offset:1024 sc1
  buffer_load_dwordx4 a[200:203], v1, s[40:43], s88 offen offset:2048 sc1
  buffer_load_dwordx4 a[204:207], v1, s[40:43], s88 offen offset:3072 sc1
  v_exp_f32 v32, v32
  v_exp_f32 v33, v33
  v_exp_f32 v34, v34
  v_exp_f32 v35, v35
  v_cvt_pk_bf16_f32 v64, v32, v33
  v_mfma_f32_32x32x16_bf16 v[48:63], a[36:39], v[172:175], v[48:63]
  v_exp_f32 v36, v36
  v_exp_f32 v37, v37
  v_cvt_pk_bf16_f32 v65, v34, v35
  v_exp_f32 v38, v38
  v_exp_f32 v39, v39
  v_cvt_pk_bf16_f32 v66, v36, v37
  v_mfma_f32_32x32x16_bf16 v[144:159], a[24:27], v[72:75], v[144:159]
  v_exp_f32 v40, v40
  v_exp_f32 v41, v41
  v_cvt_pk_bf16_f32 v67, v38, v39
  v_exp_f32 v42, v42
  v_exp_f32 v43, v43
  v_cvt_pk_bf16_f32 v68, v40, v41
  v_mfma_f32_32x32x16_bf16 v[144:159], a[28:31], v[76:79], v[144:159]
  v_exp_f32 v44, v44
  v_exp_f32 v45, v45
  v_cvt_pk_bf16_f32 v69, v42, v43
  v_exp_f32 v46, v46
  v_exp_f32 v47, v47
  v_cvt_pk_bf16_f32 v70, v44, v45
  v_cvt_pk_bf16_f32 v71, v46, v47
  v_mfma_f32_32x32x16_bf16 v[32:47], a[32:35], v[176:179], 0
  v_exp_f32 v48, v48
  v_exp_f32 v49, v49
  v_exp_f32 v50, v50
  v_exp_f32 v51, v51
  v_cvt_pk_bf16_f32 v72, v48, v49
  v_mfma_f32_32x32x16_bf16 v[32:47], a[36:39], v[180:183], v[32:47]
  s_add_u32 s65, s80, 53248
  buffer_load_dwordx4 a[16:19], v1, s[40:43], s65 offen offset:0 sc1
  buffer_load_dwordx4 a[20:23], v1, s[40:43], s65 offen offset:1024 sc1
  buffer_load_dwordx4 a[24:27], v1, s[40:43], s65 offen offset:2048 sc1
  buffer_load_dwordx4 a[28:31], v1, s[40:43], s65 offen offset:3072 sc1
  v_exp_f32 v52, v52
  v_exp_f32 v53, v53
  v_cvt_pk_bf16_f32 v73, v50, v51
  v_exp_f32 v54, v54
  v_exp_f32 v55, v55
  v_cvt_pk_bf16_f32 v74, v52, v53
  v_mfma_f32_32x32x16_bf16 v[96:111], a[40:43], v[64:67], v[96:111]
  v_exp_f32 v56, v56
  v_exp_f32 v57, v57
  v_cvt_pk_bf16_f32 v75, v54, v55
  v_exp_f32 v58, v58
  v_exp_f32 v59, v59
  v_cvt_pk_bf16_f32 v76, v56, v57
  v_mfma_f32_32x32x16_bf16 v[96:111], a[44:47], v[68:71], v[96:111]
  v_exp_f32 v60, v60
  v_exp_f32 v61, v61
  v_cvt_pk_bf16_f32 v77, v58, v59
  v_exp_f32 v62, v62
  v_exp_f32 v63, v63
  v_cvt_pk_bf16_f32 v78, v60, v61
  v_cvt_pk_bf16_f32 v79, v62, v63
  v_mfma_f32_32x32x16_bf16 v[48:63], a[32:35], v[184:187], 0
  s_waitcnt vmcnt(20)
  v_cmp_ne_u32 vcc, s56, v25
  s_nop 1
  s_cbranch_vccnz L_spin_f3_24
L_back_f3_23:
  s_lshl_b32 s72, s92, 12
  s_add_u32 s72, s72, 65536
  buffer_load_dwordx4 v[192:195], v1, s[40:43], s72 offen offset:0 sc1
  buffer_load_dwordx4 v[196:199], v1, s[40:43], s72 offen offset:1024 sc1
  buffer_load_dwordx4 v[200:203], v1, s[40:43], s72 offen offset:2048 sc1
  buffer_load_dwordx4 v[204:207], v1, s[40:43], s72 offen offset:3072 sc1
  v_exp_f32 v32, v32
  v_exp_f32 v33, v33
  v_exp_f32 v34, v34
  v_exp_f32 v35, v35
  v_cvt_pk_bf16_f32 v64, v32, v33
  v_mfma_f32_32x32x16_bf16 v[48:63], a[36:39], v[188:191], v[48:63]
  v_exp_f32 v36, v36
  v_exp_f32 v37, v37
  v_cvt_pk_bf16_f32 v65, v34, v35
  v_exp_f32 v38, v38
  v_exp_f32 v39, v39
  v_cvt_pk_bf16_f32 v66, v36, v37
  v_mfma_f32_32x32x16_bf16 v[112:127], a[40:43], v[72:75], v[112:127]
  v_exp_f32 v40, v40
  v_exp_f32 v41, v41
  v_cvt_pk_bf16_f32 v67, v38, v39
  v_exp_f32 v42, v42
  v_exp_f32 v43, v43
  v_cvt_pk_bf16_f32 v68, v40, v41
  v_mfma_f32_32x32x16_bf16 v[112:127], a[44:47], v[76:79], v[112:127]
  v_exp_f32 v44, v44
  v_exp_f32 v45, v45
  v_cvt_pk_bf16_f32 v69, v42, v43
  v_exp_f32 v46, v46
  v_exp_f32 v47, v47
  v_cvt_pk_bf16_f32 v70, v44, v45
  v_cvt_pk_bf16_f32 v71, v46, v47
  v_mfma_f32_32x32x16_bf16 v[32:47], a[48:51], v[160:163], 0
  s_add_u32 s88, s87, 20480
  buffer_load_dwordx4 a[208:211], v1, s[40:43], s88 offen offset:0 sc1
  buffer_load_dwordx4 a[212:215], v1, s[40:43], s88 offen offset:1024 sc1
  buffer_load_dwordx4 a[216:219], v1, s[40:43], s88 offen offset:2048 sc1
  buffer_load_dwordx4 a[220:223], v1, s[40:43], s88 offen offset:3072 sc1
  v_exp_f32 v48, v48
  v_exp_f32 v49, v49
  v_exp_f32 v50, v50
  v_exp_f32 v51, v51
  v_cvt_pk_bf16_f32 v72, v48, v49
  v_mfma_f32_32x32x16_bf16 v[32:47], a[52:55], v[164:167], v[32:47]
  v_exp_f32 v52, v52
  v_exp_f32 v53, v53
  v_cvt_pk_bf16_f32 v73, v50, v51
  v_exp_f32 v54, v54
  v_exp_f32 v55, v55
  v_cvt_pk_bf16_f32 v74, v52, v53
  v_mfma_f32_32x32x16_bf16 v[128:143], a[40:43], v[64:67], v[128:143]
  v_exp_f32 v56, v56
  v_exp_f32 v57, v57
  v_cvt_pk_bf16_f32 v75, v54, v55
  v_exp_f32 v58, v58
  v_exp_f32 v59, v59
  v_cvt_pk_bf16_f32 v76, v56, v57
  v_mfma_f32_32x32x16_bf16 v[128:143], a[44:47], v[68:71], v[128:143]
  v_exp_f32 v60, v60
  v_exp_f32 v61, v61
  v_cvt_pk_bf16_f32 v77, v58, v59
  v_exp_f32 v62, v62
  v_exp_f32 v63, v63
  v_cvt_pk_bf16_f32 v78, v60, v61
  v_cvt_pk_bf16_f32 v79, v62, v63
  v_mfma_f32_32x32x16_bf16 v[48:63], a[48:51], v[168:171], 0
  s_add_u32 s88, s87, 24576
  buffer_load_dwordx4 a[224:227], v1, s[40:43], s88 offen offset:0 sc1
  buffer_load_dwordx4 a[228:231], v1, s[40:43], s88 offen offset:1024 sc1
  buffer_load_dwordx4 a[232:235], v1, s[40:43], s88 offen offset:2048 sc1
  buffer_load_dwordx4 a[236:239], v1, s[40:43], s88 offen offset:3072 sc1
  v_exp_f32 v32, v32
  v_exp_f32 v33, v33
  v_exp_f32 v34, v34
  v_exp_f32 v35, v35
  v_cvt_pk_bf16_f32 v64, v32, v33
  v_mfma_f32_32x32x16_bf16 v[48:63], a[52:55], v[172:175], v[48:63]
  v_exp_f32 v36, v36
  v_exp_f32 v37, v37
  v_cvt_pk_bf16_f32 v65, v34, v35
  v_exp_f32 v38, v38
  v_exp_f32 v39, v39
  v_cvt_pk_bf16_f32 v66, v36, v37
  v_mfma_f32_32x32x16_bf16 v[144:159], a[40:43], v[72:75], v[144:159]
  v_exp_f32 v40, v40
  v_exp_f32 v41, v41
  v_cvt_pk_bf16_f32 v67, v38, v39
  v_exp_f32 v42, v42
  v_exp_f32 v43, v43
  v_cvt_pk_bf16_f32 v68, v40, v41
  v_mfma_f32_32x32x16_bf16 v[144:159], a[44:47], v[76:79], v[144:159]
  v_exp_f32 v44, v44
  v_exp_f32 v45, v45
  v_cvt_pk_bf16_f32 v69, v42, v43
  v_exp_f32 v46, v46
  v_exp_f32 v47, v47
  v_cvt_pk_bf16_f32 v70, v44, v45
  v_cvt_pk_bf16_f32 v71, v46, v47
  v_mfma_f32_32x32x16_bf16 v[32:47], a[48:51], v[176:179], 0
  v_exp_f32 v48, v48
  v_exp_f32 v49, v49
  v_exp_f32 v50, v50
  v_exp_f32 v51, v51
  v_cvt_pk_bf16_f32 v72, v48, v49
  v_mfma_f32_32x32x16_bf16 v[32:47], a[52:55], v[180:183], v[32:47]
  s_add_u32 s65, s80, 57344
  buffer_load_dwordx4 a[32:35], v1, s[40:43], s65 offen offset:0 sc1
  buffer_load_dwordx4 a[36:39], v1, s[40:43], s65 offen offset:1024 sc1
  buffer_load_dwordx4 a[40:43], v1, s[40:43], s65 offen offset:2048 sc1
  buffer_load_dwordx4 a[44:47], v1, s[40:43], s65 offen offset:3072 sc1
  v_exp_f32 v52, v52
  v_exp_f32 v53, v53
  v_cvt_pk_bf16_f32 v73, v50, v51
  v_exp_f32 v54, v54
  v_exp_f32 v55, v55
  v_cvt_pk_bf16_f32 v74, v52, v53
  v_mfma_f32_32x32x16_bf16 v[96:111], a[56:59], v[64:67], v[96:111]
  v_exp_f32 v56, v56
  v_exp_f32 v57, v57
  v_cvt_pk_bf16_f32 v75, v54, v55
  v_exp_f32 v58, v58
  v_exp_f32 v59, v59
  v_cvt_pk_bf16_f32 v76, v56, v57
  v_mfma_f32_32x32x16_bf16 v[96:111], a[60:63], v[68:71], v[96:111]
  v_exp_f32 v60, v60
  v_exp_f32 v61, v61
  v_cvt_pk_bf16_f32 v77, v58, v59
  v_exp_f32 v62, v62
  v_exp_f32 v63, v63
  v_cvt_pk_bf16_f32 v78, v60, v61
  v_cvt_pk_bf16_f32 v79, v62, v63
  v_mfma_f32_32x32x16_bf16 v[48:63], a[48:51], v[184:187], 0
  v_exp_f32 v32, v32
  v_exp_f32 v33, v33
  v_exp_f32 v34, v34
  v_exp_f32 v35, v35
  v_cvt_pk_bf16_f32 v64, v32, v33
  s_waitcnt vmcnt(12)
  v_mfma_f32_32x32x16_bf16 v[208:223], v[192:195], v[224:227], 0
  v_mfma_f32_32x32x16_bf16 v[48:63], a[52:55], v[188:191], v[48:63]
  v_exp_f32 v36, v36
  v_exp_f32 v37, v37
  v_cvt_pk_bf16_f32 v65, v34, v35
  v_exp_f32 v38, v38
  v_exp_f32 v39, v39
  v_cvt_pk_bf16_f32 v66, v36, v37
  v_mfma_f32_32x32x16_bf16 v[208:223], v[196:199], v[228:231], v[208:223]
  v_mfma_f32_32x32x16_bf16 v[112:127], a[56:59], v[72:75], v[112:127]
  v_exp_f32 v40, v40
  v_exp_f32 v41, v41
  v_cvt_pk_bf16_f32 v67, v38, v39
  v_exp_f32 v42, v42
  v_exp_f32 v43, v43
  v_cvt_pk_bf16_f32 v68, v40, v41
  v_mfma_f32_32x32x16_bf16 v[208:223], v[200:203], v[232:235], v[208:223]
  v_mfma_f32_32x32x16_bf16 v[112:127], a[60:63], v[76:79], v[112:127]
  v_exp_f32 v44, v44
  v_exp_f32 v45, v45
  v_cvt_pk_bf16_f32 v69, v42, v43
  v_exp_f32 v46, v46
  v_exp_f32 v47, v47
  v_cvt_pk_bf16_f32 v70, v44, v45
  v_cvt_pk_bf16_f32 v71, v46, v47
  v_mfma_f32_32x32x16_bf16 v[208:223], v[204:207], v[236:239], v[208:223]
  v_mfma_f32_32x32x16_bf16 v[32:47], a[0:3], v[160:163], 0
  v_exp_f32 v48, v48
  v_exp_f32 v49, v49
  v_exp_f32 v50, v50
  v_exp_f32 v51, v51
  v_cvt_pk_bf16_f32 v72, v48, v49
  s_lshl_b32 s72, s54, 2
  s_lshl_b32 s73, s59, 1
  s_add_u32 s72, s72, s73
  s_lshl_b32 s72, s72, 4
  s_add_u32 s72, s72, s92
  s_lshl_b32 s72, s72, 11
  s_add_u32 s75, s72, 7340032
  v_mov_b32 v16, v220
  v_mov_b32 v17, v220
  s_nop 1
  v_permlane32_swap_b32 v16, v17
  v_add_f32 v17, 0x358637bd, v17
  v_rcp_f32 v18, v17
  s_nop 0
  v_mul_f32 v208, v18, v208
  v_mul_f32 v209, v18, v209
  v_mul_f32 v210, v18, v210
  v_mul_f32 v211, v18, v211
  v_mul_f32 v212, v18, v212
  v_mul_f32 v213, v18, v213
  v_mul_f32 v214, v18, v214
  v_mul_f32 v215, v18, v215
  v_mul_f32 v216, v18, v216
  v_mul_f32 v217, v18, v217
  v_mul_f32 v218, v18, v218
  v_mul_f32 v219, v18, v219
  v_mul_f32 v220, v18, v220
  v_mul_f32 v221, v18, v221
  v_mul_f32 v222, v18, v222
  v_mul_f32 v223, v18, v223
  v_cvt_pk_bf16_f32 v208, v208, v209
  v_cvt_pk_bf16_f32 v209, v210, v211
  v_cvt_pk_bf16_f32 v210, v212, v213
  v_cvt_pk_bf16_f32 v211, v214, v215
  v_cvt_pk_bf16_f32 v212, v216, v217
  v_cvt_pk_bf16_f32 v213, v218, v219
  v_cvt_pk_bf16_f32 v214, v220, v221
  v_cvt_pk_bf16_f32 v215, v222, v223
  s_mov_b32 exec_lo, 0
  v_mov_b32 v214, 0
  v_mov_b32 v215, 0
  s_mov_b32 exec_lo, -1
  buffer_store_dwordx4 v[208:211], v1, s[40:43], s75 offen sc1
  buffer_store_dwordx4 v[212:215], v1, s[40:43], s75 offen offset:1024 sc1
  v_mfma_f32_32x32x16_bf16 v[32:47], a[4:7], v[164:167], v[32:47]
  v_exp_f32 v52, v52
  v_exp_f32 v53, v53
  v_cvt_pk_bf16_f32 v73, v50, v51
  v_exp_f32 v54, v54
  v_exp_f32 v55, v55
  v_cvt_pk_bf16_f32 v74, v52, v53
  v_mfma_f32_32x32x16_bf16 v[128:143], a[56:59], v[64:67], v[128:143]
  v_exp_f32 v56, v56
  v_exp_f32 v57, v57
  v_cvt_pk_bf16_f32 v75, v54, v55
  v_exp_f32 v58, v58
  v_exp_f32 v59, v59
  v_cvt_pk_bf16_f32 v76, v56, v57
  v_mfma_f32_32x32x16_bf16 v[128:143], a[60:63], v[68:71], v[128:143]
  v_exp_f32 v60, v60
  v_exp_f32 v61, v61
  v_cvt_pk_bf16_f32 v77, v58, v59
  v_exp_f32 v62, v62
  v_exp_f32 v63, v63
  v_cvt_pk_bf16_f32 v78, v60, v61
  v_cvt_pk_bf16_f32 v79, v62, v63
  v_mfma_f32_32x32x16_bf16 v[48:63], a[0:3], v[168:171], 0
  v_exp_f32 v32, v32
  v_exp_f32 v33, v33
  v_exp_f32 v34, v34
  v_exp_f32 v35, v35
  v_cvt_pk_bf16_f32 v64, v32, v33
  v_mfma_f32_32x32x16_bf16 v[208:223], v[192:195], v[240:243], 0
  v_mfma_f32_32x32x16_bf16 v[48:63], a[4:7], v[172:175], v[48:63]
  v_exp_f32 v36, v36
  v_exp_f32 v37, v37
  v_cvt_pk_bf16_f32 v65, v34, v35
  v_exp_f32 v38, v38
  v_exp_f32 v39, v39
  v_cvt_pk_bf16_f32 v66, v36, v37
  v_mfma_f32_32x32x16_bf16 v[208:223], v[196:199], v[244:247], v[208:223]
  v_mfma_f32_32x32x16_bf16 v[144:159], a[56:59], v[72:75], v[144:159]
  v_exp_f32 v40, v40
  v_exp_f32 v41, v41
  v_cvt_pk_bf16_f32 v67, v38, v39
  v_exp_f32 v42, v42
  v_exp_f32 v43, v43
  v_cvt_pk_bf16_f32 v68, v40, v41
  v_mfma_f32_32x32x16_bf16 v[208:223], v[200:203], v[248:251], v[208:223]
  v_mfma_f32_32x32x16_bf16 v[144:159], a[60:63], v[76:79], v[144:159]
  v_exp_f32 v44, v44
  v_exp_f32 v45, v45
  v_cvt_pk_bf16_f32 v69, v42, v43
  v_exp_f32 v46, v46
  v_exp_f32 v47, v47
  v_cvt_pk_bf16_f32 v70, v44, v45
  v_cvt_pk_bf16_f32 v71, v46, v47
  v_mfma_f32_32x32x16_bf16 v[208:223], v[204:207], v[252:255], v[208:223]
  v_mfma_f32_32x32x16_bf16 v[32:47], a[0:3], v[176:179], 0
  v_exp_f32 v48, v48
  v_exp_f32 v49, v49
  v_exp_f32 v50, v50
  v_exp_f32 v51, v51
  v_cvt_pk_bf16_f32 v72, v48, v49
  v_mfma_f32_32x32x16_bf16 v[32:47], a[4:7], v[180:183], v[32:47]
  s_add_u32 s65, s80, 61440
  buffer_load_dwordx4 a[48:51], v1, s[40:43], s65 offen offset:0 sc1
  buffer_load_dwordx4 a[52:55], v1, s[40:43], s65 offen offset:1024 sc1
  buffer_load_dwordx4 a[56:59], v1, s[40:43], s65 offen offset:2048 sc1
  buffer_load_dwordx4 a[60:63], v1, s[40:43], s65 offen offset:3072 sc1
  v_exp_f32 v52, v52
  v_exp_f32 v53, v53
  v_cvt_pk_bf16_f32 v73, v50, v51
  v_exp_f32 v54, v54
  v_exp_f32 v55, v55
  v_cvt_pk_bf16_f32 v74, v52, v53
  v_mfma_f32_32x32x16_bf16 v[96:111], a[8:11], v[64:67], v[96:111]
  v_exp_f32 v56, v56
  v_exp_f32 v57, v57
  v_cvt_pk_bf16_f32 v75, v54, v55
  v_exp_f32 v58, v58
  v_exp_f32 v59, v59
  v_cvt_pk_bf16_f32 v76, v56, v57
  v_mfma_f32_32x32x16_bf16 v[96:111], a[12:15], v[68:71], v[96:111]
  v_exp_f32 v60, v60
  v_exp_f32 v61, v61
  v_cvt_pk_bf16_f32 v77, v58, v59
  v_exp_f32 v62, v62
  v_exp_f32 v63, v63
  v_cvt_pk_bf16_f32 v78, v60, v61
  v_cvt_pk_bf16_f32 v79, v62, v63
  v_mfma_f32_32x32x16_bf16 v[48:63], a[0:3], v[184:187], 0
  s_lshl_b32 s72, s54, 2
  s_lshl_b32 s73, s59, 1
  s_add_u32 s72, s72, s73
  s_lshl_b32 s72, s72, 4
  s_add_u32 s72, s72, s92
  s_lshl_b32 s72, s72, 11
  s_add_u32 s75, s72, 7372800
  v_mov_b32 v16, v220
  v_mov_b32 v17, v220
  s_nop 1
  v_permlane32_swap_b32 v16, v17
  v_add_f32 v17, 0x358637bd, v17
  v_rcp_f32 v18, v17
  s_nop 0
  v_mul_f32 v208, v18, v208
  v_mul_f32 v209, v18, v209
  v_mul_f32 v210, v18, v210
  v_mul_f32 v211, v18, v211
  v_mul_f32 v212, v18, v212
  v_mul_f32 v213, v18, v213
  v_mul_f32 v214, v18, v214
  v_mul_f32 v215, v18, v215
  v_mul_f32 v216, v18, v216
  v_mul_f32 v217, v18, v217
  v_mul_f32 v218, v18, v218
  v_mul_f32 v219, v18, v219
  v_mul_f32 v220, v18, v220
  v_mul_f32 v221, v18, v221
  v_mul_f32 v222, v18, v222
  v_mul_f32 v223, v18, v223
  v_cvt_pk_bf16_f32 v208, v208, v209
  v_cvt_pk_bf16_f32 v209, v210, v211
  v_cvt_pk_bf16_f32 v210, v212, v213
  v_cvt_pk_bf16_f32 v211, v214, v215
  v_cvt_pk_bf16_f32 v212, v216, v217
  v_cvt_pk_bf16_f32 v213, v218, v219
  v_cvt_pk_bf16_f32 v214, v220, v221
  v_cvt_pk_bf16_f32 v215, v222, v223
  s_mov_b32 exec_lo, 0
  v_mov_b32 v214, 0
  v_mov_b32 v215, 0
  s_mov_b32 exec_lo, -1
  buffer_store_dwordx4 v[208:211], v1, s[40:43], s75 offen sc1
  buffer_store_dwordx4 v[212:215], v1, s[40:43], s75 offen offset:1024 sc1
  v_exp_f32 v32, v32
  v_exp_f32 v33, v33
  v_exp_f32 v34, v34
  v_exp_f32 v35, v35
  v_cvt_pk_bf16_f32 v64, v32, v33
  v_mfma_f32_32x32x16_bf16 v[48:63], a[4:7], v[188:191], v[48:63]
  v_exp_f32 v36, v36
  v_exp_f32 v37, v37
  v_cvt_pk_bf16_f32 v65, v34, v35
  v_exp_f32 v38, v38
  v_exp_f32 v39, v39
  v_cvt_pk_bf16_f32 v66, v36, v37
  v_mfma_f32_32x32x16_bf16 v[112:127], a[8:11], v[72:75], v[112:127]
  v_exp_f32 v40, v40
  v_exp_f32 v41, v41
  v_cvt_pk_bf16_f32 v67, v38, v39
  v_exp_f32 v42, v42
  v_exp_f32 v43, v43
  v_cvt_pk_bf16_f32 v68, v40, v41
  v_mfma_f32_32x32x16_bf16 v[112:127], a[12:15], v[76:79], v[112:127]
  v_exp_f32 v44, v44
  v_exp_f32 v45, v45
  v_cvt_pk_bf16_f32 v69, v42, v43
  v_exp_f32 v46, v46
  v_exp_f32 v47, v47
  v_cvt_pk_bf16_f32 v70, v44, v45
  v_cvt_pk_bf16_f32 v71, v46, v47
  v_mfma_f32_32x32x16_bf16 v[32:47], a[16:19], v[160:163], 0
  s_add_u32 s88, s87, 28672
  buffer_load_dwordx4 a[240:243], v1, s[40:43], s88 offen offset:0 sc1
  buffer_load_dwordx4 a[244:247], v1, s[40:43], s88 offen offset:1024 sc1
  buffer_load_dwordx4 a[248:251], v1, s[40:43], s88 offen offset:2048 sc1
  buffer_load_dwordx4 a[252:255], v1, s[40:43], s88 offen offset:3072 sc1
  v_exp_f32 v48, v48
  v_exp_f32 v49, v49
  v_exp_f32 v50, v50
  v_exp_f32 v51, v51
  v_cvt_pk_bf16_f32 v72, v48, v49
  v_mfma_f32_32x32x16_bf16 v[32:47], a[20:23], v[164:167], v[32:47]
  v_exp_f32 v52, v52
  v_exp_f32 v53, v53
  v_cvt_pk_bf16_f32 v73, v50, v51
  v_exp_f32 v54, v54
  v_exp_f32 v55, v55
  v_cvt_pk_bf16_f32 v74, v52, v53
  v_mfma_f32_32x32x16_bf16 v[128:143], a[8:11], v[64:67], v[128:143]
  v_exp_f32 v56, v56
  v_exp_f32 v57, v57
  v_cvt_pk_bf16_f32 v75, v54, v55
  v_exp_f32 v58, v58
  v_exp_f32 v59, v59
  v_cvt_pk_bf16_f32 v76, v56, v57
  v_mfma_f32_32x32x16_bf16 v[128:143], a[12:15], v[68:71], v[128:143]
  v_exp_f32 v60, v60
  v_exp_f32 v61, v61
  v_cvt_pk_bf16_f32 v77, v58, v59
  v_exp_f32 v62, v62
  v_exp_f32 v63, v63
  v_cvt_pk_bf16_f32 v78, v60, v61
  v_cvt_pk_bf16_f32 v79, v62, v63
  v_mfma_f32_32x32x16_bf16 v[48:63], a[16:19], v[168:171], 0
  s_add_u32 s88, s87, 524288
  buffer_load_dwordx4 a[64:67], v1, s[40:43], s88 offen offset:0 sc1
  buffer_load_dwordx4 a[68:71], v1, s[40:43], s88 offen offset:1024 sc1
  buffer_load_dwordx4 a[72:75], v1, s[40:43], s88 offen offset:2048 sc1
  buffer_load_dwordx4 a[76:79], v1, s[40:43], s88 offen offset:3072 sc1
  v_exp_f32 v32, v32
  v_exp_f32 v33, v33
  v_exp_f32 v34, v34
  v_exp_f32 v35, v35
  v_cvt_pk_bf16_f32 v64, v32, v33
  v_mfma_f32_32x32x16_bf16 v[48:63], a[20:23], v[172:175], v[48:63]
  v_exp_f32 v36, v36
  v_exp_f32 v37, v37
  v_cvt_pk_bf16_f32 v65, v34, v35
  v_exp_f32 v38, v38
  v_exp_f32 v39, v39
  v_cvt_pk_bf16_f32 v66, v36, v37
  v_mfma_f32_32x32x16_bf16 v[144:159], a[8:11], v[72:75], v[144:159]
  v_exp_f32 v40, v40
  v_exp_f32 v41, v41
  v_cvt_pk_bf16_f32 v67, v38, v39
  v_exp_f32 v42, v42
  v_exp_f32 v43, v43
  v_cvt_pk_bf16_f32 v68, v40, v41
  v_mfma_f32_32x32x16_bf16 v[144:159], a[12:15], v[76:79], v[144:159]
  v_exp_f32 v44, v44
  v_exp_f32 v45, v45
  v_cvt_pk_bf16_f32 v69, v42, v43
  v_exp_f32 v46, v46
  v_exp_f32 v47, v47
  v_cvt_pk_bf16_f32 v70, v44, v45
  v_cvt_pk_bf16_f32 v71, v46, v47
  v_mfma_f32_32x32x16_bf16 v[32:47], a[16:19], v[176:179], 0
  v_exp_f32 v48, v48
  v_exp_f32 v49, v49
  v_exp_f32 v50, v50
  v_exp_f32 v51, v51
  v_cvt_pk_bf16_f32 v72, v48, v49
  v_mfma_f32_32x32x16_bf16 v[32:47], a[20:23], v[180:183], v[32:47]
  v_exp_f32 v52, v52
  v_exp_f32 v53, v53
  v_cvt_pk_bf16_f32 v73, v50, v51
  v_exp_f32 v54, v54
  v_exp_f32 v55, v55
  v_cvt_pk_bf16_f32 v74, v52, v53
  v_mfma_f32_32x32x16_bf16 v[96:111], a[24:27], v[64:67], v[96:111]
  v_exp_f32 v56, v56
  v_exp_f32 v57, v57
  v_cvt_pk_bf16_f32 v75, v54, v55
  v_exp_f32 v58, v58
  v_exp_f32 v59, v59
  v_cvt_pk_bf16_f32 v76, v56, v57
  v_mfma_f32_32x32x16_bf16 v[96:111], a[28:31], v[68:71], v[96:111]
  v_exp_f32 v60, v60
  v_exp_f32 v61, v61
  v_cvt_pk_bf16_f32 v77, v58, v59
  v_exp_f32 v62, v62
  v_exp_f32 v63, v63
  v_cvt_pk_bf16_f32 v78, v60, v61
  v_cvt_pk_bf16_f32 v79, v62, v63
  v_mfma_f32_32x32x16_bf16 v[48:63], a[16:19], v[184:187], 0
  s_add_u32 s88, s87, 540672
  buffer_load_dwordx4 a[0:3], v1, s[40:43], s88 offen offset:0 sc1
  buffer_load_dwordx4 a[4:7], v1, s[40:43], s88 offen offset:1024 sc1
  buffer_load_dwordx4 a[8:11], v1, s[40:43], s88 offen offset:2048 sc1
  buffer_load_dwordx4 a[12:15], v1, s[40:43], s88 offen offset:3072 sc1
  v_exp_f32 v32, v32
  v_exp_f32 v33, v33
  v_exp_f32 v34, v34
  v_exp_f32 v35, v35
  v_cvt_pk_bf16_f32 v64, v32, v33
  v_mfma_f32_32x32x16_bf16 v[48:63], a[20:23], v[188:191], v[48:63]
  v_exp_f32 v36, v36
  v_exp_f32 v37, v37
  v_cvt_pk_bf16_f32 v65, v34, v35
  v_exp_f32 v38, v38
  v_exp_f32 v39, v39
  v_cvt_pk_bf16_f32 v66, v36, v37
  v_mfma_f32_32x32x16_bf16 v[112:127], a[24:27], v[72:75], v[112:127]
  v_exp_f32 v40, v40
  v_exp_f32 v41, v41
  v_cvt_pk_bf16_f32 v67, v38, v39
  v_exp_f32 v42, v42
  v_exp_f32 v43, v43
  v_cvt_pk_bf16_f32 v68, v40, v41
  v_mfma_f32_32x32x16_bf16 v[112:127], a[28:31], v[76:79], v[112:127]
  v_exp_f32 v44, v44
  v_exp_f32 v45, v45
  v_cvt_pk_bf16_f32 v69, v42, v43
  v_exp_f32 v46, v46
  v_exp_f32 v47, v47
  v_cvt_pk_bf16_f32 v70, v44, v45
  v_cvt_pk_bf16_f32 v71, v46, v47
  s_waitcnt vmcnt(20)
  v_mfma_f32_32x32x16_bf16 v[32:47], a[32:35], v[160:163], 0
  s_add_u32 s88, s87, 528384
  buffer_load_dwordx4 a[80:83], v1, s[40:43], s88 offen offset:0 sc1
  buffer_load_dwordx4 a[84:87], v1, s[40:43], s88 offen offset:1024 sc1
  buffer_load_dwordx4 a[88:91], v1, s[40:43], s88 offen offset:2048 sc1
  buffer_load_dwordx4 a[92:95], v1, s[40:43], s88 offen offset:3072 sc1
  v_exp_f32 v48, v48
  v_exp_f32 v49, v49
  v_exp_f32 v50, v50
  v_exp_f32 v51, v51
  v_cvt_pk_bf16_f32 v72, v48, v49
  v_mfma_f32_32x32x16_bf16 v[32:47], a[36:39], v[164:167], v[32:47]
  v_exp_f32 v52, v52
  v_exp_f32 v53, v53
  v_cvt_pk_bf16_f32 v73, v50, v51
  v_exp_f32 v54, v54
  v_exp_f32 v55, v55
  v_cvt_pk_bf16_f32 v74, v52, v53
  v_mfma_f32_32x32x16_bf16 v[128:143], a[24:27], v[64:67], v[128:143]
  v_exp_f32 v56, v56
  v_exp_f32 v57, v57
  v_cvt_pk_bf16_f32 v75, v54, v55
  v_exp_f32 v58, v58
  v_exp_f32 v59, v59
  v_cvt_pk_bf16_f32 v76, v56, v57
  v_mfma_f32_32x32x16_bf16 v[128:143], a[28:31], v[68:71], v[128:143]
  v_exp_f32 v60, v60
  v_exp_f32 v61, v61
  v_cvt_pk_bf16_f32 v77, v58, v59
  v_exp_f32 v62, v62
  v_exp_f32 v63, v63
  v_cvt_pk_bf16_f32 v78, v60, v61
  v_cvt_pk_bf16_f32 v79, v62, v63
  v_mfma_f32_32x32x16_bf16 v[48:63], a[32:35], v[168:171], 0
  s_add_u32 s88, s87, 532480
  buffer_load_dwordx4 a[96:99], v1, s[40:43], s88 offen offset:0 sc1
  buffer_load_dwordx4 a[100:103], v1, s[40:43], s88 offen offset:1024 sc1
  buffer_load_dwordx4 a[104:107], v1, s[40:43], s88 offen offset:2048 sc1
  buffer_load_dwordx4 a[108:111], v1, s[40:43], s88 offen offset:3072 sc1
  v_exp_f32 v32, v32
  v_exp_f32 v33, v33
  v_exp_f32 v34, v34
  v_exp_f32 v35, v35
  v_cvt_pk_bf16_f32 v64, v32, v33
  v_mfma_f32_32x32x16_bf16 v[48:63], a[36:39], v[172:175], v[48:63]
  v_exp_f32 v36, v36
  v_exp_f32 v37, v37
  v_cvt_pk_bf16_f32 v65, v34, v35
  v_exp_f32 v38, v38
  v_exp_f32 v39, v39
  v_cvt_pk_bf16_f32 v66, v36, v37
  v_mfma_f32_32x32x16_bf16 v[144:159], a[24:27], v[72:75], v[144:159]
  v_exp_f32 v40, v40
  v_exp_f32 v41, v41
  v_cvt_pk_bf16_f32 v67, v38, v39
  v_exp_f32 v42, v42
  v_exp_f32 v43, v43
  v_cvt_pk_bf16_f32 v68, v40, v41
  v_mfma_f32_32x32x16_bf16 v[144:159], a[28:31], v[76:79], v[144:159]
  v_exp_f32 v44, v44
  v_exp_f32 v45, v45
  v_cvt_pk_bf16_f32 v69, v42, v43
  v_exp_f32 v46, v46
  v_exp_f32 v47, v47
  v_cvt_pk_bf16_f32 v70, v44, v45
  v_cvt_pk_bf16_f32 v71, v46, v47
  v_mfma_f32_32x32x16_bf16 v[32:47], a[32:35], v[176:179], 0
  v_exp_f32 v48, v48
  v_exp_f32 v49, v49
  v_exp_f32 v50, v50
  v_exp_f32 v51, v51
  v_cvt_pk_bf16_f32 v72, v48, v49
  v_mfma_f32_32x32x16_bf16 v[32:47], a[36:39], v[180:183], v[32:47]
  v_exp_f32 v52, v52
  v_exp_f32 v53, v53
  v_cvt_pk_bf16_f32 v73, v50, v51
  v_exp_f32 v54, v54
  v_exp_f32 v55, v55
  v_cvt_pk_bf16_f32 v74, v52, v53
  v_mfma_f32_32x32x16_bf16 v[96:111], a[40:43], v[64:67], v[96:111]
  v_exp_f32 v56, v56
  v_exp_f32 v57, v57
  v_cvt_pk_bf16_f32 v75, v54, v55
  v_exp_f32 v58, v58
  v_exp_f32 v59, v59
  v_cvt_pk_bf16_f32 v76, v56, v57
  v_mfma_f32_32x32x16_bf16 v[96:111], a[44:47], v[68:71], v[96:111]
  v_exp_f32 v60, v60
  v_exp_f32 v61, v61
  v_cvt_pk_bf16_f32 v77, v58, v59
  v_exp_f32 v62, v62
  v_exp_f32 v63, v63
  v_cvt_pk_bf16_f32 v78, v60, v61
  v_cvt_pk_bf16_f32 v79, v62, v63
  v_mfma_f32_32x32x16_bf16 v[48:63], a[32:35], v[184:187], 0
  s_add_u32 s88, s87, 544768
  buffer_load_dwordx4 a[16:19], v1, s[40:43], s88 offen offset:0 sc1
  buffer_load_dwordx4 a[20:23], v1, s[40:43], s88 offen offset:1024 sc1
  buffer_load_dwordx4 a[24:27], v1, s[40:43], s88 offen offset:2048 sc1
  buffer_load_dwordx4 a[28:31], v1, s[40:43], s88 offen offset:3072 sc1
  v_exp_f32 v32, v32
  v_exp_f32 v33, v33
  v_exp_f32 v34, v34
  v_exp_f32 v35, v35
  v_cvt_pk_bf16_f32 v64, v32, v33
  v_mfma_f32_32x32x16_bf16 v[48:63], a[36:39], v[188:191], v[48:63]
  v_exp_f32 v36, v36
  v_exp_f32 v37, v37
  v_cvt_pk_bf16_f32 v65, v34, v35
  v_exp_f32 v38, v38
  v_exp_f32 v39, v39
  v_cvt_pk_bf16_f32 v66, v36, v37
  v_mfma_f32_32x32x16_bf16 v[112:127], a[40:43], v[72:75], v[112:127]
  v_exp_f32 v40, v40
  v_exp_f32 v41, v41
  v_cvt_pk_bf16_f32 v67, v38, v39
  v_exp_f32 v42, v42
  v_exp_f32 v43, v43
  v_cvt_pk_bf16_f32 v68, v40, v41
  v_mfma_f32_32x32x16_bf16 v[112:127], a[44:47], v[76:79], v[112:127]
  v_exp_f32 v44, v44
  v_exp_f32 v45, v45
  v_cvt_pk_bf16_f32 v69, v42, v43
  v_exp_f32 v46, v46
  v_exp_f32 v47, v47
  v_cvt_pk_bf16_f32 v70, v44, v45
  v_cvt_pk_bf16_f32 v71, v46, v47
  s_waitcnt vmcnt(26)
  v_mfma_f32_32x32x16_bf16 v[32:47], a[48:51], v[160:163], 0
  s_lshr_b32 s89, s2, 5
  s_lshl_b32 s89, s89, 3
  s_and_b32 s72, s2, 7
  s_add_u32 s89, s89, s72
  s_lshl_b32 s72, s89, 15
  s_lshl_b32 s73, s55, 13
  s_add_u32 s72, s72, s73
  s_add_u32 s83, s72, 7340032
  s_add_u32 s84, s83, 4096
  s_add_u32 s98, s73, 86016
  s_add_u32 m0, s98, 0
  s_nop 0
  buffer_load_dwordx4 v1, s[40:43], s83 offen offset:0 sc1 lds
  buffer_load_dwordx4 v1, s[40:43], s83 offen offset:1024 sc1 lds
  buffer_load_dwordx4 v1, s[40:43], s83 offen offset:2048 sc1 lds
  buffer_load_dwordx4 v1, s[40:43], s83 offen offset:3072 sc1 lds
  s_add_u32 m0, s98, 4096
  s_nop 0
  buffer_load_dwordx4 v1, s[40:43], s84 offen offset:0 sc1 lds
  buffer_load_dwordx4 v1, s[40:43], s84 offen offset:1024 sc1 lds
  buffer_load_dwordx4 v1, s[40:43], s84 offen offset:2048 sc1 lds
  buffer_load_dwordx4 v1, s[40:43], s84 offen offset:3072 sc1 lds
  v_exp_f32 v48, v48
  v_exp_f32 v49, v49
  v_exp_f32 v50, v50
  v_exp_f32 v51, v51
  v_cvt_pk_bf16_f32 v72, v48, v49
  v_mfma_f32_32x32x16_bf16 v[32:47], a[52:55], v[164:167], v[32:47]
  v_exp_f32 v52, v52
  v_exp_f32 v53, v53
  v_cvt_pk_bf16_f32 v73, v50, v51
  v_exp_f32 v54, v54
  v_exp_f32 v55, v55
  v_cvt_pk_bf16_f32 v74, v52, v53
  v_mfma_f32_32x32x16_bf16 v[128:143], a[40:43], v[64:67], v[128:143]
  v_exp_f32 v56, v56
  v_exp_f32 v57, v57
  v_cvt_pk_bf16_f32 v75, v54, v55
  v_exp_f32 v58, v58
  v_exp_f32 v59, v59
  v_cvt_pk_bf16_f32 v76, v56, v57
  v_mfma_f32_32x32x16_bf16 v[128:143], a[44:47], v[68:71], v[128:143]
  v_exp_f32 v60, v60
  v_exp_f32 v61, v61
  v_cvt_pk_bf16_f32 v77, v58, v59
  v_exp_f32 v62, v62
  v_exp_f32 v63, v63
  v_cvt_pk_bf16_f32 v78, v60, v61
  v_cvt_pk_bf16_f32 v79, v62, v63
  v_mfma_f32_32x32x16_bf16 v[48:63], a[48:51], v[168:171], 0
  s_add_u32 s88, s87, 536576
  buffer_load_dwordx4 a[112:115], v1, s[40:43], s88 offen offset:0 sc1
  buffer_load_dwordx4 a[116:119], v1, s[40:43], s88 offen offset:1024 sc1
  buffer_load_dwordx4 a[120:123], v1, s[40:43], s88 offen offset:2048 sc1
  buffer_load_dwordx4 a[124:127], v1, s[40:43], s88 offen offset:3072 sc1
  v_exp_f32 v32, v32
  v_exp_f32 v33, v33
  v_exp_f32 v34, v34
  v_exp_f32 v35, v35
  v_cvt_pk_bf16_f32 v64, v32, v33
  v_mfma_f32_32x32x16_bf16 v[48:63], a[52:55], v[172:175], v[48:63]
  v_exp_f32 v36, v36
  v_exp_f32 v37, v37
  v_cvt_pk_bf16_f32 v65, v34, v35
  v_exp_f32 v38, v38
  v_exp_f32 v39, v39
  v_cvt_pk_bf16_f32 v66, v36, v37
  v_mfma_f32_32x32x16_bf16 v[144:159], a[40:43], v[72:75], v[144:159]
  v_exp_f32 v40, v40
  v_exp_f32 v41, v41
  v_cvt_pk_bf16_f32 v67, v38, v39
  v_exp_f32 v42, v42
  v_exp_f32 v43, v43
  v_cvt_pk_bf16_f32 v68, v40, v41
  v_mfma_f32_32x32x16_bf16 v[144:159], a[44:47], v[76:79], v[144:159]
  v_exp_f32 v44, v44
  v_exp_f32 v45, v45
  v_cvt_pk_bf16_f32 v69, v42, v43
  v_exp_f32 v46, v46
  v_exp_f32 v47, v47
  v_cvt_pk_bf16_f32 v70, v44, v45
  v_cvt_pk_bf16_f32 v71, v46, v47
  v_mfma_f32_32x32x16_bf16 v[32:47], a[48:51], v[176:179], 0
  v_exp_f32 v48, v48
  v_exp_f32 v49, v49
  v_exp_f32 v50, v50
  v_exp_f32 v51, v51
  v_cvt_pk_bf16_f32 v72, v48, v49
  v_mfma_f32_32x32x16_bf16 v[32:47], a[52:55], v[180:183], v[32:47]
  v_exp_f32 v52, v52
  v_exp_f32 v53, v53
  v_cvt_pk_bf16_f32 v73, v50, v51
  v_exp_f32 v54, v54
  v_exp_f32 v55, v55
  v_cvt_pk_bf16_f32 v74, v52, v53
  v_mfma_f32_32x32x16_bf16 v[96:111], a[56:59], v[64:67], v[96:111]
  s_add_u32 s72, s55, 1
  s_and_b32 s72, s72, 3
  s_mul_i32 s72, s72, 12288
  s_add_u32 s72, s72, 0
  v_add_u32 v17, s72, v1
  s_add_u32 s72, s55, 2
  s_and_b32 s72, s72, 3
  s_mul_i32 s72, s72, 12288
  s_add_u32 s72, s72, 4096
  v_add_u32 v18, s72, v1
  s_add_u32 s72, s55, 3
  s_and_b32 s72, s72, 3
  s_mul_i32 s72, s72, 12288
  s_add_u32 s72, s72, 8192
  v_add_u32 v19, s72, v1
  s_mul_i32 s72, s55, 12288
  s_add_u32 s72, s72, 0
  v_add_u32 v20, s72, v1
  v_exp_f32 v56, v56
  v_exp_f32 v57, v57
  v_cvt_pk_bf16_f32 v75, v54, v55
  v_exp_f32 v58, v58
  v_exp_f32 v59, v59
  v_cvt_pk_bf16_f32 v76, v56, v57
  v_mfma_f32_32x32x16_bf16 v[96:111], a[60:63], v[68:71], v[96:111]
  v_exp_f32 v60, v60
  v_exp_f32 v61, v61
  v_cvt_pk_bf16_f32 v77, v58, v59
  v_exp_f32 v62, v62
  v_exp_f32 v63, v63
  v_cvt_pk_bf16_f32 v78, v60, v61
  v_cvt_pk_bf16_f32 v79, v62, v63
  v_mfma_f32_32x32x16_bf16 v[48:63], a[48:51], v[184:187], 0
  s_add_u32 s88, s87, 548864
  buffer_load_dwordx4 a[32:35], v1, s[40:43], s88 offen offset:0 sc1
  buffer_load_dwordx4 a[36:39], v1, s[40:43], s88 offen offset:1024 sc1
  buffer_load_dwordx4 a[40:43], v1, s[40:43], s88 offen offset:2048 sc1
  buffer_load_dwordx4 a[44:47], v1, s[40:43], s88 offen offset:3072 sc1
  v_exp_f32 v32, v32
  v_exp_f32 v33, v33
  v_exp_f32 v34, v34
  v_exp_f32 v35, v35
  v_cvt_pk_bf16_f32 v64, v32, v33
  v_mfma_f32_32x32x16_bf16 v[48:63], a[52:55], v[188:191], v[48:63]
  v_exp_f32 v36, v36
  v_exp_f32 v37, v37
  v_cvt_pk_bf16_f32 v65, v34, v35
  v_exp_f32 v38, v38
  v_exp_f32 v39, v39
  v_cvt_pk_bf16_f32 v66, v36, v37
  v_mfma_f32_32x32x16_bf16 v[112:127], a[56:59], v[72:75], v[112:127]
  ds_write_b128 v17, v[96:99] offset:0
  ds_write_b128 v17, v[100:103] offset:1024
  v_exp_f32 v40, v40
  v_exp_f32 v41, v41
  v_cvt_pk_bf16_f32 v67, v38, v39
  v_exp_f32 v42, v42
  v_exp_f32 v43, v43
  v_cvt_pk_bf16_f32 v68, v40, v41
  v_mfma_f32_32x32x16_bf16 v[112:127], a[60:63], v[76:79], v[112:127]
  ds_write_b128 v17, v[104:107] offset:2048
  ds_write_b128 v17, v[108:111] offset:3072
  v_exp_f32 v44, v44
  v_exp_f32 v45, v45
  v_cvt_pk_bf16_f32 v69, v42, v43
  v_exp_f32 v46, v46
  v_exp_f32 v47, v47
  v_cvt_pk_bf16_f32 v70, v44, v45
  v_cvt_pk_bf16_f32 v71, v46, v47
  v_exp_f32 v48, v48
  v_exp_f32 v49, v49
  v_exp_f32 v50, v50
  v_exp_f32 v51, v51
  v_cvt_pk_bf16_f32 v72, v48, v49
  v_exp_f32 v52, v52
  v_exp_f32 v53, v53
  v_cvt_pk_bf16_f32 v73, v50, v51
  v_exp_f32 v54, v54
  v_exp_f32 v55, v55
  v_cvt_pk_bf16_f32 v74, v52, v53
  v_mfma_f32_32x32x16_bf16 v[128:143], a[56:59], v[64:67], v[128:143]
  ds_write_b128 v18, v[112:115] offset:0
  ds_write_b128 v18, v[116:119] offset:1024
  v_exp_f32 v56, v56
  v_exp_f32 v57, v57
  v_cvt_pk_bf16_f32 v75, v54, v55
  v_exp_f32 v58, v58
  v_exp_f32 v59, v59
  v_cvt_pk_bf16_f32 v76, v56, v57
  v_mfma_f32_32x32x16_bf16 v[128:143], a[60:63], v[68:71], v[128:143]
  ds_write_b128 v18, v[120:123] offset:2048
  ds_write_b128 v18, v[124:127] offset:3072
  v_exp_f32 v60, v60
  v_exp_f32 v61, v61
  v_cvt_pk_bf16_f32 v77, v58, v59
  v_exp_f32 v62, v62
  v_exp_f32 v63, v63
  v_cvt_pk_bf16_f32 v78, v60, v61
  v_cvt_pk_bf16_f32 v79, v62, v63
  s_nop 0
  v_mfma_f32_32x32x16_bf16 v[144:159], a[56:59], v[72:75], v[144:159]
  v_mfma_f32_32x32x16_bf16 v[144:159], a[60:63], v[76:79], v[144:159]
L_roles_done:
L_combine:
  s_waitcnt vmcnt(4)
  v_add_u32 v27, s98, v1
  ds_read_b128 v[192:195], v27 offset:0
  ds_read_b128 v[196:199], v27 offset:1024
  ds_read_b128 v[200:203], v27 offset:2048
  ds_read_b128 v[204:207], v27 offset:3072
  ds_read_b128 v[208:211], v27 offset:4096
  ds_read_b128 v[212:215], v27 offset:5120
  ds_read_b128 v[216:219], v27 offset:6144
  ds_read_b128 v[220:223], v27 offset:7168
  ds_write_b128 v19, v[128:131] offset:0
  ds_write_b128 v19, v[132:135] offset:1024
  ds_write_b128 v19, v[136:139] offset:2048
  ds_write_b128 v19, v[140:143] offset:3072
  v_max3_f32 v16, v108, v124, v140
  s_nop 1
  v_max_f32 v16, v16, v156
  v_mov_b32 v21, 0x6c800000
  s_mov_b32 exec_lo, 0
  v_cmp_nle_f32 vcc, v16, v21
  s_mov_b32 exec_lo, -1
  s_nop 0
  s_cmp_lg_u32 vcc_hi, 0
  s_cselect_b32 s72, 1, 0
  v_mov_b32 v21, s72
  s_lshl_b32 s73, s55, 2
  s_add_u32 s73, s73, 49152
  v_mov_b32 v22, s73
  ds_write_b32 v22, v21
  s_waitcnt lgkmcnt(5)
  v_max3_u32 v26, v192, v193, v194
  v_max3_u32 v25, v208, v209, v210
  v_max3_u32 v26, v26, v195, v196
  v_max3_u32 v25, v25, v211, v212
  v_max3_u32 v26, v26, v197, v198
  v_max3_u32 v25, v25, v213, v214
  v_max3_u32 v26, v26, v199, v200
  v_max3_u32 v25, v25, v215, v216
  v_max3_u32 v26, v26, v201, v202
  v_max3_u32 v25, v25, v217, v218
  v_max3_u32 v26, v26, v203, v204
  v_max3_u32 v25, v25, v219, v220
  v_max3_u32 v26, v26, v205, v206
  v_max3_u32 v25, v25, v221, v222
  v_max3_u32 v26, v26, v207, v223
  v_max_u32 v26, v26, v25
  v_cmp_eq_u32 vcc, -1, v26
  s_nop 1
  s_cbranch_vccnz L_oloop_26
L_oback_25:
  s_waitcnt lgkmcnt(0)
  s_barrier
  ds_read_b128 v[32:35], v20 offset:0
  ds_read_b128 v[36:39], v20 offset:1024
  ds_read_b128 v[40:43], v20 offset:2048
  ds_read_b128 v[44:47], v20 offset:3072
  ds_read_b128 v[48:51], v20 offset:4096
  ds_read_b128 v[52:55], v20 offset:5120
  ds_read_b128 v[56:59], v20 offset:6144
  ds_read_b128 v[60:63], v20 offset:7168
  ds_read_b128 v[64:67], v20 offset:8192
  ds_read_b128 v[68:71], v20 offset:9216
  ds_read_b128 v[72:75], v20 offset:10240
  ds_read_b128 v[76:79], v20 offset:11264
  v_mov_b32 v22, 49152
  ds_read_b128 v[16:19], v22
  s_waitcnt lgkmcnt(9)
  v_pk_add_f32 v[144:145], v[144:145], v[32:33]
  v_pk_add_f32 v[146:147], v[146:147], v[34:35]
  v_pk_add_f32 v[148:149], v[148:149], v[36:37]
  v_pk_add_f32 v[150:151], v[150:151], v[38:39]
  v_pk_add_f32 v[152:153], v[152:153], v[40:41]
  v_pk_add_f32 v[154:155], v[154:155], v[42:43]
  v_pk_add_f32 v[156:157], v[156:157], v[44:45]
  v_pk_add_f32 v[158:159], v[158:159], v[46:47]
  s_waitcnt lgkmcnt(5)
  v_pk_add_f32 v[144:145], v[144:145], v[48:49]
  v_pk_add_f32 v[146:147], v[146:147], v[50:51]
  v_pk_add_f32 v[148:149], v[148:149], v[52:53]
  v_pk_add_f32 v[150:151], v[150:151], v[54:55]
  v_pk_add_f32 v[152:153], v[152:153], v[56:57]
  v_pk_add_f32 v[154:155], v[154:155], v[58:59]
  v_pk_add_f32 v[156:157], v[156:157], v[60:61]
  v_pk_add_f32 v[158:159], v[158:159], v[62:63]
  s_waitcnt lgkmcnt(1)
  v_pk_add_f32 v[144:145], v[144:145], v[64:65]
  v_pk_add_f32 v[146:147], v[146:147], v[66:67]
  v_pk_add_f32 v[148:149], v[148:149], v[68:69]
  v_pk_add_f32 v[150:151], v[150:151], v[70:71]
  v_pk_add_f32 v[152:153], v[152:153], v[72:73]
  v_pk_add_f32 v[154:155], v[154:155], v[74:75]
  v_pk_add_f32 v[156:157], v[156:157], v[76:77]
  v_pk_add_f32 v[158:159], v[158:159], v[78:79]
  s_waitcnt lgkmcnt(0)
  v_or3_b32 v16, v16, v17, v18
  v_or_b32 v16, v16, v19
  s_nop 0
  v_readfirstlane_b32 s72, v16
  s_nop 0
  s_andn2_b32 s72, s72, s100
  s_cbranch_scc1 L_fallback
  s_lshl_b32 s72, s58, 2
  s_add_u32 s72, s72, s55
  s_lshl_b32 s72, s72, 4
  s_add_u32 s72, s72, s57
  s_lshl_b32 s72, s72, 11
  s_add_u32 s72, s72, 9437184
  v_mov_b32 v16, v156
  v_mov_b32 v17, v156
  s_nop 1
  v_permlane32_swap_b32 v16, v17
  v_rcp_f32 v18, v17
  s_nop 0
  v_pk_mul_f32 v[144:145], v[144:145], v[18:19] op_sel_hi:[1,0]
  v_pk_mul_f32 v[146:147], v[146:147], v[18:19] op_sel_hi:[1,0]
  v_pk_mul_f32 v[148:149], v[148:149], v[18:19] op_sel_hi:[1,0]
  v_pk_mul_f32 v[150:151], v[150:151], v[18:19] op_sel_hi:[1,0]
  v_pk_mul_f32 v[152:153], v[152:153], v[18:19] op_sel_hi:[1,0]
  v_pk_mul_f32 v[154:155], v[154:155], v[18:19] op_sel_hi:[1,0]
  v_pk_mul_f32 v[156:157], v[156:157], v[18:19] op_sel_hi:[1,0]
  v_pk_mul_f32 v[158:159], v[158:159], v[18:19] op_sel_hi:[1,0]
  v_cvt_pk_bf16_f32 v144, v144, v145
  v_cvt_pk_bf16_f32 v145, v146, v147
  v_cvt_pk_bf16_f32 v146, v148, v149
  v_cvt_pk_bf16_f32 v147, v150, v151
  v_cvt_pk_bf16_f32 v148, v152, v153
  v_cvt_pk_bf16_f32 v149, v154, v155
  v_cvt_pk_bf16_f32 v150, v156, v157
  v_cvt_pk_bf16_f32 v151, v158, v159
  s_mov_b32 exec_lo, 0
  v_mov_b32 v150, 0
  v_mov_b32 v151, 0
  s_mov_b32 exec_lo, -1
  buffer_store_dwordx4 v[144:147], v1, s[40:43], s72 offen sc1
  buffer_store_dwordx4 v[148:151], v1, s[40:43], s72 offen offset:1024 sc1
  v_add_u32 v18, 86016, v1
  ds_read_b128 v[32:35], v18 offset:0
  ds_read_b128 v[36:39], v18 offset:1024
  ds_read_b128 v[40:43], v18 offset:2048
  ds_read_b128 v[44:47], v18 offset:3072
  ds_read_b128 v[48:51], v18 offset:4096
  ds_read_b128 v[52:55], v18 offset:5120
  ds_read_b128 v[56:59], v18 offset:6144
  s_waitcnt lgkmcnt(6)
  v_mfma_f32_32x32x16_bf16 v[96:111], a[128:131], v[32:35], 0
  ds_read_b128 v[60:63], v18 offset:7168
  s_waitcnt lgkmcnt(6)
  v_mfma_f32_32x32x16_bf16 v[96:111], a[132:135], v[36:39], v[96:111]
  ds_read_b128 v[32:35], v18 offset:8192
  s_lshr_b32 s89, s2, 5
  s_lshl_b32 s89, s89, 3
  s_and_b32 s72, s2, 7
  s_add_u32 s89, s89, s72
  v_and_b32 v28, 31, v0
  s_lshl_b32 s72, s89, 5
  v_add_u32 v28, s72, v28
  v_mul_u32_u24 v28, 1792, v28
  v_lshrrev_b32 v29, 5, v0
  v_lshl_add_u32 v28, v29, 3, v28
  s_bfe_u32 s72, s2, 0x20003
  s_lshl_b32 s72, s72, 2
  s_add_u32 s72, s72, s55
  s_mul_i32 s91, s72, 56
  s_add_u32 s90, s91, 896
  s_waitcnt lgkmcnt(6)
  v_mfma_f32_32x32x16_bf16 v[96:111], a[136:139], v[40:43], v[96:111]
  ds_read_b128 v[36:39], v18 offset:9216
  s_waitcnt lgkmcnt(6)
  v_mfma_f32_32x32x16_bf16 v[96:111], a[140:143], v[44:47], v[96:111]
  ds_read_b128 v[40:43], v18 offset:10240
  s_add_u32 s88, s87, 552960
  buffer_load_dwordx4 a[48:51], v1, s[40:43], s88 offen offset:0 sc1
  buffer_load_dwordx4 a[52:55], v1, s[40:43], s88 offen offset:1024 sc1
  buffer_load_dwordx4 a[56:59], v1, s[40:43], s88 offen offset:2048 sc1
  buffer_load_dwordx4 a[60:63], v1, s[40:43], s88 offen offset:3072 sc1
  s_waitcnt lgkmcnt(6)
  v_mfma_f32_32x32x16_bf16 v[96:111], a[144:147], v[48:51], v[96:111]
  ds_read_b128 v[44:47], v18 offset:11264
  s_waitcnt lgkmcnt(6)
  v_mfma_f32_32x32x16_bf16 v[96:111], a[148:151], v[52:55], v[96:111]
  ds_read_b128 v[48:51], v18 offset:12288
  s_waitcnt lgkmcnt(6)
  v_mfma_f32_32x32x16_bf16 v[96:111], a[152:155], v[56:59], v[96:111]
  ds_read_b128 v[52:55], v18 offset:13312
  s_waitcnt lgkmcnt(6)
  v_mfma_f32_32x32x16_bf16 v[96:111], a[156:159], v[60:63], v[96:111]
  ds_read_b128 v[56:59], v18 offset:14336
  s_waitcnt lgkmcnt(6)
  v_mfma_f32_32x32x16_bf16 v[96:111], a[160:163], v[32:35], v[96:111]
  ds_read_b128 v[60:63], v18 offset:15360
  s_waitcnt lgkmcnt(6)
  v_mfma_f32_32x32x16_bf16 v[96:111], a[164:167], v[36:39], v[96:111]
  ds_read_b128 v[32:35], v18 offset:16384
  s_waitcnt lgkmcnt(6)
  v_mfma_f32_32x32x16_bf16 v[96:111], a[168:171], v[40:43], v[96:111]
  ds_read_b128 v[36:39], v18 offset:17408
  s_waitcnt lgkmcnt(6)
  v_mfma_f32_32x32x16_bf16 v[96:111], a[172:175], v[44:47], v[96:111]
  ds_read_b128 v[40:43], v18 offset:18432
  s_waitcnt lgkmcnt(6)
  v_mfma_f32_32x32x16_bf16 v[96:111], a[176:179], v[48:51], v[96:111]
  ds_read_b128 v[44:47], v18 offset:19456
  s_waitcnt lgkmcnt(6)
  v_mfma_f32_32x32x16_bf16 v[96:111], a[180:183], v[52:55], v[96:111]
  ds_read_b128 v[48:51], v18 offset:20480
  s_waitcnt lgkmcnt(6)
  v_mfma_f32_32x32x16_bf16 v[96:111], a[184:187], v[56:59], v[96:111]
  ds_read_b128 v[52:55], v18 offset:21504
  s_waitcnt lgkmcnt(6)
  v_mfma_f32_32x32x16_bf16 v[96:111], a[188:191], v[60:63], v[96:111]
  ds_read_b128 v[56:59], v18 offset:22528
  s_waitcnt lgkmcnt(6)
  v_mfma_f32_32x32x16_bf16 v[96:111], a[192:195], v[32:35], v[96:111]
  ds_read_b128 v[60:63], v18 offset:23552
  s_waitcnt lgkmcnt(6)
  v_mfma_f32_32x32x16_bf16 v[96:111], a[196:199], v[36:39], v[96:111]
  ds_read_b128 v[32:35], v18 offset:24576
  s_waitcnt lgkmcnt(6)
  v_mfma_f32_32x32x16_bf16 v[96:111], a[200:203], v[40:43], v[96:111]
  ds_read_b128 v[36:39], v18 offset:25600
  s_waitcnt lgkmcnt(6)
  v_mfma_f32_32x32x16_bf16 v[96:111], a[204:207], v[44:47], v[96:111]
  ds_read_b128 v[40:43], v18 offset:26624
  s_waitcnt lgkmcnt(6)
  v_mfma_f32_32x32x16_bf16 v[96:111], a[208:211], v[48:51], v[96:111]
  ds_read_b128 v[44:47], v18 offset:27648
  s_waitcnt lgkmcnt(6)
  v_mfma_f32_32x32x16_bf16 v[96:111], a[212:215], v[52:55], v[96:111]
  ds_read_b128 v[48:51], v18 offset:28672
  s_waitcnt lgkmcnt(6)
  v_mfma_f32_32x32x16_bf16 v[96:111], a[216:219], v[56:59], v[96:111]
  ds_read_b128 v[52:55], v18 offset:29696
  s_waitcnt lgkmcnt(6)
  v_mfma_f32_32x32x16_bf16 v[96:111], a[220:223], v[60:63], v[96:111]
  ds_read_b128 v[56:59], v18 offset:30720
  s_waitcnt lgkmcnt(6)
  v_mfma_f32_32x32x16_bf16 v[96:111], a[224:227], v[32:35], v[96:111]
  ds_read_b128 v[60:63], v18 offset:31744
  s_waitcnt lgkmcnt(6)
  v_mfma_f32_32x32x16_bf16 v[96:111], a[228:231], v[36:39], v[96:111]
  s_waitcnt lgkmcnt(5)
  v_mfma_f32_32x32x16_bf16 v[96:111], a[232:235], v[40:43], v[96:111]
  s_waitcnt lgkmcnt(4)
  v_mfma_f32_32x32x16_bf16 v[96:111], a[236:239], v[44:47], v[96:111]
  s_waitcnt lgkmcnt(3)
  v_mfma_f32_32x32x16_bf16 v[96:111], a[240:243], v[48:51], v[96:111]
  s_waitcnt lgkmcnt(2)
  v_mfma_f32_32x32x16_bf16 v[96:111], a[244:247], v[52:55], v[96:111]
  s_waitcnt lgkmcnt(1)
  v_mfma_f32_32x32x16_bf16 v[96:111], a[248:251], v[56:59], v[96:111]
  s_waitcnt lgkmcnt(0)
  v_mfma_f32_32x32x16_bf16 v[96:111], a[252:255], v[60:63], v[96:111]
  s_lshr_b32 s89, s2, 5
  s_lshl_b32 s89, s89, 3
  s_and_b32 s72, s2, 7
  s_add_u32 s89, s89, s72
  s_lshl_b32 s72, s89, 15
  s_lshl_b32 s73, s55, 13
  s_add_u32 s72, s72, s73
  s_add_u32 s85, s72, 9437184
  s_add_u32 s86, s85, 4096
  s_add_u32 s99, s73, 53248
  s_add_u32 m0, s99, 0
  s_nop 0
  buffer_load_dwordx4 v1, s[40:43], s85 offen offset:0 sc1 lds
  buffer_load_dwordx4 v1, s[40:43], s85 offen offset:1024 sc1 lds
  buffer_load_dwordx4 v1, s[40:43], s85 offen offset:2048 sc1 lds
  buffer_load_dwordx4 v1, s[40:43], s85 offen offset:3072 sc1 lds
  s_add_u32 m0, s99, 4096
  s_nop 0
  buffer_load_dwordx4 v1, s[40:43], s86 offen offset:0 sc1 lds
  buffer_load_dwordx4 v1, s[40:43], s86 offen offset:1024 sc1 lds
  buffer_load_dwordx4 v1, s[40:43], s86 offen offset:2048 sc1 lds
  buffer_load_dwordx4 v1, s[40:43], s86 offen offset:3072 sc1 lds
  s_waitcnt vmcnt(0)
  v_add_u32 v27, s99, v1
  ds_read_b128 v[192:195], v27 offset:0
  ds_read_b128 v[196:199], v27 offset:1024
  ds_read_b128 v[200:203], v27 offset:2048
  ds_read_b128 v[204:207], v27 offset:3072
  ds_read_b128 v[208:211], v27 offset:4096
  ds_read_b128 v[212:215], v27 offset:5120
  ds_read_b128 v[216:219], v27 offset:6144
  ds_read_b128 v[220:223], v27 offset:7168
  s_waitcnt lgkmcnt(0)
  v_max3_u32 v26, v192, v193, v194
  v_max3_u32 v25, v208, v209, v210
  v_max3_u32 v26, v26, v195, v196
  v_max3_u32 v25, v25, v211, v212
  v_max3_u32 v26, v26, v197, v198
  v_max3_u32 v25, v25, v213, v214
  v_max3_u32 v26, v26, v199, v200
  v_max3_u32 v25, v25, v215, v216
  v_max3_u32 v26, v26, v201, v202
  v_max3_u32 v25, v25, v217, v218
  v_max3_u32 v26, v26, v203, v204
  v_max3_u32 v25, v25, v219, v220
  v_max3_u32 v26, v26, v205, v206
  v_max3_u32 v25, v25, v221, v222
  v_max3_u32 v26, v26, v207, v223
  v_max_u32 v26, v26, v25
  v_cmp_eq_u32 vcc, -1, v26
  s_nop 1
  s_cbranch_vccnz L_oloop_28
L_oback_27:
  s_barrier
  v_add_u32 v18, 53248, v1
  ds_read_b128 v[32:35], v18 offset:0
  ds_read_b128 v[36:39], v18 offset:1024
  ds_read_b128 v[40:43], v18 offset:2048
  ds_read_b128 v[44:47], v18 offset:3072
  ds_read_b128 v[48:51], v18 offset:4096
  ds_read_b128 v[52:55], v18 offset:5120
  ds_read_b128 v[56:59], v18 offset:6144
  s_waitcnt lgkmcnt(6)
  v_mfma_f32_32x32x16_bf16 v[112:127], a[64:67], v[32:35], 0
  ds_read_b128 v[60:63], v18 offset:7168
  s_waitcnt lgkmcnt(6)
  v_mfma_f32_32x32x16_bf16 v[112:127], a[68:71], v[36:39], v[112:127]
  ds_read_b128 v[32:35], v18 offset:8192
  s_waitcnt lgkmcnt(6)
  v_mfma_f32_32x32x16_bf16 v[112:127], a[72:75], v[40:43], v[112:127]
  ds_read_b128 v[36:39], v18 offset:9216
  v_cvt_pk_bf16_f32 v96, v96, v97
  v_cvt_pk_bf16_f32 v97, v98, v99
  v_cvt_pk_bf16_f32 v98, v100, v101
  v_cvt_pk_bf16_f32 v99, v102, v103
  v_cvt_pk_bf16_f32 v100, v104, v105
  v_cvt_pk_bf16_f32 v101, v106, v107
  v_cvt_pk_bf16_f32 v102, v108, v109
  v_cvt_pk_bf16_f32 v103, v110, v111
  s_waitcnt lgkmcnt(6)
  v_mfma_f32_32x32x16_bf16 v[112:127], a[76:79], v[44:47], v[112:127]
  ds_read_b128 v[40:43], v18 offset:10240
  s_waitcnt lgkmcnt(6)
  v_mfma_f32_32x32x16_bf16 v[112:127], a[80:83], v[48:51], v[112:127]
  ds_read_b128 v[44:47], v18 offset:11264
  s_waitcnt lgkmcnt(6)
  v_mfma_f32_32x32x16_bf16 v[112:127], a[84:87], v[52:55], v[112:127]
  ds_read_b128 v[48:51], v18 offset:12288
  s_waitcnt lgkmcnt(6)
  v_mfma_f32_32x32x16_bf16 v[112:127], a[88:91], v[56:59], v[112:127]
  ds_read_b128 v[52:55], v18 offset:13312
  buffer_store_dwordx2 v[96:97], v28, s[44:47], s91 offen offset:0
  s_waitcnt lgkmcnt(6)
  v_mfma_f32_32x32x16_bf16 v[112:127], a[92:95], v[60:63], v[112:127]
  ds_read_b128 v[56:59], v18 offset:14336
  s_waitcnt lgkmcnt(6)
  v_mfma_f32_32x32x16_bf16 v[112:127], a[96:99], v[32:35], v[112:127]
  ds_read_b128 v[60:63], v18 offset:15360
  s_waitcnt lgkmcnt(6)
  v_mfma_f32_32x32x16_bf16 v[112:127], a[100:103], v[36:39], v[112:127]
  ds_read_b128 v[32:35], v18 offset:16384
  s_waitcnt lgkmcnt(6)
  v_mfma_f32_32x32x16_bf16 v[112:127], a[104:107], v[40:43], v[112:127]
  ds_read_b128 v[36:39], v18 offset:17408
  buffer_store_dwordx2 v[98:99], v28, s[44:47], s91 offen offset:16
  s_waitcnt lgkmcnt(6)
  v_mfma_f32_32x32x16_bf16 v[112:127], a[108:111], v[44:47], v[112:127]
  ds_read_b128 v[40:43], v18 offset:18432
  s_waitcnt lgkmcnt(6)
  v_mfma_f32_32x32x16_bf16 v[112:127], a[112:115], v[48:51], v[112:127]
  ds_read_b128 v[44:47], v18 offset:19456
  s_waitcnt lgkmcnt(6)
  v_mfma_f32_32x32x16_bf16 v[112:127], a[116:119], v[52:55], v[112:127]
  ds_read_b128 v[48:51], v18 offset:20480
  s_waitcnt lgkmcnt(6)
  v_mfma_f32_32x32x16_bf16 v[112:127], a[120:123], v[56:59], v[112:127]
  ds_read_b128 v[52:55], v18 offset:21504
  buffer_store_dwordx2 v[100:101], v28, s[44:47], s91 offen offset:32
  s_waitcnt lgkmcnt(6)
  v_mfma_f32_32x32x16_bf16 v[112:127], a[124:127], v[60:63], v[112:127]
  ds_read_b128 v[56:59], v18 offset:22528
  s_waitcnt lgkmcnt(6)
  v_mfma_f32_32x32x16_bf16 v[112:127], a[0:3], v[32:35], v[112:127]
  ds_read_b128 v[60:63], v18 offset:23552
  s_waitcnt lgkmcnt(6)
  v_mfma_f32_32x32x16_bf16 v[112:127], a[4:7], v[36:39], v[112:127]
  ds_read_b128 v[32:35], v18 offset:24576
  s_waitcnt lgkmcnt(6)
  v_mfma_f32_32x32x16_bf16 v[112:127], a[8:11], v[40:43], v[112:127]
  ds_read_b128 v[36:39], v18 offset:25600
  s_mov_b32 exec_hi, 0
  buffer_store_dwordx2 v[102:103], v28, s[44:47], s91 offen offset:48
  s_mov_b32 exec_hi, -1
  s_waitcnt lgkmcnt(6)
  v_mfma_f32_32x32x16_bf16 v[112:127], a[12:15], v[44:47], v[112:127]
  ds_read_b128 v[40:43], v18 offset:26624
  s_waitcnt lgkmcnt(6)
  v_mfma_f32_32x32x16_bf16 v[112:127], a[16:19], v[48:51], v[112:127]
  ds_read_b128 v[44:47], v18 offset:27648
  s_waitcnt lgkmcnt(6)
  v_mfma_f32_32x32x16_bf16 v[112:127], a[20:23], v[52:55], v[112:127]
  ds_read_b128 v[48:51], v18 offset:28672
  s_waitcnt lgkmcnt(6)
  v_mfma_f32_32x32x16_bf16 v[112:127], a[24:27], v[56:59], v[112:127]
  ds_read_b128 v[52:55], v18 offset:29696
  s_waitcnt lgkmcnt(6)
  v_mfma_f32_32x32x16_bf16 v[112:127], a[28:31], v[60:63], v[112:127]
  ds_read_b128 v[56:59], v18 offset:30720
  s_waitcnt lgkmcnt(6)
  v_mfma_f32_32x32x16_bf16 v[112:127], a[32:35], v[32:35], v[112:127]
  ds_read_b128 v[60:63], v18 offset:31744
  s_waitcnt lgkmcnt(6)
  v_mfma_f32_32x32x16_bf16 v[112:127], a[36:39], v[36:39], v[112:127]
  s_waitcnt lgkmcnt(5)
  v_mfma_f32_32x32x16_bf16 v[112:127], a[40:43], v[40:43], v[112:127]
  s_waitcnt lgkmcnt(4)
  v_mfma_f32_32x32x16_bf16 v[112:127], a[44:47], v[44:47], v[112:127]
  s_waitcnt lgkmcnt(3)
  v_mfma_f32_32x32x16_bf16 v[112:127], a[48:51], v[48:51], v[112:127]
  s_waitcnt lgkmcnt(2)
  v_mfma_f32_32x32x16_bf16 v[112:127], a[52:55], v[52:55], v[112:127]
  s_waitcnt lgkmcnt(1)
  v_mfma_f32_32x32x16_bf16 v[112:127], a[56:59], v[56:59], v[112:127]
  s_waitcnt lgkmcnt(0)
  v_mfma_f32_32x32x16_bf16 v[112:127], a[60:63], v[60:63], v[112:127]
  s_nop 11
  v_cvt_pk_bf16_f32 v112, v112, v113
  v_cvt_pk_bf16_f32 v113, v114, v115
  v_cvt_pk_bf16_f32 v114, v116, v117
  v_cvt_pk_bf16_f32 v115, v118, v119
  v_cvt_pk_bf16_f32 v116, v120, v121
  v_cvt_pk_bf16_f32 v117, v122, v123
  v_cvt_pk_bf16_f32 v118, v124, v125
  v_cvt_pk_bf16_f32 v119, v126, v127
  buffer_store_dwordx2 v[112:113], v28, s[44:47], s90 offen offset:0
  buffer_store_dwordx2 v[114:115], v28, s[44:47], s90 offen offset:16
  buffer_store_dwordx2 v[116:117], v28, s[44:47], s90 offen offset:32
  s_mov_b32 exec_hi, 0
  buffer_store_dwordx2 v[118:119], v28, s[44:47], s90 offen offset:48
  s_mov_b32 exec_hi, -1
  s_cmp_lg_u32 s2, 0
  s_cbranch_scc1 L_gen_29
  s_cmp_lg_u32 s55, 0
  s_cbranch_scc1 L_gen_29
  v_mov_b32 v23, s56
  v_mov_b32 v22, 0
  s_mov_b64 exec, 1
  buffer_store_dword v23, v22, s[40:43], 0 offen
  s_mov_b64 exec, -1
L_gen_29:
L_end:
  s_endpgm
L_spin_f1_9:
  s_mov_b32 s81, 0x8000
L_spin_f1_9_loop:
  buffer_load_dword v20, v19, s[40:43], s82 offen sc1
  s_waitcnt vmcnt(0)
  v_cmp_ne_u32 vcc, s56, v20
  s_nop 1
  s_cbranch_vccz L_back_f1_8
  s_sub_u32 s81, s81, 1
  s_cmp_lg_u32 s81, 0
  s_cbranch_scc1 L_spin_f1_9_loop
  s_branch L_back_f1_8
L_spin_f2_14:
  s_mov_b32 s81, 0x8000
L_spin_f2_14_loop:
  buffer_load_dword v25, v24, s[40:43], s90 offen sc1
  s_waitcnt vmcnt(0)
  v_cmp_ne_u32 vcc, s56, v25
  s_nop 1
  s_cbranch_vccz L_back_f2_13
  s_sub_u32 s81, s81, 1
  s_cmp_lg_u32 s81, 0
  s_cbranch_scc1 L_spin_f2_14_loop
  s_branch L_back_f2_13
L_spin_f0_18:
  s_mov_b32 s81, 0x8000
L_spin_f0_18_loop:
  buffer_load_dwordx2 v[82:83], v80, s[40:43], s89 offen sc1
  s_waitcnt vmcnt(0)
  v_xor_b32 v82, s56, v82
  v_xor_b32 v83, s56, v83
  v_or_b32 v82, v82, v83
  v_cmp_ne_u32 vcc, 0, v82
  s_nop 1
  s_cbranch_vccz L_back_f0_17
  s_sub_u32 s81, s81, 1
  s_cmp_lg_u32 s81, 0
  s_cbranch_scc1 L_spin_f0_18_loop
  s_branch L_back_f0_17
L_spin_f1_20:
  s_mov_b32 s81, 0x8000
L_spin_f1_20_loop:
  buffer_load_dword v20, v19, s[40:43], s82 offen sc1
  s_waitcnt vmcnt(0)
  v_cmp_ne_u32 vcc, s56, v20
  s_nop 1
  s_cbranch_vccz L_back_f1_19
  s_sub_u32 s81, s81, 1
  s_cmp_lg_u32 s81, 0
  s_cbranch_scc1 L_spin_f1_20_loop
  s_branch L_back_f1_19
L_spin_f0_22:
  s_mov_b32 s81, 0x8000
L_spin_f0_22_loop:
  buffer_load_dwordx2 v[82:83], v80, s[40:43], s89 offen sc1
  s_waitcnt vmcnt(0)
  v_xor_b32 v82, s56, v82
  v_xor_b32 v83, s56, v83
  v_or_b32 v82, v82, v83
  v_cmp_ne_u32 vcc, 0, v82
  s_nop 1
  s_cbranch_vccz L_back_f0_21
  s_sub_u32 s81, s81, 1
  s_cmp_lg_u32 s81, 0
  s_cbranch_scc1 L_spin_f0_22_loop
  s_branch L_back_f0_21
L_spin_f3_24:
  s_mov_b32 s81, 0x8000
L_spin_f3_24_loop:
  buffer_load_dword v25, v24, s[40:43], s91 offen sc1
  s_waitcnt vmcnt(0)
  v_cmp_ne_u32 vcc, s56, v25
  s_nop 1
  s_cbranch_vccz L_back_f3_23
  s_sub_u32 s81, s81, 1
  s_cmp_lg_u32 s81, 0
  s_cbranch_scc1 L_spin_f3_24_loop
  s_branch L_back_f3_23
L_oloop_26:
  s_mov_b32 s81, 0x8000
L_oloop_26_l:
  s_add_u32 m0, s98, 0
  s_nop 0
  buffer_load_dwordx4 v1, s[40:43], s83 offen offset:0 sc1 lds
  buffer_load_dwordx4 v1, s[40:43], s83 offen offset:1024 sc1 lds
  buffer_load_dwordx4 v1, s[40:43], s83 offen offset:2048 sc1 lds
  buffer_load_dwordx4 v1, s[40:43], s83 offen offset:3072 sc1 lds
  s_add_u32 m0, s98, 4096
  s_nop 0
  buffer_load_dwordx4 v1, s[40:43], s84 offen offset:0 sc1 lds
  buffer_load_dwordx4 v1, s[40:43], s84 offen offset:1024 sc1 lds
  buffer_load_dwordx4 v1, s[40:43], s84 offen offset:2048 sc1 lds
  buffer_load_dwordx4 v1, s[40:43], s84 offen offset:3072 sc1 lds
  s_waitcnt vmcnt(0)
  v_add_u32 v27, s98, v1
  ds_read_b128 v[192:195], v27 offset:0
  ds_read_b128 v[196:199], v27 offset:1024
  ds_read_b128 v[200:203], v27 offset:2048
  ds_read_b128 v[204:207], v27 offset:3072
  ds_read_b128 v[208:211], v27 offset:4096
  ds_read_b128 v[212:215], v27 offset:5120
  ds_read_b128 v[216:219], v27 offset:6144
  ds_read_b128 v[220:223], v27 offset:7168
  s_waitcnt lgkmcnt(0)
  v_max3_u32 v26, v192, v193, v194
  v_max3_u32 v25, v208, v209, v210
  v_max3_u32 v26, v26, v195, v196
  v_max3_u32 v25, v25, v211, v212
  v_max3_u32 v26, v26, v197, v198
  v_max3_u32 v25, v25, v213, v214
  v_max3_u32 v26, v26, v199, v200
  v_max3_u32 v25, v25, v215, v216
  v_max3_u32 v26, v26, v201, v202
  v_max3_u32 v25, v25, v217, v218
  v_max3_u32 v26, v26, v203, v204
  v_max3_u32 v25, v25, v219, v220
  v_max3_u32 v26, v26, v205, v206
  v_max3_u32 v25, v25, v221, v222
  v_max3_u32 v26, v26, v207, v223
  v_max_u32 v26, v26, v25
  v_cmp_eq_u32 vcc, -1, v26
  s_nop 1
  s_cbranch_vccz L_oback_25
  s_sub_u32 s81, s81, 1
  s_cmp_lg_u32 s81, 0
  s_cbranch_scc1 L_oloop_26_l
  s_branch L_oback_25
L_oloop_28:
  s_mov_b32 s81, 0x8000
L_oloop_28_l:
  s_add_u32 m0, s99, 0
  s_nop 0
  buffer_load_dwordx4 v1, s[40:43], s85 offen offset:0 sc1 lds
  buffer_load_dwordx4 v1, s[40:43], s85 offen offset:1024 sc1 lds
  buffer_load_dwordx4 v1, s[40:43], s85 offen offset:2048 sc1 lds
  buffer_load_dwordx4 v1, s[40:43], s85 offen offset:3072 sc1 lds
  s_add_u32 m0, s99, 4096
  s_nop 0
  buffer_load_dwordx4 v1, s[40:43], s86 offen offset:0 sc1 lds
  buffer_load_dwordx4 v1, s[40:43], s86 offen offset:1024 sc1 lds
  buffer_load_dwordx4 v1, s[40:43], s86 offen offset:2048 sc1 lds
  buffer_load_dwordx4 v1, s[40:43], s86 offen offset:3072 sc1 lds
  s_waitcnt vmcnt(0)
  v_add_u32 v27, s99, v1
  ds_read_b128 v[192:195], v27 offset:0
  ds_read_b128 v[196:199], v27 offset:1024
  ds_read_b128 v[200:203], v27 offset:2048
  ds_read_b128 v[204:207], v27 offset:3072
  ds_read_b128 v[208:211], v27 offset:4096
  ds_read_b128 v[212:215], v27 offset:5120
  ds_read_b128 v[216:219], v27 offset:6144
  ds_read_b128 v[220:223], v27 offset:7168
  s_waitcnt lgkmcnt(0)
  v_max3_u32 v26, v192, v193, v194
  v_max3_u32 v25, v208, v209, v210
  v_max3_u32 v26, v26, v195, v196
  v_max3_u32 v25, v25, v211, v212
  v_max3_u32 v26, v26, v197, v198
  v_max3_u32 v25, v25, v213, v214
  v_max3_u32 v26, v26, v199, v200
  v_max3_u32 v25, v25, v215, v216
  v_max3_u32 v26, v26, v201, v202
  v_max3_u32 v25, v25, v217, v218
  v_max3_u32 v26, v26, v203, v204
  v_max3_u32 v25, v25, v219, v220
  v_max3_u32 v26, v26, v205, v206
  v_max3_u32 v25, v25, v221, v222
  v_max3_u32 v26, v26, v207, v223
  v_max_u32 v26, v26, v25
  v_cmp_eq_u32 vcc, -1, v26
  s_nop 1
  s_cbranch_vccz L_oback_27
  s_sub_u32 s81, s81, 1
  s_cmp_lg_u32 s81, 0
  s_cbranch_scc1 L_oloop_28_l
  s_branch L_oback_27
L_fallback:
  s_waitcnt vmcnt(0) lgkmcnt(0)
  s_barrier
  v_mov_b32 v80, 0xff800000
  v_mov_b32 v81, 0xff800000
  v_mov_b32 v82, 0xff800000
  v_mov_b32 v83, 0xff800000
  s_mov_b32 s81, 0
L_fb_max:
  s_lshl_b32 s72, s81, 12
  s_add_u32 s72, s72, s80
  buffer_load_dwordx4 v[32:35], v1, s[40:43], s72 offen offset:0 sc1
  buffer_load_dwordx4 v[36:39], v1, s[40:43], s72 offen offset:1024 sc1
  s_waitcnt vmcnt(0)
  v_mfma_f32_32x32x16_bf16 v[48:63], v[32:35], v[160:163], 0
  v_mfma_f32_32x32x16_bf16 v[48:63], v[36:39], v[164:167], v[48:63]
  s_nop 11
  v_max3_f32 v80, v80, v48, v49
  v_max3_f32 v80, v80, v50, v51
  v_max3_f32 v80, v80, v52, v53
  v_max3_f32 v80, v80, v54, v55
  v_max3_f32 v80, v80, v56, v57
  v_max3_f32 v80, v80, v58, v59
  v_max3_f32 v80, v80, v60, v61
  v_max3_f32 v80, v80, v62, v63
  v_mfma_f32_32x32x16_bf16 v[48:63], v[32:35], v[168:171], 0
  v_mfma_f32_32x32x16_bf16 v[48:63], v[36:39], v[172:175], v[48:63]
  s_nop 11
  v_max3_f32 v81, v81, v48, v49
  v_max3_f32 v81, v81, v50, v51
  v_max3_f32 v81, v81, v52, v53
  v_max3_f32 v81, v81, v54, v55
  v_max3_f32 v81, v81, v56, v57
  v_max3_f32 v81, v81, v58, v59
  v_max3_f32 v81, v81, v60, v61
  v_max3_f32 v81, v81, v62, v63
  v_mfma_f32_32x32x16_bf16 v[48:63], v[32:35], v[176:179], 0
  v_mfma_f32_32x32x16_bf16 v[48:63], v[36:39], v[180:183], v[48:63]
  s_nop 11
  v_max3_f32 v82, v82, v48, v49
  v_max3_f32 v82, v82, v50, v51
  v_max3_f32 v82, v82, v52, v53
  v_max3_f32 v82, v82, v54, v55
  v_max3_f32 v82, v82, v56, v57
  v_max3_f32 v82, v82, v58, v59
  v_max3_f32 v82, v82, v60, v61
  v_max3_f32 v82, v82, v62, v63
  v_mfma_f32_32x32x16_bf16 v[48:63], v[32:35], v[184:187], 0
  v_mfma_f32_32x32x16_bf16 v[48:63], v[36:39], v[188:191], v[48:63]
  s_nop 11
  v_max3_f32 v83, v83, v48, v49
  v_max3_f32 v83, v83, v50, v51
  v_max3_f32 v83, v83, v52, v53
  v_max3_f32 v83, v83, v54, v55
  v_max3_f32 v83, v83, v56, v57
  v_max3_f32 v83, v83, v58, v59
  v_max3_f32 v83, v83, v60, v61
  v_max3_f32 v83, v83, v62, v63
  s_add_u32 s81, s81, 1
  s_cmp_lt_u32 s81, 16
  s_cbranch_scc1 L_fb_max
  v_mov_b32 v84, v80
  v_mov_b32 v85, v81
  v_mov_b32 v86, v82
  v_mov_b32 v87, v83
  s_nop 0
  v_permlane32_swap_b32 v80, v84
  v_permlane32_swap_b32 v81, v85
  v_permlane32_swap_b32 v82, v86
  v_permlane32_swap_b32 v83, v87
  v_max_f32 v80, v80, v84
  v_max_f32 v81, v81, v85
  v_max_f32 v82, v82, v86
  v_max_f32 v83, v83, v87
  v_and_b32 v88, 31, v0
  v_lshlrev_b32 v88, 2, v88
  s_add_u32 s72, s55, 1
  s_and_b32 s72, s72, 3
  s_lshl_b32 s72, s72, 7
  s_add_u32 s72, s72, 49664
  v_add_u32 v89, s72, v88
  s_add_u32 s72, s55, 2
  s_and_b32 s72, s72, 3
  s_lshl_b32 s72, s72, 7
  s_add_u32 s72, s72, 49664
  v_add_u32 v90, s72, v88
  s_add_u32 s72, s55, 3
  s_and_b32 s72, s72, 3
  s_lshl_b32 s72, s72, 7
  s_add_u32 s72, s72, 49664
  v_add_u32 v91, s72, v88
  s_add_u32 s72, s55, 4
  s_and_b32 s72, s72, 3
  s_lshl_b32 s72, s72, 7
  s_add_u32 s72, s72, 49664
  v_add_u32 v92, s72, v88
  s_lshl_b32 s72, s55, 9
  v_add_u32 v93, s72, v89
  ds_write_b32 v93, v80
  v_add_u32 v93, s72, v90
  ds_write_b32 v93, v81
  v_add_u32 v93, s72, v91
  ds_write_b32 v93, v82
  v_add_u32 v93, s72, v92
  ds_write_b32 v93, v83
  s_waitcnt lgkmcnt(0)
  s_barrier
  ds_read_b32 v48, v89 offset:0
  ds_read_b32 v49, v89 offset:512
  ds_read_b32 v50, v89 offset:1024
  ds_read_b32 v51, v89 offset:1536
  ds_read_b32 v52, v90 offset:0
  ds_read_b32 v53, v90 offset:512
  ds_read_b32 v54, v90 offset:1024
  ds_read_b32 v55, v90 offset:1536
  ds_read_b32 v56, v91 offset:0
  ds_read_b32 v57, v91 offset:512
  ds_read_b32 v58, v91 offset:1024
  ds_read_b32 v59, v91 offset:1536
  ds_read_b32 v60, v92 offset:0
  ds_read_b32 v61, v92 offset:512
  ds_read_b32 v62, v92 offset:1024
  ds_read_b32 v63, v92 offset:1536
  s_waitcnt lgkmcnt(0)
  v_max3_f32 v80, v48, v49, v50
  v_max_f32 v80, v80, v51
  v_lshlrev_b32 v84, 16, v166
  v_sub_f32 v84, v84, v80
  v_max3_f32 v81, v52, v53, v54
  v_max_f32 v81, v81, v55
  v_lshlrev_b32 v85, 16, v174
  v_sub_f32 v85, v85, v81
  v_max3_f32 v82, v56, v57, v58
  v_max_f32 v82, v82, v59
  v_lshlrev_b32 v86, 16, v182
  v_sub_f32 v86, v86, v82
  v_max3_f32 v83, v60, v61, v62
  v_max_f32 v83, v83, v63
  v_lshlrev_b32 v87, 16, v190
  v_sub_f32 v87, v87, v83
  s_mov_b32 exec_lo, 0
  v_cvt_pk_bf16_f32 v166, v84, 0
  v_cvt_pk_bf16_f32 v174, v85, 0
  v_cvt_pk_bf16_f32 v182, v86, 0
  v_cvt_pk_bf16_f32 v190, v87, 0
  s_mov_b32 exec_lo, -1
  v_mov_b32 v96, 0
  v_mov_b32 v97, 0
  v_mov_b32 v98, 0
  v_mov_b32 v99, 0
  v_mov_b32 v100, 0
  v_mov_b32 v101, 0
  v_mov_b32 v102, 0
  v_mov_b32 v103, 0
  v_mov_b32 v104, 0
  v_mov_b32 v105, 0
  v_mov_b32 v106, 0
  v_mov_b32 v107, 0
  v_mov_b32 v108, 0
  v_mov_b32 v109, 0
  v_mov_b32 v110, 0
  v_mov_b32 v111, 0
  v_mov_b32 v112, 0
  v_mov_b32 v113, 0
  v_mov_b32 v114, 0
  v_mov_b32 v115, 0
  v_mov_b32 v116, 0
  v_mov_b32 v117, 0
  v_mov_b32 v118, 0
  v_mov_b32 v119, 0
  v_mov_b32 v120, 0
  v_mov_b32 v121, 0
  v_mov_b32 v122, 0
  v_mov_b32 v123, 0
  v_mov_b32 v124, 0
  v_mov_b32 v125, 0
  v_mov_b32 v126, 0
  v_mov_b32 v127, 0
  v_mov_b32 v128, 0
  v_mov_b32 v129, 0
  v_mov_b32 v130, 0
  v_mov_b32 v131, 0
  v_mov_b32 v132, 0
  v_mov_b32 v133, 0
  v_mov_b32 v134, 0
  v_mov_b32 v135, 0
  v_mov_b32 v136, 0
  v_mov_b32 v137, 0
  v_mov_b32 v138, 0
  v_mov_b32 v139, 0
  v_mov_b32 v140, 0
  v_mov_b32 v141, 0
  v_mov_b32 v142, 0
  v_mov_b32 v143, 0
  v_mov_b32 v144, 0
  v_mov_b32 v145, 0
  v_mov_b32 v146, 0
  v_mov_b32 v147, 0
  v_mov_b32 v148, 0
  v_mov_b32 v149, 0
  v_mov_b32 v150, 0
  v_mov_b32 v151, 0
  v_mov_b32 v152, 0
  v_mov_b32 v153, 0
  v_mov_b32 v154, 0
  v_mov_b32 v155, 0
  v_mov_b32 v156, 0
  v_mov_b32 v157, 0
  v_mov_b32 v158, 0
  v_mov_b32 v159, 0
  s_mov_b32 s81, 0
L_fb_main:
  s_lshl_b32 s72, s81, 12
  s_add_u32 s72, s72, s80
  buffer_load_dwordx4 v[32:35], v1, s[40:43], s72 offen offset:0 sc1
  buffer_load_dwordx4 v[36:39], v1, s[40:43], s72 offen offset:1024 sc1
  buffer_load_dwordx4 v[40:43], v1, s[40:43], s72 offen offset:2048 sc1
  buffer_load_dwordx4 v[44:47], v1, s[40:43], s72 offen offset:3072 sc1
  s_waitcnt vmcnt(0)
  v_mfma_f32_32x32x16_bf16 v[48:63], v[32:35], v[160:163], 0
  v_mfma_f32_32x32x16_bf16 v[48:63], v[36:39], v[164:167], v[48:63]
  s_nop 11
  v_exp_f32 v48, v48
  v_exp_f32 v49, v49
  v_exp_f32 v50, v50
  v_exp_f32 v51, v51
  v_exp_f32 v52, v52
  v_exp_f32 v53, v53
  v_exp_f32 v54, v54
  v_exp_f32 v55, v55
  v_exp_f32 v56, v56
  v_exp_f32 v57, v57
  v_exp_f32 v58, v58
  v_exp_f32 v59, v59
  v_exp_f32 v60, v60
  v_exp_f32 v61, v61
  v_exp_f32 v62, v62
  v_exp_f32 v63, v63
  s_nop 0
  v_cvt_pk_bf16_f32 v64, v48, v49
  v_cvt_pk_bf16_f32 v65, v50, v51
  v_cvt_pk_bf16_f32 v66, v52, v53
  v_cvt_pk_bf16_f32 v67, v54, v55
  v_cvt_pk_bf16_f32 v68, v56, v57
  v_cvt_pk_bf16_f32 v69, v58, v59
  v_cvt_pk_bf16_f32 v70, v60, v61
  v_cvt_pk_bf16_f32 v71, v62, v63
  s_nop 1
  v_mfma_f32_32x32x16_bf16 v[96:111], v[40:43], v[64:67], v[96:111]
  v_mfma_f32_32x32x16_bf16 v[96:111], v[44:47], v[68:71], v[96:111]
  v_mfma_f32_32x32x16_bf16 v[48:63], v[32:35], v[168:171], 0
  v_mfma_f32_32x32x16_bf16 v[48:63], v[36:39], v[172:175], v[48:63]
  s_nop 11
  v_exp_f32 v48, v48
  v_exp_f32 v49, v49
  v_exp_f32 v50, v50
  v_exp_f32 v51, v51
  v_exp_f32 v52, v52
  v_exp_f32 v53, v53
  v_exp_f32 v54, v54
  v_exp_f32 v55, v55
  v_exp_f32 v56, v56
  v_exp_f32 v57, v57
  v_exp_f32 v58, v58
  v_exp_f32 v59, v59
  v_exp_f32 v60, v60
  v_exp_f32 v61, v61
  v_exp_f32 v62, v62
  v_exp_f32 v63, v63
  s_nop 0
  v_cvt_pk_bf16_f32 v64, v48, v49
  v_cvt_pk_bf16_f32 v65, v50, v51
  v_cvt_pk_bf16_f32 v66, v52, v53
  v_cvt_pk_bf16_f32 v67, v54, v55
  v_cvt_pk_bf16_f32 v68, v56, v57
  v_cvt_pk_bf16_f32 v69, v58, v59
  v_cvt_pk_bf16_f32 v70, v60, v61
  v_cvt_pk_bf16_f32 v71, v62, v63
  s_nop 1
  v_mfma_f32_32x32x16_bf16 v[112:127], v[40:43], v[64:67], v[112:127]
  v_mfma_f32_32x32x16_bf16 v[112:127], v[44:47], v[68:71], v[112:127]
  v_mfma_f32_32x32x16_bf16 v[48:63], v[32:35], v[176:179], 0
  v_mfma_f32_32x32x16_bf16 v[48:63], v[36:39], v[180:183], v[48:63]
  s_nop 11
  v_exp_f32 v48, v48
  v_exp_f32 v49, v49
  v_exp_f32 v50, v50
  v_exp_f32 v51, v51
  v_exp_f32 v52, v52
  v_exp_f32 v53, v53
  v_exp_f32 v54, v54
  v_exp_f32 v55, v55
  v_exp_f32 v56, v56
  v_exp_f32 v57, v57
  v_exp_f32 v58, v58
  v_exp_f32 v59, v59
  v_exp_f32 v60, v60
  v_exp_f32 v61, v61
  v_exp_f32 v62, v62
  v_exp_f32 v63, v63
  s_nop 0
  v_cvt_pk_bf16_f32 v64, v48, v49
  v_cvt_pk_bf16_f32 v65, v50, v51
  v_cvt_pk_bf16_f32 v66, v52, v53
  v_cvt_pk_bf16_f32 v67, v54, v55
  v_cvt_pk_bf16_f32 v68, v56, v57
  v_cvt_pk_bf16_f32 v69, v58, v59
  v_cvt_pk_bf16_f32 v70, v60, v61
  v_cvt_pk_bf16_f32 v71, v62, v63
  s_nop 1
  v_mfma_f32_32x32x16_bf16 v[128:143], v[40:43], v[64:67], v[128:143]
  v_mfma_f32_32x32x16_bf16 v[128:143], v[44:47], v[68:71], v[128:143]
  v_mfma_f32_32x32x16_bf16 v[48:63], v[32:35], v[184:187], 0
  v_mfma_f32_32x32x16_bf16 v[48:63], v[36:39], v[188:191], v[48:63]
  s_nop 11
  v_exp_f32 v48, v48
  v_exp_f32 v49, v49
  v_exp_f32 v50, v50
  v_exp_f32 v51, v51
  v_exp_f32 v52, v52
  v_exp_f32 v53, v53
  v_exp_f32 v54, v54
  v_exp_f32 v55, v55
  v_exp_f32 v56, v56
  v_exp_f32 v57, v57
  v_exp_f32 v58, v58
  v_exp_f32 v59, v59
  v_exp_f32 v60, v60
  v_exp_f32 v61, v61
  v_exp_f32 v62, v62
  v_exp_f32 v63, v63
  s_nop 0
  v_cvt_pk_bf16_f32 v64, v48, v49
  v_cvt_pk_bf16_f32 v65, v50, v51
  v_cvt_pk_bf16_f32 v66, v52, v53
  v_cvt_pk_bf16_f32 v67, v54, v55
  v_cvt_pk_bf16_f32 v68, v56, v57
  v_cvt_pk_bf16_f32 v69, v58, v59
  v_cvt_pk_bf16_f32 v70, v60, v61
  v_cvt_pk_bf16_f32 v71, v62, v63
  s_nop 1
  v_mfma_f32_32x32x16_bf16 v[144:159], v[40:43], v[64:67], v[144:159]
  v_mfma_f32_32x32x16_bf16 v[144:159], v[44:47], v[68:71], v[144:159]
  s_add_u32 s81, s81, 1
  s_cmp_lt_u32 s81, 16
  s_cbranch_scc1 L_fb_main
  s_nop 11
  s_mov_b32 s100, -1
  s_barrier
  s_add_u32 s72, s55, 1
  s_and_b32 s72, s72, 3
  s_mul_i32 s72, s72, 12288
  s_add_u32 s72, s72, 0
  v_add_u32 v17, s72, v1
  s_add_u32 s72, s55, 2
  s_and_b32 s72, s72, 3
  s_mul_i32 s72, s72, 12288
  s_add_u32 s72, s72, 4096
  v_add_u32 v18, s72, v1
  s_add_u32 s72, s55, 3
  s_and_b32 s72, s72, 3
  s_mul_i32 s72, s72, 12288
  s_add_u32 s72, s72, 8192
  v_add_u32 v19, s72, v1
  s_mul_i32 s72, s55, 12288
  s_add_u32 s72, s72, 0
  v_add_u32 v20, s72, v1
  ds_write_b128 v17, v[96:99] offset:0
  ds_write_b128 v17, v[100:103] offset:1024
  ds_write_b128 v17, v[104:107] offset:2048
  ds_write_b128 v17, v[108:111] offset:3072
  ds_write_b128 v18, v[112:115] offset:0
  ds_write_b128 v18, v[116:119] offset:1024
  ds_write_b128 v18, v[120:123] offset:2048
  ds_write_b128 v18, v[124:127] offset:3072
  s_branch L_combine
L_codeend:
  s_endpgm
.section .rodata,"a"
.p2align 6
.amdhsa_kernel concat_heads__linear_kernel_hedgehog__mha_block__prompt_kernel
  .amdhsa_next_free_vgpr 512
  .amdhsa_next_free_sgpr 102
  .amdhsa_accum_offset 256
  .amdhsa_group_segment_fixed_size 0
  .amdhsa_kernarg_size 80
  .amdhsa_user_sgpr_count 2
  .amdhsa_user_sgpr_kernarg_segment_ptr 1
  .amdhsa_system_sgpr_workgroup_id_x 1
.end_amdhsa_kernel
```
